```python
import torch

def _softmax(x, axis=-1):
    return torch.softmax(x, dim=axis)
def _gelu(x):
    return torch.nn.functional.gelu(x, approximate="tanh")
def _silu(x):
    return torch.nn.functional.silu(x)
def _sigmoid(x):
    return torch.sigmoid(x)
def _layernorm(x, axis=-1, eps=1e-5):
    m = x.mean(dim=axis, keepdim=True)
    v = x.var(dim=axis, keepdim=True, unbiased=False)
    return (x - m) / torch.sqrt(v + eps)
def _scatter_add(tgt, idx, src, axis=0):
    return tgt.clone().index_add_(axis, idx, src)
def _segment_sum(src, seg, n):
    out = torch.zeros((n,) + src.shape[1:], dtype=src.dtype)
    return out.index_add_(0, seg, src)
def _pad(x, pw):
    flat = tuple(v for pair in reversed(pw) for v in pair)
    return torch.nn.functional.pad(x, flat)

kernel_name = 'interleave_layers__ssm_conv_h3__swiglu_ffn__prompt'

def setup_inputs():

    _w = (lambda a: (lambda t: t.to(torch.bfloat16) if t.is_floating_point() else t)(torch.as_tensor(a)))
    def _A_setup():
        B, S, D = 1, 2048, 640
        ks = 4
        return {
            "q": _w((lambda *s: torch.randn(*s, dtype=torch.bfloat16) * 0.05)(B, S, D)),
            "k": _w((lambda *s: torch.randn(*s, dtype=torch.bfloat16) * 0.8)(B, S, D)),
            "v": _w((lambda *s: torch.randn(*s, dtype=torch.bfloat16) * 0.8)(B, S, D)),
            "shift_k": _w((lambda *s: torch.randn(*s, dtype=torch.bfloat16) * 0.8)(D, ks) * 0.5),
            "ssm_k": _w((lambda *s: torch.randn(*s, dtype=torch.bfloat16) * 0.8)(D, S) * (1.0 / S ** 0.5)),
            "ssm_D": _w((lambda *s: torch.randn(*s, dtype=torch.bfloat16) * 0.8)(D)),
        }
    _A_in = _A_setup()

    def _B_setup():
        B, S, D, F = 1, 2048, 640, 1536
        return {
            "x": _w((lambda *s: torch.randn(*s, dtype=torch.bfloat16) * 0.05)(B, S, D)),
            "w_gate": _w((lambda *s: torch.randn(*s, dtype=torch.bfloat16) * 0.1)(D, F)),
            "w_up": _w((lambda *s: torch.randn(*s, dtype=torch.bfloat16) * 0.1)(D, F)),
            "w_down": _w((lambda *s: torch.randn(*s, dtype=torch.bfloat16) * 0.1)(F, D)),
        }
    _B_in = _B_setup()

    return {
        "A_q": _A_in["q"],
        "A_k": _A_in["k"],
        "A_v": _A_in["v"],
        "A_shift_k": _A_in["shift_k"],
        "A_ssm_k": _A_in["ssm_k"],
        "A_ssm_D": _A_in["ssm_D"],
        "B_x": _B_in["x"],
        "B_w_gate": _B_in["w_gate"],
        "B_w_up": _B_in["w_up"],
        "B_w_down": _B_in["w_down"],
    }

def reference(A_q, A_k, A_v, A_shift_k, A_ssm_k, A_ssm_D, B_x, B_w_gate, B_w_up, B_w_down):
    def _A_ref(q, k, v, shift_k, ssm_k, ssm_D):
        B, S, D = q.shape
        ks = shift_k.shape[-1]
        k_pad = _pad(k, ((0, 0), (ks - 1, 0), (0, 0)))
        k_shift = torch.zeros_like(k)
        for t in range(ks):
            k_shift = k_shift + k_pad[:, t:t + S, :] * shift_k[:, ks - 1 - t][None, None, :]
        kv = k_shift * v
        L = 2 * S
        kv_pad = _pad(kv, ((0, 0), (0, S), (0, 0)))
        kf_pad = _pad(ssm_k, ((0, 0), (0, S)))
        kv_f = (lambda x, axes=(-2,-1): torch.fft.rfft2(x.float(), dim=axes))(kv_pad[:, None, :, :], axes=(1, 2))
        kf_f = (lambda x, axes=(-2,-1): torch.fft.rfft2(x.float(), dim=axes))(kf_pad[:, None, :], axes=(1, 2))
        kf_f = (lambda x, *d: x.permute(*d))(kf_f, 1, 2, 0)
        y_f = kv_f * kf_f[None, :, :, :]
        y = (lambda x, s, axes=(-2,-1): torch.fft.irfft2(x, s=s, dim=axes).to(torch.bfloat16))(y_f, (1, L), axes=(1, 2))[:, 0, :S, :]
        y = y + kv * ssm_D[None, None, :]
        return q * y

    def _B_ref(x, w_gate, w_up, w_down):
        g = _silu(x @ w_gate)
        u = x @ w_up
        return (g * u) @ w_down

    x = A_q
    x = x + _A_ref(_layernorm(x, axis=-1), A_k, A_v, A_shift_k, A_ssm_k, A_ssm_D)
    x = x + _B_ref(_layernorm(x, axis=-1), B_w_gate, B_w_up, B_w_down)
    x = x + _A_ref(_layernorm(x, axis=-1), A_k, A_v, A_shift_k, A_ssm_k, A_ssm_D)
    x = x + _B_ref(_layernorm(x, axis=-1), B_w_gate, B_w_up, B_w_down)
    return x
```

```asm
; @launch grid=(256,1,1) block=(256,1,1) lds=163840
.amdgcn_target "amdgcn-amd-amdhsa--gfx950"
.text
.globl interleave_layers__ssm_conv_h3__swiglu_ffn__prompt_kernel
.p2align 8
.type interleave_layers__ssm_conv_h3__swiglu_ffn__prompt_kernel,@function
interleave_layers__ssm_conv_h3__swiglu_ffn__prompt_kernel:
    s_cmp_ge_u32 s2, 256
    s_cbranch_scc1 main_end
    s_load_dwordx2 s[24:25], s[0:1], 96
    s_load_dwordx2 s[26:27], s[0:1], 0
    s_getpc_b64 s[60:61]
mega_pc:
    s_sub_u32 s60, s60, mega_pc-interleave_layers__ssm_conv_h3__swiglu_ffn__prompt_kernel
    s_subb_u32 s61, s61, 0
    s_mov_b32 s62, main_code_end-interleave_layers__ssm_conv_h3__swiglu_ffn__prompt_kernel
    s_mov_b32 s63, 0x00020000
    s_lshr_b32 s10, s2, 3
    s_lshl_b32 s10, s10, 11
    v_lshrrev_b32 v2, 4, v0
    v_lshlrev_b32 v1, 7, v0
    v_lshl_or_b32 v1, v2, 24, v1
    buffer_load_dword v255, v1, s[60:63], s10 offen
    s_load_dwordx2 s[52:53], s[0:1], 88
    s_mov_b32 s54, 256
    s_mov_b32 s55, 0x00020000
    v_lshrrev_b32 v1, 6, v0
    s_nop 0
    v_readfirstlane_b32 s3, v1
    v_and_b32 v1, 63, v0
    v_and_b32 v2, 15, v0
    v_bfe_u32 v3, v0, 4, 2
    v_lshlrev_b32 v10, 4, v1
    s_cmp_lt_u32 s2, 96
    s_cbranch_scc1 main_prep
    s_load_dwordx2 s[28:29], s[0:1], 8
    s_mov_b32 s30, 2621440
    s_mov_b32 s31, 0x00020000
    s_load_dwordx2 s[36:37], s[0:1], 16
    s_mov_b32 s38, 2621440
    s_mov_b32 s39, 0x00020000
    s_load_dwordx2 s[32:33], s[0:1], 24
    s_mov_b32 s34, 5120
    s_mov_b32 s35, 0x00020000
    s_load_dwordx2 s[40:41], s[0:1], 32
    s_mov_b32 s42, 4096
    s_mov_b32 s43, 0x00020000
    s_load_dwordx2 s[44:45], s[0:1], 40
    s_mov_b32 s46, 1280
    s_mov_b32 s47, 0x00020000
    s_sub_u32 s56, s2, 96
    s_lshr_b32 s57, s56, 4
    s_and_b32 s58, s56, 15
    s_lshl_b32 s59, s56, 2
    s_add_u32 s60, s59, s3
    s_mul_i32 s61, s3, 21248
    s_add_u32 s61, s61, 78848
    v_lshrrev_b32 v4, 3, v1
    v_and_b32 v5, 7, v1
    s_lshl_b32 s10, s58, 7
    s_lshl_b32 s11, s3, 5
    s_add_u32 s10, s10, s11
    v_lshlrev_b32 v6, 2, v4
    v_add_u32 v6, s10, v6
    v_mul_u32_u24 v7, 1280, v6
    v_lshl_add_u32 v7, v5, 4, v7
    s_lshl_b32 s12, s57, 7
    v_add_u32 v7, s12, v7
    s_waitcnt lgkmcnt(0)
    buffer_load_dwordx4 v[28:31], v7, s[28:31], 0 offen offset:0
    buffer_load_dwordx4 v[32:35], v7, s[28:31], 0 offen offset:1280
    buffer_load_dwordx4 v[36:39], v7, s[28:31], 0 offen offset:2560
    buffer_load_dwordx4 v[40:43], v7, s[28:31], 0 offen offset:3840
    v_add_u32 v8, 0xfffffb00, v7
    buffer_load_dwordx4 v[24:27], v8, s[28:31], 0 offen
    v_add_u32 v8, 0xfffff600, v7
    buffer_load_dwordx4 v[20:23], v8, s[28:31], 0 offen
    v_add_u32 v8, 0xfffff100, v7
    buffer_load_dwordx4 v[16:19], v8, s[28:31], 0 offen
    buffer_load_dwordx4 v[44:47], v7, s[36:39], 0 offen offset:0
    buffer_load_dwordx4 v[48:51], v7, s[36:39], 0 offen offset:1280
    buffer_load_dwordx4 v[52:55], v7, s[36:39], 0 offen offset:2560
    buffer_load_dwordx4 v[56:59], v7, s[36:39], 0 offen offset:3840
    v_lshlrev_b32 v9, 6, v5
    s_lshl_b32 s12, s57, 9
    buffer_load_dwordx4 v[60:63], v9, s[32:35], s12 offen offset:0
    buffer_load_dwordx4 v[64:67], v9, s[32:35], s12 offen offset:16
    buffer_load_dwordx4 v[68:71], v9, s[32:35], s12 offen offset:32
    buffer_load_dwordx4 v[72:75], v9, s[32:35], s12 offen offset:48
    s_lshl_b32 s12, s60, 12
    s_add_u32 s40, s40, s12
    s_addc_u32 s41, s41, 0
    s_lshl_b32 s10, s3, 6
    s_sub_u32 s10, 248, s10
    v_lshlrev_b32 v8, 3, v4
    v_sub_u32 v8, s10, v8
    v_lshlrev_b32 v9, 4, v5
    v_xor_b32 v8, v8, v9
    v_lshl_add_u32 v8, v5, 11, v8
    s_waitcnt vmcnt(3)
    v_lshlrev_b32 v80, 16, v60
    v_and_b32 v81, 0xffff0000, v60
    v_lshlrev_b32 v82, 16, v61
    v_and_b32 v83, 0xffff0000, v61
    v_lshlrev_b32 v84, 16, v62
    v_and_b32 v85, 0xffff0000, v62
    v_lshlrev_b32 v86, 16, v63
    v_and_b32 v87, 0xffff0000, v63
    s_waitcnt vmcnt(2)
    v_lshlrev_b32 v88, 16, v64
    v_and_b32 v89, 0xffff0000, v64
    v_lshlrev_b32 v90, 16, v65
    v_and_b32 v91, 0xffff0000, v65
    v_lshlrev_b32 v92, 16, v66
    v_and_b32 v93, 0xffff0000, v66
    v_lshlrev_b32 v94, 16, v67
    v_and_b32 v95, 0xffff0000, v67
    s_waitcnt vmcnt(1)
    v_lshlrev_b32 v96, 16, v68
    v_and_b32 v97, 0xffff0000, v68
    v_lshlrev_b32 v98, 16, v69
    v_and_b32 v99, 0xffff0000, v69
    v_lshlrev_b32 v100, 16, v70
    v_and_b32 v101, 0xffff0000, v70
    v_lshlrev_b32 v102, 16, v71
    v_and_b32 v103, 0xffff0000, v71
    s_waitcnt vmcnt(0)
    v_lshlrev_b32 v104, 16, v72
    v_and_b32 v105, 0xffff0000, v72
    v_lshlrev_b32 v106, 16, v73
    v_and_b32 v107, 0xffff0000, v73
    v_lshlrev_b32 v108, 16, v74
    v_and_b32 v109, 0xffff0000, v74
    v_lshlrev_b32 v110, 16, v75
    v_and_b32 v111, 0xffff0000, v75
    s_mov_b64 exec, 0x1
    buffer_load_dwordx2 v[12:13], v1, s[52:55], 0 offen sc1
    s_mov_b64 exec, -1
    s_mov_b32 s28, s24
    s_mov_b32 s29, s25
    s_mov_b32 s30, 50331648
    s_mov_b32 s31, 0x00020000
    v_lshlrev_b32 v112, 16, v16
    v_and_b32 v113, 0xffff0000, v16
    v_lshlrev_b32 v114, 16, v20
    v_and_b32 v115, 0xffff0000, v20
    v_lshlrev_b32 v116, 16, v24
    v_and_b32 v117, 0xffff0000, v24
    v_lshlrev_b32 v118, 16, v28
    v_and_b32 v119, 0xffff0000, v28
    v_lshlrev_b32 v120, 16, v32
    v_and_b32 v121, 0xffff0000, v32
    v_lshlrev_b32 v122, 16, v36
    v_and_b32 v123, 0xffff0000, v36
    v_lshlrev_b32 v124, 16, v40
    v_and_b32 v125, 0xffff0000, v40
    v_lshlrev_b32 v128, 16, v44
    v_and_b32 v129, 0xffff0000, v44
    v_lshlrev_b32 v130, 16, v48
    v_and_b32 v131, 0xffff0000, v48
    v_lshlrev_b32 v132, 16, v52
    v_and_b32 v133, 0xffff0000, v52
    v_lshlrev_b32 v134, 16, v56
    v_and_b32 v135, 0xffff0000, v56
    v_mul_f32 v136, v112, v83
    v_mul_f32 v137, v114, v83
    v_mul_f32 v138, v116, v83
    v_mul_f32 v139, v118, v83
    v_fmac_f32 v136, v114, v82
    v_fmac_f32 v137, v116, v82
    v_fmac_f32 v138, v118, v82
    v_fmac_f32 v139, v120, v82
    v_fmac_f32 v136, v116, v81
    v_fmac_f32 v137, v118, v81
    v_fmac_f32 v138, v120, v81
    v_fmac_f32 v139, v122, v81
    v_fmac_f32 v136, v118, v80
    v_fmac_f32 v137, v120, v80
    v_fmac_f32 v138, v122, v80
    v_fmac_f32 v139, v124, v80
    v_mul_f32 v136, v136, v128
    v_mul_f32 v137, v137, v130
    v_mul_f32 v138, v138, v132
    v_mul_f32 v139, v139, v134
    v_cvt_pk_bf16_f32 v144, v139, v138
    v_cvt_pk_bf16_f32 v145, v137, v136
    ds_write_b64 v8, v[144:145] offset:0
    v_mul_f32 v140, v113, v87
    v_mul_f32 v141, v115, v87
    v_mul_f32 v142, v117, v87
    v_mul_f32 v143, v119, v87
    v_fmac_f32 v140, v115, v86
    v_fmac_f32 v141, v117, v86
    v_fmac_f32 v142, v119, v86
    v_fmac_f32 v143, v121, v86
    v_fmac_f32 v140, v117, v85
    v_fmac_f32 v141, v119, v85
    v_fmac_f32 v142, v121, v85
    v_fmac_f32 v143, v123, v85
    v_fmac_f32 v140, v119, v84
    v_fmac_f32 v141, v121, v84
    v_fmac_f32 v142, v123, v84
    v_fmac_f32 v143, v125, v84
    v_mul_f32 v140, v140, v129
    v_mul_f32 v141, v141, v131
    v_mul_f32 v142, v142, v133
    v_mul_f32 v143, v143, v135
    v_cvt_pk_bf16_f32 v146, v143, v142
    v_cvt_pk_bf16_f32 v147, v141, v140
    ds_write_b64 v8, v[146:147] offset:256
    v_lshlrev_b32 v112, 16, v17
    v_and_b32 v113, 0xffff0000, v17
    v_lshlrev_b32 v114, 16, v21
    v_and_b32 v115, 0xffff0000, v21
    v_lshlrev_b32 v116, 16, v25
    v_and_b32 v117, 0xffff0000, v25
    v_lshlrev_b32 v118, 16, v29
    v_and_b32 v119, 0xffff0000, v29
    v_lshlrev_b32 v120, 16, v33
    v_and_b32 v121, 0xffff0000, v33
    v_lshlrev_b32 v122, 16, v37
    v_and_b32 v123, 0xffff0000, v37
    v_lshlrev_b32 v124, 16, v41
    v_and_b32 v125, 0xffff0000, v41
    v_lshlrev_b32 v128, 16, v45
    v_and_b32 v129, 0xffff0000, v45
    v_lshlrev_b32 v130, 16, v49
    v_and_b32 v131, 0xffff0000, v49
    v_lshlrev_b32 v132, 16, v53
    v_and_b32 v133, 0xffff0000, v53
    v_lshlrev_b32 v134, 16, v57
    v_and_b32 v135, 0xffff0000, v57
    v_mul_f32 v136, v112, v91
    v_mul_f32 v137, v114, v91
    v_mul_f32 v138, v116, v91
    v_mul_f32 v139, v118, v91
    v_fmac_f32 v136, v114, v90
    v_fmac_f32 v137, v116, v90
    v_fmac_f32 v138, v118, v90
    v_fmac_f32 v139, v120, v90
    v_fmac_f32 v136, v116, v89
    v_fmac_f32 v137, v118, v89
    v_fmac_f32 v138, v120, v89
    v_fmac_f32 v139, v122, v89
    v_fmac_f32 v136, v118, v88
    v_fmac_f32 v137, v120, v88
    v_fmac_f32 v138, v122, v88
    v_fmac_f32 v139, v124, v88
    v_mul_f32 v136, v136, v128
    v_mul_f32 v137, v137, v130
    v_mul_f32 v138, v138, v132
    v_mul_f32 v139, v139, v134
    v_cvt_pk_bf16_f32 v144, v139, v138
    v_cvt_pk_bf16_f32 v145, v137, v136
    ds_write_b64 v8, v[144:145] offset:512
    v_mul_f32 v140, v113, v95
    v_mul_f32 v141, v115, v95
    v_mul_f32 v142, v117, v95
    v_mul_f32 v143, v119, v95
    v_fmac_f32 v140, v115, v94
    v_fmac_f32 v141, v117, v94
    v_fmac_f32 v142, v119, v94
    v_fmac_f32 v143, v121, v94
    v_fmac_f32 v140, v117, v93
    v_fmac_f32 v141, v119, v93
    v_fmac_f32 v142, v121, v93
    v_fmac_f32 v143, v123, v93
    v_fmac_f32 v140, v119, v92
    v_fmac_f32 v141, v121, v92
    v_fmac_f32 v142, v123, v92
    v_fmac_f32 v143, v125, v92
    v_mul_f32 v140, v140, v129
    v_mul_f32 v141, v141, v131
    v_mul_f32 v142, v142, v133
    v_mul_f32 v143, v143, v135
    v_cvt_pk_bf16_f32 v146, v143, v142
    v_cvt_pk_bf16_f32 v147, v141, v140
    ds_write_b64 v8, v[146:147] offset:768
    v_lshlrev_b32 v112, 16, v18
    v_and_b32 v113, 0xffff0000, v18
    v_lshlrev_b32 v114, 16, v22
    v_and_b32 v115, 0xffff0000, v22
    v_lshlrev_b32 v116, 16, v26
    v_and_b32 v117, 0xffff0000, v26
    v_lshlrev_b32 v118, 16, v30
    v_and_b32 v119, 0xffff0000, v30
    v_lshlrev_b32 v120, 16, v34
    v_and_b32 v121, 0xffff0000, v34
    v_lshlrev_b32 v122, 16, v38
    v_and_b32 v123, 0xffff0000, v38
    v_lshlrev_b32 v124, 16, v42
    v_and_b32 v125, 0xffff0000, v42
    v_lshlrev_b32 v128, 16, v46
    v_and_b32 v129, 0xffff0000, v46
    v_lshlrev_b32 v130, 16, v50
    v_and_b32 v131, 0xffff0000, v50
    v_lshlrev_b32 v132, 16, v54
    v_and_b32 v133, 0xffff0000, v54
    v_lshlrev_b32 v134, 16, v58
    v_and_b32 v135, 0xffff0000, v58
    v_mul_f32 v136, v112, v99
    v_mul_f32 v137, v114, v99
    v_mul_f32 v138, v116, v99
    v_mul_f32 v139, v118, v99
    v_fmac_f32 v136, v114, v98
    v_fmac_f32 v137, v116, v98
    v_fmac_f32 v138, v118, v98
    v_fmac_f32 v139, v120, v98
    v_fmac_f32 v136, v116, v97
    v_fmac_f32 v137, v118, v97
    v_fmac_f32 v138, v120, v97
    v_fmac_f32 v139, v122, v97
    v_fmac_f32 v136, v118, v96
    v_fmac_f32 v137, v120, v96
    v_fmac_f32 v138, v122, v96
    v_fmac_f32 v139, v124, v96
    v_mul_f32 v136, v136, v128
    v_mul_f32 v137, v137, v130
    v_mul_f32 v138, v138, v132
    v_mul_f32 v139, v139, v134
    v_cvt_pk_bf16_f32 v144, v139, v138
    v_cvt_pk_bf16_f32 v145, v137, v136
    ds_write_b64 v8, v[144:145] offset:1024
    v_mul_f32 v140, v113, v103
    v_mul_f32 v141, v115, v103
    v_mul_f32 v142, v117, v103
    v_mul_f32 v143, v119, v103
    v_fmac_f32 v140, v115, v102
    v_fmac_f32 v141, v117, v102
    v_fmac_f32 v142, v119, v102
    v_fmac_f32 v143, v121, v102
    v_fmac_f32 v140, v117, v101
    v_fmac_f32 v141, v119, v101
    v_fmac_f32 v142, v121, v101
    v_fmac_f32 v143, v123, v101
    v_fmac_f32 v140, v119, v100
    v_fmac_f32 v141, v121, v100
    v_fmac_f32 v142, v123, v100
    v_fmac_f32 v143, v125, v100
    v_mul_f32 v140, v140, v129
    v_mul_f32 v141, v141, v131
    v_mul_f32 v142, v142, v133
    v_mul_f32 v143, v143, v135
    v_cvt_pk_bf16_f32 v146, v143, v142
    v_cvt_pk_bf16_f32 v147, v141, v140
    ds_write_b64 v8, v[146:147] offset:1280
    v_lshlrev_b32 v112, 16, v19
    v_and_b32 v113, 0xffff0000, v19
    v_lshlrev_b32 v114, 16, v23
    v_and_b32 v115, 0xffff0000, v23
    v_lshlrev_b32 v116, 16, v27
    v_and_b32 v117, 0xffff0000, v27
    v_lshlrev_b32 v118, 16, v31
    v_and_b32 v119, 0xffff0000, v31
    v_lshlrev_b32 v120, 16, v35
    v_and_b32 v121, 0xffff0000, v35
    v_lshlrev_b32 v122, 16, v39
    v_and_b32 v123, 0xffff0000, v39
    v_lshlrev_b32 v124, 16, v43
    v_and_b32 v125, 0xffff0000, v43
    v_lshlrev_b32 v128, 16, v47
    v_and_b32 v129, 0xffff0000, v47
    v_lshlrev_b32 v130, 16, v51
    v_and_b32 v131, 0xffff0000, v51
    v_lshlrev_b32 v132, 16, v55
    v_and_b32 v133, 0xffff0000, v55
    v_lshlrev_b32 v134, 16, v59
    v_and_b32 v135, 0xffff0000, v59
    v_mul_f32 v136, v112, v107
    v_mul_f32 v137, v114, v107
    v_mul_f32 v138, v116, v107
    v_mul_f32 v139, v118, v107
    v_fmac_f32 v136, v114, v106
    v_fmac_f32 v137, v116, v106
    v_fmac_f32 v138, v118, v106
    v_fmac_f32 v139, v120, v106
    v_fmac_f32 v136, v116, v105
    v_fmac_f32 v137, v118, v105
    v_fmac_f32 v138, v120, v105
    v_fmac_f32 v139, v122, v105
    v_fmac_f32 v136, v118, v104
    v_fmac_f32 v137, v120, v104
    v_fmac_f32 v138, v122, v104
    v_fmac_f32 v139, v124, v104
    v_mul_f32 v136, v136, v128
    v_mul_f32 v137, v137, v130
    v_mul_f32 v138, v138, v132
    v_mul_f32 v139, v139, v134
    v_cvt_pk_bf16_f32 v144, v139, v138
    v_cvt_pk_bf16_f32 v145, v137, v136
    ds_write_b64 v8, v[144:145] offset:1536
    v_mul_f32 v140, v113, v111
    v_mul_f32 v141, v115, v111
    v_mul_f32 v142, v117, v111
    v_mul_f32 v143, v119, v111
    v_fmac_f32 v140, v115, v110
    v_fmac_f32 v141, v117, v110
    v_fmac_f32 v142, v119, v110
    v_fmac_f32 v143, v121, v110
    v_fmac_f32 v140, v117, v109
    v_fmac_f32 v141, v119, v109
    v_fmac_f32 v142, v121, v109
    v_fmac_f32 v143, v123, v109
    v_fmac_f32 v140, v119, v108
    v_fmac_f32 v141, v121, v108
    v_fmac_f32 v142, v123, v108
    v_fmac_f32 v143, v125, v108
    v_mul_f32 v140, v140, v129
    v_mul_f32 v141, v141, v131
    v_mul_f32 v142, v142, v133
    v_mul_f32 v143, v143, v135
    v_cvt_pk_bf16_f32 v146, v143, v142
    v_cvt_pk_bf16_f32 v147, v141, v140
    ds_write_b64 v8, v[146:147] offset:1792
    s_lshl_b32 s10, s3, 12
    v_lshlrev_b32 v8, 8, v3
    v_add_u32 v8, s10, v8
    s_lshl_b32 s11, s3, 1
    s_add_u32 s12, s11, 0
    v_xor_b32 v14, s12, v2
    v_lshl_add_u32 v14, v14, 4, v8
    s_add_u32 s12, s11, 1
    v_xor_b32 v15, s12, v2
    v_lshl_add_u32 v15, v15, 4, v8
    v_lshlrev_b32 v9, 12, v3
    v_lshl_add_u32 v9, v2, 4, v9
    s_lshl_b32 s10, s57, 6
    s_lshl_b32 s11, s3, 4
    s_add_u32 s10, s10, s11
    s_lshl_b32 s10, s10, 12
    s_lshl_b32 s11, s58, 8
    s_sub_u32 s11, 3840, s11
    s_add_u32 s10, s10, s11
    s_waitcnt lgkmcnt(0)
    s_barrier
    ds_read_b128 v[16:19], v14 offset:0
    ds_read_b128 v[20:23], v14 offset:1024
    ds_read_b128 v[24:27], v15 offset:2048
    ds_read_b128 v[28:31], v15 offset:3072
    s_waitcnt lgkmcnt(3)
    buffer_store_dwordx4 v[16:19], v9, s[28:31], s10 offen sc1
    s_add_u32 s10, s10, 16384
    s_waitcnt lgkmcnt(2)
    buffer_store_dwordx4 v[20:23], v9, s[28:31], s10 offen sc1
    s_add_u32 s10, s10, 16384
    s_waitcnt lgkmcnt(1)
    buffer_store_dwordx4 v[24:27], v9, s[28:31], s10 offen sc1
    s_add_u32 s10, s10, 16384
    s_waitcnt lgkmcnt(0)
    buffer_store_dwordx4 v[28:31], v9, s[28:31], s10 offen sc1
    s_add_u32 s10, s10, 16384
    buffer_load_dwordx4 v[164:167], v10, s[40:43], 0 offen offset:0
    v_add_u32 v9, 0xfffffff8, v10
    buffer_load_dwordx2 v[162:163], v9, s[40:43], 0 offen
    buffer_load_dwordx4 v[172:175], v10, s[40:43], 0 offen offset:1024
    v_add_u32 v9, 0x3f8, v10
    buffer_load_dwordx2 v[170:171], v9, s[40:43], 0 offen
    buffer_load_dwordx4 v[180:183], v10, s[40:43], 0 offen offset:2048
    v_add_u32 v9, 0x7f8, v10
    buffer_load_dwordx2 v[178:179], v9, s[40:43], 0 offen
    buffer_load_dwordx4 v[188:191], v10, s[40:43], 0 offen offset:3072
    v_add_u32 v9, 0xbf8, v10
    buffer_load_dwordx2 v[186:187], v9, s[40:43], 0 offen
    s_lshl_b32 s12, s60, 1
    v_mov_b32 v9, s12
    buffer_load_ushort v11, v9, s[44:47], 0 offen
    s_and_b32 s4, s2, 6
    s_lshr_b32 s10, s2, 7
    s_add_u32 s4, s4, s10
    s_bfe_u32 s5, s2, 0x40003
    s_and_b32 s10, s2, 1
    s_lshl_b32 s10, s10, 4
    s_add_u32 s5, s5, s10
    s_and_b32 s7, s5, 3
    s_lshr_b32 s8, s5, 2
    s_and_b32 s9, s3, 1
    s_lshr_b32 s14, s3, 1
    s_lshl_b32 s6, s4, 4
    s_lshl_b32 s10, s3, 1
    s_add_u32 s15, s6, s10
    s_lshl_b32 s10, s7, 1
    s_add_u32 s16, s6, s10
    s_add_u32 s16, s16, s9
    s_mul_i32 s17, s15, 20480
    s_mul_i32 s18, s3, 3072
    s_mul_i32 s19, s5, 122880
    s_add_u32 s19, s19, s18
    s_lshl_b32 s10, s8, 2
    s_add_u32 s10, s10, s3
    s_mul_i32 s10, s10, 61440
    s_lshl_b32 s11, s14, 11
    s_add_u32 s20, s10, s11
    s_xor_b32 s11, s11, 2048
    s_add_u32 s21, s10, s11
    s_add_u32 s22, s10, 4096
    s_mov_b32 s48, s24
    s_mov_b32 s49, s25
    s_mov_b32 s50, 50331648
    s_mov_b32 s51, 0x00020000
    s_add_u32 s32, s24, 4194304
    s_addc_u32 s33, s25, 0
    s_mov_b32 s34, 3932160
    s_mov_b32 s35, 0x00020000
    s_add_u32 s40, s24, 9437184
    s_addc_u32 s41, s25, 0
    s_mov_b32 s42, 1966080
    s_mov_b32 s43, 0x00020000
    s_add_u32 s44, s24, 41943040
    s_addc_u32 s45, s25, 0
    s_mov_b32 s46, 1540096
    s_mov_b32 s47, 0x00020000
    v_mov_b32 v32, 0
    v_mov_b32 v33, 0
    v_lshlrev_b32 v8, 3, v1
    v_add_u32 v8, s61, v8
    ds_write_b64 v8, v[32:33] offset:20736
    v_bfe_u32 v8, v1, 2, 2
    v_mul_u32_u24 v8, 4160, v8
    v_and_b32 v9, 3, v1
    v_lshl_add_u32 v8, v9, 3, v8
    v_add_u32 v8, s61, v8
    ds_write_b64 v8, v[32:33]
    v_add_u32 v8, s61, v10
    s_waitcnt vmcnt(13)
    v_mov_b32 v12, v12
    s_mov_b64 exec, 0x1
    v_cmp_ne_u32 vcc, 0, v12
    s_nop 0
    s_cmp_eq_u64 vcc, exec
    s_mov_b64 exec, -1
    s_cbranch_scc1 interleave_layers__ssm_conv_h3__swiglu_ffn__prompt_kernel_ok1
    s_mov_b32 s23, 0
interleave_layers__ssm_conv_h3__swiglu_ffn__prompt_kernel_spin2:
    s_sleep 8
    s_mov_b64 exec, 0x1
    buffer_load_dwordx2 v[12:13], v1, s[52:55], 0 offen sc1
    s_mov_b64 exec, -1
    s_waitcnt vmcnt(0)
    s_add_u32 s23, s23, 1
    s_cmp_ge_u32 s23, 262144
    s_cbranch_scc1 interleave_layers__ssm_conv_h3__swiglu_ffn__prompt_kernel_ok1
    v_mov_b32 v12, v12
    s_mov_b64 exec, 0x1
    v_cmp_ne_u32 vcc, 0, v12
    s_nop 0
    s_cmp_eq_u64 vcc, exec
    s_mov_b64 exec, -1
    s_cbranch_scc0 interleave_layers__ssm_conv_h3__swiglu_ffn__prompt_kernel_spin2
    s_nop 0
interleave_layers__ssm_conv_h3__swiglu_ffn__prompt_kernel_ok1:
    v_readfirstlane_b32 s100, v12
    v_readfirstlane_b32 s101, v13
    s_lshl_b32 s10, s56, 2
    s_add_u32 s10, s10, s3
    s_lshl_b32 s10, s10, 7
    s_add_u32 s10, s10, 43171840
    v_mov_b32 v14, s100
    v_mov_b32 v15, s101
    s_waitcnt vmcnt(9)
    s_mov_b64 exec, 0x1
    buffer_store_dwordx2 v[14:15], v1, s[48:51], s10 offen sc1
    s_mov_b64 exec, -1
    s_waitcnt vmcnt(9)
    ds_write_b128 v8, v[164:167] offset:32
    s_waitcnt vmcnt(8)
    v_alignbyte_b32 v48, v164, v163, 2
    v_alignbyte_b32 v49, v165, v164, 2
    v_alignbyte_b32 v50, v166, v165, 2
    v_alignbyte_b32 v51, v167, v166, 2
    ds_write_b128 v8, v[48:51] offset:4192
    v_mov_b32 v52, v163
    v_mov_b32 v53, v164
    v_mov_b32 v54, v165
    v_mov_b32 v55, v166
    ds_write_b128 v8, v[52:55] offset:8352
    v_alignbyte_b32 v56, v163, v162, 2
    v_alignbyte_b32 v57, v164, v163, 2
    v_alignbyte_b32 v58, v165, v164, 2
    v_alignbyte_b32 v59, v166, v165, 2
    ds_write_b128 v8, v[56:59] offset:12512
    s_waitcnt vmcnt(7)
    ds_write_b128 v8, v[172:175] offset:1056
    s_waitcnt vmcnt(6)
    v_alignbyte_b32 v60, v172, v171, 2
    v_alignbyte_b32 v61, v173, v172, 2
    v_alignbyte_b32 v62, v174, v173, 2
    v_alignbyte_b32 v63, v175, v174, 2
    ds_write_b128 v8, v[60:63] offset:5216
    v_mov_b32 v64, v171
    v_mov_b32 v65, v172
    v_mov_b32 v66, v173
    v_mov_b32 v67, v174
    ds_write_b128 v8, v[64:67] offset:9376
    v_alignbyte_b32 v68, v171, v170, 2
    v_alignbyte_b32 v69, v172, v171, 2
    v_alignbyte_b32 v70, v173, v172, 2
    v_alignbyte_b32 v71, v174, v173, 2
    ds_write_b128 v8, v[68:71] offset:13536
    s_waitcnt vmcnt(5)
    ds_write_b128 v8, v[180:183] offset:2080
    s_waitcnt vmcnt(4)
    v_alignbyte_b32 v48, v180, v179, 2
    v_alignbyte_b32 v49, v181, v180, 2
    v_alignbyte_b32 v50, v182, v181, 2
    v_alignbyte_b32 v51, v183, v182, 2
    ds_write_b128 v8, v[48:51] offset:6240
    v_mov_b32 v52, v179
    v_mov_b32 v53, v180
    v_mov_b32 v54, v181
    v_mov_b32 v55, v182
    ds_write_b128 v8, v[52:55] offset:10400
    v_alignbyte_b32 v56, v179, v178, 2
    v_alignbyte_b32 v57, v180, v179, 2
    v_alignbyte_b32 v58, v181, v180, 2
    v_alignbyte_b32 v59, v182, v181, 2
    ds_write_b128 v8, v[56:59] offset:14560
    s_waitcnt vmcnt(3)
    ds_write_b128 v8, v[188:191] offset:3104
    s_waitcnt vmcnt(2)
    v_alignbyte_b32 v60, v188, v187, 2
    v_alignbyte_b32 v61, v189, v188, 2
    v_alignbyte_b32 v62, v190, v189, 2
    v_alignbyte_b32 v63, v191, v190, 2
    ds_write_b128 v8, v[60:63] offset:7264
    v_mov_b32 v64, v187
    v_mov_b32 v65, v188
    v_mov_b32 v66, v189
    v_mov_b32 v67, v190
    ds_write_b128 v8, v[64:67] offset:11424
    v_alignbyte_b32 v68, v187, v186, 2
    v_alignbyte_b32 v69, v188, v187, 2
    v_alignbyte_b32 v70, v189, v188, 2
    v_alignbyte_b32 v71, v190, v189, 2
    ds_write_b128 v8, v[68:71] offset:15584
    v_sub_u32 v7, 3, v2
    v_and_b32 v7, 3, v7
    v_add3_u32 v8, v2, v7, 1
    v_lshl_add_u32 v8, v3, 3, v8
    v_lshlrev_b32 v8, 1, v8
    v_mul_u32_u24 v7, 4160, v7
    v_add3_u32 v4, v7, v8, s61
    v_lshlrev_b32 v7, 5, v2
    v_lshlrev_b32 v8, 4, v3
    v_sub_u32 v8, v8, v7
    v_add_u32 v8, 17120, v8
    v_add_u32 v5, s61, v8
    s_waitcnt vmcnt(1)
    v_lshlrev_b32 v11, 16, v11
    v_lshlrev_b32 v6, 7, v1
    s_lshl_b32 s12, s57, 13
    s_add_u32 s12, s12, 43171840
    buffer_load_dwordx2 v[12:13], v6, s[48:51], s12 offen sc1
    s_waitcnt vmcnt(0)
    v_cmp_eq_u64 vcc, s[100:101], v[12:13]
    s_nop 0
    s_cmp_eq_u64 vcc, -1
    s_cbranch_scc1 interleave_layers__ssm_conv_h3__swiglu_ffn__prompt_kernel_ok3
    s_mov_b32 s23, 0
interleave_layers__ssm_conv_h3__swiglu_ffn__prompt_kernel_spin4:
    s_sleep 1
    buffer_load_dwordx2 v[12:13], v6, s[48:51], s12 offen sc1
    s_waitcnt vmcnt(0)
    s_add_u32 s23, s23, 1
    s_cmp_ge_u32 s23, 262144
    s_cbranch_scc1 interleave_layers__ssm_conv_h3__swiglu_ffn__prompt_kernel_ok3
    v_cmp_eq_u64 vcc, s[100:101], v[12:13]
    s_nop 0
    s_cmp_eq_u64 vcc, -1
    s_cbranch_scc0 interleave_layers__ssm_conv_h3__swiglu_ffn__prompt_kernel_spin4
    s_nop 1
interleave_layers__ssm_conv_h3__swiglu_ffn__prompt_kernel_ok3:
    s_add_u32 m0, s61, 16640
    s_lshl_b32 s12, s60, 12
    buffer_load_dwordx4 v10, s[48:51], s12 offen offset:3072 sc1 lds
    buffer_load_dwordx4 v10, s[48:51], s12 offen offset:2048 sc1 lds
    buffer_load_dwordx4 v10, s[48:51], s12 offen offset:1024 sc1 lds
    buffer_load_dwordx4 v10, s[48:51], s12 offen offset:0 sc1 lds
    v_lshlrev_b32 v6, 3, v3
    v_add_u32 v6, v6, v2
    v_sub_u32 v6, 15, v6
    v_lshrrev_b32 v7, 16, v11
    v_and_b32 v8, 1, v6
    v_cmp_eq_u32 vcc, 1, v8
    s_nop 1
    v_cndmask_b32 v7, v7, v11, vcc
    v_ashrrev_i32 v6, 1, v6
    v_cmp_eq_u32 vcc, 0, v6
    s_nop 1
    v_cndmask_b32 v8, 0, v7, vcc
    v_accvgpr_write_b32 a240, v8
    v_cmp_eq_u32 vcc, 1, v6
    s_nop 1
    v_cndmask_b32 v8, 0, v7, vcc
    v_accvgpr_write_b32 a241, v8
    v_cmp_eq_u32 vcc, 2, v6
    s_nop 1
    v_cndmask_b32 v8, 0, v7, vcc
    v_accvgpr_write_b32 a242, v8
    v_cmp_eq_u32 vcc, 3, v6
    s_nop 1
    v_cndmask_b32 v8, 0, v7, vcc
    v_accvgpr_write_b32 a243, v8
    s_lshl_b32 s10, s3, 11
    v_lshlrev_b32 v6, 3, v1
    v_add_u32 v6, s10, v6
    v_mul_u32_u24 v7, 20480, v3
    v_lshl_add_u32 v7, v2, 4, v7
    s_mul_i32 s57, s3, 327680
    s_lshr_b32 s10, s56, 1
    s_lshl_b32 s10, s10, 8
    s_add_u32 s57, s57, s10
    s_and_b32 s10, s56, 1
    s_lshl_b32 s10, s10, 3
    s_add_u32 s57, s57, s10
    s_mul_i32 s58, s3, 327680
    s_lshl_b32 s10, s56, 8
    s_add_u32 s58, s58, s10
    s_mul_i32 s59, s3, 160
    s_add_u32 s59, s59, s56
    s_lshl_b32 s59, s59, 7
    s_add_u32 s59, s59, 1376256
    v_lshrrev_b32 v0, 1, v1
    v_lshlrev_b32 v0, 4, v0
    v_and_b32 v9, 1, v1
    s_lshr_b32 s10, s5, 2
    s_lshl_b32 s10, s10, 1
    v_add3_u32 v0, v0, v9, s10
    s_lshl_b32 s10, s3, 3
    s_add_u32 s10, s10, 56
    v_add_u32 v9, s10, v1
    v_cmp_gt_u32 vcc, 8, v1
    s_nop 1
    v_cndmask_b32 v0, v9, v0, vcc
    v_lshlrev_b32 v0, 7, v0
    v_add_u32 v0, 1196032, v0
    s_lshl_b32 s10, s3, 11
    s_add_u32 s62, s10, 1310720
    v_lshlrev_b32 v8, 7, v2
    v_lshl_add_u32 v8, v3, 13, v8
    s_waitcnt lgkmcnt(0)
    ds_read_b64 v[16:17], v4 offset:0
    ds_read_b64 v[18:19], v4 offset:8
    ds_read_b64 v[20:21], v4 offset:64
    ds_read_b64 v[22:23], v4 offset:72
    ds_read_b64 v[24:25], v4 offset:128
    ds_read_b64 v[26:27], v4 offset:136
    ds_read_b64 v[28:29], v4 offset:192
    ds_read_b64 v[30:31], v4 offset:200
    ds_read_b64 v[32:33], v4 offset:256
    ds_read_b64 v[34:35], v4 offset:264
    ds_read_b64 v[36:37], v4 offset:320
    ds_read_b64 v[38:39], v4 offset:328
    ds_read_b64 v[40:41], v4 offset:384
    ds_read_b64 v[42:43], v4 offset:392
    ds_read_b64 v[44:45], v4 offset:448
    ds_read_b64 v[46:47], v4 offset:456
    s_waitcnt vmcnt(0)
    ds_read_b128 v[112:115], v5 offset:3584
    ds_read_b128 v[116:119], v5 offset:3648
    ds_read_b128 v[120:123], v5 offset:3712
    ds_read_b128 v[124:127], v5 offset:3776
    ds_read_b128 v[128:131], v5 offset:3840
    ds_read_b128 v[132:135], v5 offset:3904
    ds_read_b128 v[136:139], v5 offset:3968
    ds_read_b128 v[140:143], v5 offset:4032
    ds_read_b128 v[144:147], v5 offset:3072
    s_waitcnt lgkmcnt(8)
    v_mfma_f32_16x16x32_bf16 v[80:83], v[16:19], v[112:115], 0
    v_mfma_f32_16x16x32_bf16 v[80:83], a[240:243], v[112:115], v[80:83]
    ds_read_b64 v[48:49], v4 offset:512
    ds_read_b128 v[148:151], v5 offset:3136
    s_waitcnt lgkmcnt(9)
    v_mfma_f32_16x16x32_bf16 v[80:83], v[20:23], v[116:119], v[80:83]
    ds_read_b64 v[50:51], v4 offset:520
    ds_read_b128 v[152:155], v5 offset:3200
    s_waitcnt lgkmcnt(10)
    v_mfma_f32_16x16x32_bf16 v[80:83], v[24:27], v[120:123], v[80:83]
    ds_read_b128 v[156:159], v5 offset:3264
    s_waitcnt lgkmcnt(10)
    v_mfma_f32_16x16x32_bf16 v[80:83], v[28:31], v[124:127], v[80:83]
    ds_read_b64 v[52:53], v4 offset:576
    ds_read_b128 v[160:163], v5 offset:3328
    s_waitcnt lgkmcnt(11)
    v_mfma_f32_16x16x32_bf16 v[80:83], v[32:35], v[128:131], v[80:83]
    ds_read_b128 v[164:167], v5 offset:3392
    s_waitcnt lgkmcnt(11)
    v_mfma_f32_16x16x32_bf16 v[80:83], v[36:39], v[132:135], v[80:83]
    ds_read_b64 v[54:55], v4 offset:584
    ds_read_b128 v[168:171], v5 offset:3456
    s_waitcnt lgkmcnt(12)
    v_mfma_f32_16x16x32_bf16 v[80:83], v[40:43], v[136:139], v[80:83]
    ds_read_b128 v[172:175], v5 offset:3520
    s_waitcnt lgkmcnt(12)
    v_mfma_f32_16x16x32_bf16 v[80:83], v[44:47], v[140:143], v[80:83]
    ds_read_b64 v[56:57], v4 offset:640
    ds_read_b128 v[176:179], v5 offset:2560
    s_waitcnt lgkmcnt(13)
    v_mfma_f32_16x16x32_bf16 v[84:87], v[16:19], v[144:147], 0
    v_mfma_f32_16x16x32_bf16 v[84:87], a[240:243], v[144:147], v[84:87]
    ds_read_b64 v[58:59], v4 offset:648
    ds_read_b128 v[180:183], v5 offset:2624
    s_waitcnt lgkmcnt(13)
    v_mfma_f32_16x16x32_bf16 v[84:87], v[20:23], v[148:151], v[84:87]
    ds_read_b128 v[184:187], v5 offset:2688
    s_waitcnt lgkmcnt(12)
    v_mfma_f32_16x16x32_bf16 v[84:87], v[24:27], v[152:155], v[84:87]
    ds_read_b64 v[60:61], v4 offset:704
    ds_read_b128 v[188:191], v5 offset:2752
    s_waitcnt lgkmcnt(13)
    v_mfma_f32_16x16x32_bf16 v[84:87], v[28:31], v[156:159], v[84:87]
    ds_read_b128 v[192:195], v5 offset:2816
    s_waitcnt lgkmcnt(12)
    v_mfma_f32_16x16x32_bf16 v[84:87], v[32:35], v[160:163], v[84:87]
    ds_read_b64 v[62:63], v4 offset:712
    ds_read_b128 v[196:199], v5 offset:2880
    s_waitcnt lgkmcnt(13)
    v_mfma_f32_16x16x32_bf16 v[84:87], v[36:39], v[164:167], v[84:87]
    ds_read_b128 v[200:203], v5 offset:2944
    s_waitcnt lgkmcnt(12)
    v_mfma_f32_16x16x32_bf16 v[84:87], v[40:43], v[168:171], v[84:87]
    ds_read_b64 v[64:65], v4 offset:768
    ds_read_b128 v[204:207], v5 offset:3008
    s_waitcnt lgkmcnt(13)
    v_mfma_f32_16x16x32_bf16 v[84:87], v[44:47], v[172:175], v[84:87]
    ds_read_b64 v[66:67], v4 offset:776
    ds_read_b128 v[208:211], v5 offset:2048
    s_waitcnt lgkmcnt(13)
    v_mfma_f32_16x16x32_bf16 v[88:91], v[16:19], v[176:179], 0
    v_mfma_f32_16x16x32_bf16 v[88:91], a[240:243], v[176:179], v[88:91]
    ds_read_b128 v[212:215], v5 offset:2112
    s_waitcnt lgkmcnt(12)
    v_mfma_f32_16x16x32_bf16 v[88:91], v[20:23], v[180:183], v[88:91]
    ds_read_b64 v[68:69], v4 offset:832
    ds_read_b128 v[216:219], v5 offset:2176
    s_waitcnt lgkmcnt(13)
    v_mfma_f32_16x16x32_bf16 v[88:91], v[24:27], v[184:187], v[88:91]
    ds_read_b128 v[220:223], v5 offset:2240
    s_waitcnt lgkmcnt(12)
    v_mfma_f32_16x16x32_bf16 v[88:91], v[28:31], v[188:191], v[88:91]
    ds_read_b64 v[70:71], v4 offset:840
    ds_read_b128 v[224:227], v5 offset:2304
    s_waitcnt lgkmcnt(13)
    v_mfma_f32_16x16x32_bf16 v[88:91], v[32:35], v[192:195], v[88:91]
    ds_read_b128 v[228:231], v5 offset:2368
    s_waitcnt lgkmcnt(12)
    v_mfma_f32_16x16x32_bf16 v[88:91], v[36:39], v[196:199], v[88:91]
    ds_read_b64 v[72:73], v4 offset:896
    ds_read_b128 v[232:235], v5 offset:2432
    s_waitcnt lgkmcnt(13)
    v_mfma_f32_16x16x32_bf16 v[88:91], v[40:43], v[200:203], v[88:91]
    ds_read_b64 v[74:75], v4 offset:904
    ds_read_b128 v[236:239], v5 offset:2496
    s_waitcnt lgkmcnt(13)
    v_mfma_f32_16x16x32_bf16 v[88:91], v[44:47], v[204:207], v[88:91]
    s_waitcnt lgkmcnt(11)
    v_mfma_f32_16x16x32_bf16 v[92:95], v[16:19], v[208:211], 0
    v_mfma_f32_16x16x32_bf16 v[92:95], a[240:243], v[208:211], v[92:95]
    ds_read_b64 v[76:77], v4 offset:960
    s_waitcnt lgkmcnt(11)
    v_mfma_f32_16x16x32_bf16 v[92:95], v[20:23], v[212:215], v[92:95]
    s_waitcnt lgkmcnt(9)
    v_mfma_f32_16x16x32_bf16 v[92:95], v[24:27], v[216:219], v[92:95]
    ds_read_b64 v[78:79], v4 offset:968
    s_waitcnt lgkmcnt(9)
    v_mfma_f32_16x16x32_bf16 v[92:95], v[28:31], v[220:223], v[92:95]
    s_waitcnt lgkmcnt(7)
    v_mfma_f32_16x16x32_bf16 v[92:95], v[32:35], v[224:227], v[92:95]
    s_waitcnt lgkmcnt(6)
    v_mfma_f32_16x16x32_bf16 v[92:95], v[36:39], v[228:231], v[92:95]
    s_waitcnt lgkmcnt(4)
    v_mfma_f32_16x16x32_bf16 v[92:95], v[40:43], v[232:235], v[92:95]
    s_waitcnt lgkmcnt(2)
    v_mfma_f32_16x16x32_bf16 v[92:95], v[44:47], v[236:239], v[92:95]
    s_mov_b32 exec_lo, 0xffff
    s_mov_b32 exec_hi, 0
    buffer_load_dwordx2 v[12:13], v0, s[44:47], 0 offen sc1
    s_mov_b64 exec, -1
    v_mfma_f32_16x16x32_bf16 v[84:87], v[48:51], v[112:115], v[84:87]
    ds_read_b64 v[16:17], v4 offset:1024
    v_mfma_f32_16x16x32_bf16 v[84:87], v[52:55], v[116:119], v[84:87]
    ds_read_b64 v[18:19], v4 offset:1032
    v_mfma_f32_16x16x32_bf16 v[84:87], v[56:59], v[120:123], v[84:87]
    v_mfma_f32_16x16x32_bf16 v[84:87], v[60:63], v[124:127], v[84:87]
    ds_read_b64 v[20:21], v4 offset:1088
    v_mfma_f32_16x16x32_bf16 v[84:87], v[64:67], v[128:131], v[84:87]
    v_mfma_f32_16x16x32_bf16 v[84:87], v[68:71], v[132:135], v[84:87]
    ds_read_b64 v[22:23], v4 offset:1096
    v_mfma_f32_16x16x32_bf16 v[84:87], v[72:75], v[136:139], v[84:87]
    s_waitcnt lgkmcnt(4)
    v_mfma_f32_16x16x32_bf16 v[84:87], v[76:79], v[140:143], v[84:87]
    ds_read_b64 v[24:25], v4 offset:1152
    v_mfma_f32_16x16x32_bf16 v[88:91], v[48:51], v[144:147], v[88:91]
    ds_read_b64 v[26:27], v4 offset:1160
    v_mfma_f32_16x16x32_bf16 v[88:91], v[52:55], v[148:151], v[88:91]
    v_mfma_f32_16x16x32_bf16 v[88:91], v[56:59], v[152:155], v[88:91]
    ds_read_b64 v[28:29], v4 offset:1216
    v_mfma_f32_16x16x32_bf16 v[88:91], v[60:63], v[156:159], v[88:91]
    v_mfma_f32_16x16x32_bf16 v[88:91], v[64:67], v[160:163], v[88:91]
    ds_read_b64 v[30:31], v4 offset:1224
    v_mfma_f32_16x16x32_bf16 v[88:91], v[68:71], v[164:167], v[88:91]
    v_mfma_f32_16x16x32_bf16 v[88:91], v[72:75], v[168:171], v[88:91]
    ds_read_b64 v[32:33], v4 offset:1280
    v_mfma_f32_16x16x32_bf16 v[88:91], v[76:79], v[172:175], v[88:91]
    ds_read_b64 v[34:35], v4 offset:1288
    v_mfma_f32_16x16x32_bf16 v[92:95], v[48:51], v[176:179], v[92:95]
    v_mfma_f32_16x16x32_bf16 v[92:95], v[52:55], v[180:183], v[92:95]
    ds_read_b64 v[36:37], v4 offset:1344
    v_mfma_f32_16x16x32_bf16 v[92:95], v[56:59], v[184:187], v[92:95]
    v_mfma_f32_16x16x32_bf16 v[92:95], v[60:63], v[188:191], v[92:95]
    ds_read_b64 v[38:39], v4 offset:1352
    v_mfma_f32_16x16x32_bf16 v[92:95], v[64:67], v[192:195], v[92:95]
    v_mfma_f32_16x16x32_bf16 v[92:95], v[68:71], v[196:199], v[92:95]
    ds_read_b64 v[40:41], v4 offset:1408
    v_mfma_f32_16x16x32_bf16 v[92:95], v[72:75], v[200:203], v[92:95]
    ds_read_b64 v[42:43], v4 offset:1416
    v_mfma_f32_16x16x32_bf16 v[92:95], v[76:79], v[204:207], v[92:95]
    v_mfma_f32_16x16x32_bf16 v[96:99], v[48:51], v[208:211], 0
    ds_read_b64 v[44:45], v4 offset:1472
    v_mfma_f32_16x16x32_bf16 v[96:99], v[52:55], v[212:215], v[96:99]
    v_mfma_f32_16x16x32_bf16 v[96:99], v[56:59], v[216:219], v[96:99]
    ds_read_b64 v[46:47], v4 offset:1480
    v_mfma_f32_16x16x32_bf16 v[96:99], v[60:63], v[220:223], v[96:99]
    v_mfma_f32_16x16x32_bf16 v[96:99], v[64:67], v[224:227], v[96:99]
    v_mfma_f32_16x16x32_bf16 v[96:99], v[68:71], v[228:231], v[96:99]
    v_mfma_f32_16x16x32_bf16 v[96:99], v[72:75], v[232:235], v[96:99]
    v_mfma_f32_16x16x32_bf16 v[96:99], v[76:79], v[236:239], v[96:99]
    s_waitcnt vmcnt(0)
    v_mov_b32 v12, v12
    s_mov_b32 exec_lo, 0xffff
    s_mov_b32 exec_hi, 0
    v_cmp_eq_u64 vcc, s[100:101], v[12:13]
    s_nop 0
    s_cmp_eq_u64 vcc, exec
    s_mov_b64 exec, -1
    s_cbranch_scc1 interleave_layers__ssm_conv_h3__swiglu_ffn__prompt_kernel_ok5
    s_mov_b32 s23, 0
interleave_layers__ssm_conv_h3__swiglu_ffn__prompt_kernel_spin6:
    s_sleep 1
    s_mov_b32 exec_lo, 0xffff
    s_mov_b32 exec_hi, 0
    buffer_load_dwordx2 v[12:13], v0, s[44:47], 0 offen sc1
    s_mov_b64 exec, -1
    s_waitcnt vmcnt(0)
    s_add_u32 s23, s23, 1
    s_cmp_ge_u32 s23, 262144
    s_cbranch_scc1 interleave_layers__ssm_conv_h3__swiglu_ffn__prompt_kernel_ok5
    v_mov_b32 v12, v12
    s_mov_b32 exec_lo, 0xffff
    s_mov_b32 exec_hi, 0
    v_cmp_eq_u64 vcc, s[100:101], v[12:13]
    s_nop 0
    s_cmp_eq_u64 vcc, exec
    s_mov_b64 exec, -1
    s_cbranch_scc0 interleave_layers__ssm_conv_h3__swiglu_ffn__prompt_kernel_spin6
    s_nop 0
interleave_layers__ssm_conv_h3__swiglu_ffn__prompt_kernel_ok5:
    s_waitcnt lgkmcnt(14)
    v_mfma_f32_16x16x32_bf16 v[88:91], v[16:19], v[112:115], v[88:91]
    ds_read_b64 v[48:49], v4 offset:1536
    s_add_u32 m0, s18, 0
    s_add_u32 s11, s19, 0
    buffer_load_dwordx4 v10, s[32:35], s11 offen offset:0 sc1 lds
    s_waitcnt lgkmcnt(13)
    v_mfma_f32_16x16x32_bf16 v[88:91], v[20:23], v[116:119], v[88:91]
    ds_read_b64 v[50:51], v4 offset:1544
    s_waitcnt lgkmcnt(12)
    v_mfma_f32_16x16x32_bf16 v[88:91], v[24:27], v[120:123], v[88:91]
    s_waitcnt lgkmcnt(10)
    v_mfma_f32_16x16x32_bf16 v[88:91], v[28:31], v[124:127], v[88:91]
    ds_read_b64 v[52:53], v4 offset:1600
    s_waitcnt lgkmcnt(9)
    v_mfma_f32_16x16x32_bf16 v[88:91], v[32:35], v[128:131], v[88:91]
    s_waitcnt lgkmcnt(7)
    v_mfma_f32_16x16x32_bf16 v[88:91], v[36:39], v[132:135], v[88:91]
    ds_read_b64 v[54:55], v4 offset:1608
    buffer_load_dwordx4 v10, s[32:35], s11 offen offset:1024 sc1 lds
    s_waitcnt lgkmcnt(6)
    v_mfma_f32_16x16x32_bf16 v[88:91], v[40:43], v[136:139], v[88:91]
    s_waitcnt lgkmcnt(4)
    v_mfma_f32_16x16x32_bf16 v[88:91], v[44:47], v[140:143], v[88:91]
    ds_read_b64 v[56:57], v4 offset:1664
    v_mfma_f32_16x16x32_bf16 v[92:95], v[16:19], v[144:147], v[92:95]
    ds_read_b64 v[58:59], v4 offset:1672
    v_mfma_f32_16x16x32_bf16 v[92:95], v[20:23], v[148:151], v[92:95]
    v_mfma_f32_16x16x32_bf16 v[92:95], v[24:27], v[152:155], v[92:95]
    ds_read_b64 v[60:61], v4 offset:1728
    buffer_load_dwordx4 v10, s[32:35], s11 offen offset:2048 sc1 lds
    v_mfma_f32_16x16x32_bf16 v[92:95], v[28:31], v[156:159], v[92:95]
    v_mfma_f32_16x16x32_bf16 v[92:95], v[32:35], v[160:163], v[92:95]
    ds_read_b64 v[62:63], v4 offset:1736
    v_mfma_f32_16x16x32_bf16 v[92:95], v[36:39], v[164:167], v[92:95]
    v_mfma_f32_16x16x32_bf16 v[92:95], v[40:43], v[168:171], v[92:95]
    ds_read_b64 v[64:65], v4 offset:1792
    v_mfma_f32_16x16x32_bf16 v[92:95], v[44:47], v[172:175], v[92:95]
    ds_read_b64 v[66:67], v4 offset:1800
    s_add_u32 m0, s18, 12288
    s_add_u32 s11, s19, 12288
    buffer_load_dwordx4 v10, s[32:35], s11 offen offset:0 sc1 lds
    v_mfma_f32_16x16x32_bf16 v[96:99], v[16:19], v[176:179], v[96:99]
    v_mfma_f32_16x16x32_bf16 v[96:99], v[20:23], v[180:183], v[96:99]
    ds_read_b64 v[68:69], v4 offset:1856
    v_mfma_f32_16x16x32_bf16 v[96:99], v[24:27], v[184:187], v[96:99]
    v_mfma_f32_16x16x32_bf16 v[96:99], v[28:31], v[188:191], v[96:99]
    ds_read_b64 v[70:71], v4 offset:1864
    v_mfma_f32_16x16x32_bf16 v[96:99], v[32:35], v[192:195], v[96:99]
    buffer_load_dwordx4 v10, s[32:35], s11 offen offset:1024 sc1 lds
    v_mfma_f32_16x16x32_bf16 v[96:99], v[36:39], v[196:199], v[96:99]
    ds_read_b64 v[72:73], v4 offset:1920
    v_mfma_f32_16x16x32_bf16 v[96:99], v[40:43], v[200:203], v[96:99]
    ds_read_b64 v[74:75], v4 offset:1928
    v_mfma_f32_16x16x32_bf16 v[96:99], v[44:47], v[204:207], v[96:99]
    v_mfma_f32_16x16x32_bf16 v[100:103], v[16:19], v[208:211], 0
    ds_read_b64 v[76:77], v4 offset:1984
    v_mfma_f32_16x16x32_bf16 v[100:103], v[20:23], v[212:215], v[100:103]
    buffer_load_dwordx4 v10, s[32:35], s11 offen offset:2048 sc1 lds
    v_mfma_f32_16x16x32_bf16 v[100:103], v[24:27], v[216:219], v[100:103]
    ds_read_b64 v[78:79], v4 offset:1992
    v_mfma_f32_16x16x32_bf16 v[100:103], v[28:31], v[220:223], v[100:103]
    v_mfma_f32_16x16x32_bf16 v[100:103], v[32:35], v[224:227], v[100:103]
    v_mfma_f32_16x16x32_bf16 v[100:103], v[36:39], v[228:231], v[100:103]
    v_mfma_f32_16x16x32_bf16 v[100:103], v[40:43], v[232:235], v[100:103]
    s_add_u32 m0, s18, 24576
    s_add_u32 s11, s19, 24576
    buffer_load_dwordx4 v10, s[32:35], s11 offen offset:0 sc1 lds
    v_mfma_f32_16x16x32_bf16 v[100:103], v[44:47], v[236:239], v[100:103]
    s_waitcnt lgkmcnt(14)
    v_mfma_f32_16x16x32_bf16 v[92:95], v[48:51], v[112:115], v[92:95]
    ds_read_b64 v[16:17], v4 offset:2048
    s_waitcnt lgkmcnt(13)
    v_mfma_f32_16x16x32_bf16 v[92:95], v[52:55], v[116:119], v[92:95]
    ds_read_b64 v[18:19], v4 offset:2056
    s_waitcnt lgkmcnt(12)
    v_mfma_f32_16x16x32_bf16 v[92:95], v[56:59], v[120:123], v[92:95]
    s_waitcnt lgkmcnt(10)
    v_mfma_f32_16x16x32_bf16 v[92:95], v[60:63], v[124:127], v[92:95]
    ds_read_b64 v[20:21], v4 offset:2112
    buffer_load_dwordx4 v10, s[32:35], s11 offen offset:1024 sc1 lds
    s_waitcnt lgkmcnt(9)
    v_mfma_f32_16x16x32_bf16 v[92:95], v[64:67], v[128:131], v[92:95]
    s_waitcnt lgkmcnt(7)
    v_mfma_f32_16x16x32_bf16 v[92:95], v[68:71], v[132:135], v[92:95]
    ds_read_b64 v[22:23], v4 offset:2120
    s_waitcnt lgkmcnt(6)
    v_mfma_f32_16x16x32_bf16 v[92:95], v[72:75], v[136:139], v[92:95]
    s_waitcnt lgkmcnt(4)
    v_mfma_f32_16x16x32_bf16 v[92:95], v[76:79], v[140:143], v[92:95]
    ds_read_b64 v[24:25], v4 offset:2176
    v_mfma_f32_16x16x32_bf16 v[96:99], v[48:51], v[144:147], v[96:99]
    ds_read_b64 v[26:27], v4 offset:2184
    buffer_load_dwordx4 v10, s[32:35], s11 offen offset:2048 sc1 lds
    v_mfma_f32_16x16x32_bf16 v[96:99], v[52:55], v[148:151], v[96:99]
    v_mfma_f32_16x16x32_bf16 v[96:99], v[56:59], v[152:155], v[96:99]
    ds_read_b64 v[28:29], v4 offset:2240
    v_mfma_f32_16x16x32_bf16 v[96:99], v[60:63], v[156:159], v[96:99]
    v_mfma_f32_16x16x32_bf16 v[96:99], v[64:67], v[160:163], v[96:99]
    ds_read_b64 v[30:31], v4 offset:2248
    v_mfma_f32_16x16x32_bf16 v[96:99], v[68:71], v[164:167], v[96:99]
    s_add_u32 m0, s18, 36864
    s_add_u32 s11, s19, 36864
    buffer_load_dwordx4 v10, s[32:35], s11 offen offset:0 sc1 lds
    v_mfma_f32_16x16x32_bf16 v[96:99], v[72:75], v[168:171], v[96:99]
    ds_read_b64 v[32:33], v4 offset:2304
    v_mfma_f32_16x16x32_bf16 v[96:99], v[76:79], v[172:175], v[96:99]
    ds_read_b64 v[34:35], v4 offset:2312
    v_mfma_f32_16x16x32_bf16 v[100:103], v[48:51], v[176:179], v[100:103]
    v_mfma_f32_16x16x32_bf16 v[100:103], v[52:55], v[180:183], v[100:103]
    ds_read_b64 v[36:37], v4 offset:2368
    v_mfma_f32_16x16x32_bf16 v[100:103], v[56:59], v[184:187], v[100:103]
    buffer_load_dwordx4 v10, s[32:35], s11 offen offset:1024 sc1 lds
    v_mfma_f32_16x16x32_bf16 v[100:103], v[60:63], v[188:191], v[100:103]
    ds_read_b64 v[38:39], v4 offset:2376
    v_mfma_f32_16x16x32_bf16 v[100:103], v[64:67], v[192:195], v[100:103]
    v_mfma_f32_16x16x32_bf16 v[100:103], v[68:71], v[196:199], v[100:103]
    ds_read_b64 v[40:41], v4 offset:2432
    v_mfma_f32_16x16x32_bf16 v[100:103], v[72:75], v[200:203], v[100:103]
    ds_read_b64 v[42:43], v4 offset:2440
    v_mfma_f32_16x16x32_bf16 v[100:103], v[76:79], v[204:207], v[100:103]
    buffer_load_dwordx4 v10, s[32:35], s11 offen offset:2048 sc1 lds
    v_mfma_f32_16x16x32_bf16 v[104:107], v[48:51], v[208:211], 0
    ds_read_b64 v[44:45], v4 offset:2496
    v_mfma_f32_16x16x32_bf16 v[104:107], v[52:55], v[212:215], v[104:107]
    v_mfma_f32_16x16x32_bf16 v[104:107], v[56:59], v[216:219], v[104:107]
    ds_read_b64 v[46:47], v4 offset:2504
    v_mfma_f32_16x16x32_bf16 v[104:107], v[60:63], v[220:223], v[104:107]
    v_mfma_f32_16x16x32_bf16 v[104:107], v[64:67], v[224:227], v[104:107]
    s_add_u32 m0, s18, 49152
    s_add_u32 s11, s19, 49152
    buffer_load_dwordx4 v10, s[32:35], s11 offen offset:0 sc1 lds
    v_mfma_f32_16x16x32_bf16 v[104:107], v[68:71], v[228:231], v[104:107]
    v_mfma_f32_16x16x32_bf16 v[104:107], v[72:75], v[232:235], v[104:107]
    v_mfma_f32_16x16x32_bf16 v[104:107], v[76:79], v[236:239], v[104:107]
    s_waitcnt lgkmcnt(14)
    v_mfma_f32_16x16x32_bf16 v[96:99], v[16:19], v[112:115], v[96:99]
    ds_read_b64 v[48:49], v4 offset:2560
    s_waitcnt lgkmcnt(13)
    v_mfma_f32_16x16x32_bf16 v[96:99], v[20:23], v[116:119], v[96:99]
    ds_read_b64 v[50:51], v4 offset:2568
    buffer_load_dwordx4 v10, s[32:35], s11 offen offset:1024 sc1 lds
    s_waitcnt lgkmcnt(12)
    v_mfma_f32_16x16x32_bf16 v[96:99], v[24:27], v[120:123], v[96:99]
    s_waitcnt lgkmcnt(10)
    v_mfma_f32_16x16x32_bf16 v[96:99], v[28:31], v[124:127], v[96:99]
    ds_read_b64 v[52:53], v4 offset:2624
    s_waitcnt lgkmcnt(9)
    v_mfma_f32_16x16x32_bf16 v[96:99], v[32:35], v[128:131], v[96:99]
    s_waitcnt lgkmcnt(7)
    v_mfma_f32_16x16x32_bf16 v[96:99], v[36:39], v[132:135], v[96:99]
    ds_read_b64 v[54:55], v4 offset:2632
    s_waitcnt lgkmcnt(6)
    v_mfma_f32_16x16x32_bf16 v[96:99], v[40:43], v[136:139], v[96:99]
    buffer_load_dwordx4 v10, s[32:35], s11 offen offset:2048 sc1 lds
    s_waitcnt lgkmcnt(4)
    v_mfma_f32_16x16x32_bf16 v[96:99], v[44:47], v[140:143], v[96:99]
    ds_read_b64 v[56:57], v4 offset:2688
    v_mfma_f32_16x16x32_bf16 v[100:103], v[16:19], v[144:147], v[100:103]
    ds_read_b64 v[58:59], v4 offset:2696
    v_mfma_f32_16x16x32_bf16 v[100:103], v[20:23], v[148:151], v[100:103]
    v_mfma_f32_16x16x32_bf16 v[100:103], v[24:27], v[152:155], v[100:103]
    ds_read_b64 v[60:61], v4 offset:2752
    v_mfma_f32_16x16x32_bf16 v[100:103], v[28:31], v[156:159], v[100:103]
    s_add_u32 m0, s18, 61440
    s_add_u32 s11, s19, 61440
    buffer_load_dwordx4 v10, s[32:35], s11 offen offset:0 sc1 lds
    v_mfma_f32_16x16x32_bf16 v[100:103], v[32:35], v[160:163], v[100:103]
    ds_read_b64 v[62:63], v4 offset:2760
    v_mfma_f32_16x16x32_bf16 v[100:103], v[36:39], v[164:167], v[100:103]
    v_mfma_f32_16x16x32_bf16 v[100:103], v[40:43], v[168:171], v[100:103]
    ds_read_b64 v[64:65], v4 offset:2816
    v_mfma_f32_16x16x32_bf16 v[100:103], v[44:47], v[172:175], v[100:103]
    ds_read_b64 v[66:67], v4 offset:2824
    v_mfma_f32_16x16x32_bf16 v[104:107], v[16:19], v[176:179], v[104:107]
    buffer_load_dwordx4 v10, s[32:35], s11 offen offset:1024 sc1 lds
    v_mfma_f32_16x16x32_bf16 v[104:107], v[20:23], v[180:183], v[104:107]
    ds_read_b64 v[68:69], v4 offset:2880
    v_mfma_f32_16x16x32_bf16 v[104:107], v[24:27], v[184:187], v[104:107]
    v_mfma_f32_16x16x32_bf16 v[104:107], v[28:31], v[188:191], v[104:107]
    ds_read_b64 v[70:71], v4 offset:2888
    v_mfma_f32_16x16x32_bf16 v[104:107], v[32:35], v[192:195], v[104:107]
    v_mfma_f32_16x16x32_bf16 v[104:107], v[36:39], v[196:199], v[104:107]
    ds_read_b64 v[72:73], v4 offset:2944
    buffer_load_dwordx4 v10, s[32:35], s11 offen offset:2048 sc1 lds
    v_mfma_f32_16x16x32_bf16 v[104:107], v[40:43], v[200:203], v[104:107]
    ds_read_b64 v[74:75], v4 offset:2952
    v_mfma_f32_16x16x32_bf16 v[104:107], v[44:47], v[204:207], v[104:107]
    v_mfma_f32_16x16x32_bf16 v[108:111], v[16:19], v[208:211], 0
    ds_read_b64 v[76:77], v4 offset:3008
    v_mfma_f32_16x16x32_bf16 v[108:111], v[20:23], v[212:215], v[108:111]
    v_mfma_f32_16x16x32_bf16 v[108:111], v[24:27], v[216:219], v[108:111]
    ds_read_b64 v[78:79], v4 offset:3016
    s_add_u32 s11, s20, 0
    buffer_load_dwordx4 a[0:3], v10, s[40:43], s11 offen offset:0 sc1
    v_mfma_f32_16x16x32_bf16 v[108:111], v[28:31], v[220:223], v[108:111]
    v_mfma_f32_16x16x32_bf16 v[108:111], v[32:35], v[224:227], v[108:111]
    v_mfma_f32_16x16x32_bf16 v[108:111], v[36:39], v[228:231], v[108:111]
    v_mfma_f32_16x16x32_bf16 v[108:111], v[40:43], v[232:235], v[108:111]
    v_mfma_f32_16x16x32_bf16 v[108:111], v[44:47], v[236:239], v[108:111]
    s_add_u32 s11, s20, 0
    buffer_load_dwordx4 a[4:7], v10, s[40:43], s11 offen offset:1024 sc1
    s_waitcnt lgkmcnt(14)
    v_mfma_f32_16x16x32_bf16 v[100:103], v[48:51], v[112:115], v[100:103]
    ds_read_b64 v[16:17], v4 offset:3072
    s_waitcnt lgkmcnt(13)
    v_mfma_f32_16x16x32_bf16 v[100:103], v[52:55], v[116:119], v[100:103]
    ds_read_b64 v[18:19], v4 offset:3080
    ds_read_b128 v[208:211], v5 offset:1536
    s_waitcnt lgkmcnt(13)
    v_mfma_f32_16x16x32_bf16 v[100:103], v[56:59], v[120:123], v[100:103]
    ds_read_b64 v[20:21], v4 offset:3136
    s_waitcnt lgkmcnt(12)
    v_mfma_f32_16x16x32_bf16 v[100:103], v[60:63], v[124:127], v[100:103]
    ds_read_b64 v[22:23], v4 offset:3144
    ds_read_b128 v[212:215], v5 offset:1600
    s_waitcnt lgkmcnt(12)
    v_mfma_f32_16x16x32_bf16 v[100:103], v[64:67], v[128:131], v[100:103]
    s_add_u32 s11, s21, 0
    buffer_load_dwordx4 a[8:11], v10, s[40:43], s11 offen offset:0 sc1
    s_waitcnt lgkmcnt(10)
    v_mfma_f32_16x16x32_bf16 v[100:103], v[68:71], v[132:135], v[100:103]
    ds_read_b64 v[24:25], v4 offset:3200
    ds_read_b128 v[216:219], v5 offset:1664
    s_waitcnt lgkmcnt(10)
    v_mfma_f32_16x16x32_bf16 v[100:103], v[72:75], v[136:139], v[100:103]
    ds_read_b64 v[26:27], v4 offset:3208
    s_waitcnt lgkmcnt(9)
    v_mfma_f32_16x16x32_bf16 v[100:103], v[76:79], v[140:143], v[100:103]
    ds_read_b64 v[28:29], v4 offset:3264
    ds_read_b128 v[220:223], v5 offset:1728
    v_mfma_f32_16x16x32_bf16 v[104:107], v[48:51], v[144:147], v[104:107]
    ds_read_b64 v[30:31], v4 offset:3272
    v_mfma_f32_16x16x32_bf16 v[104:107], v[52:55], v[148:151], v[104:107]
    ds_read_b128 v[224:227], v5 offset:1792
    s_add_u32 s11, s21, 0
    buffer_load_dwordx4 a[12:15], v10, s[40:43], s11 offen offset:1024 sc1
    v_mfma_f32_16x16x32_bf16 v[104:107], v[56:59], v[152:155], v[104:107]
    ds_read_b64 v[32:33], v4 offset:3328
    v_mfma_f32_16x16x32_bf16 v[104:107], v[60:63], v[156:159], v[104:107]
    ds_read_b64 v[34:35], v4 offset:3336
    ds_read_b128 v[228:231], v5 offset:1856
    v_mfma_f32_16x16x32_bf16 v[104:107], v[64:67], v[160:163], v[104:107]
    ds_read_b64 v[36:37], v4 offset:3392
    v_mfma_f32_16x16x32_bf16 v[104:107], v[68:71], v[164:167], v[104:107]
    ds_read_b64 v[38:39], v4 offset:3400
    ds_read_b128 v[232:235], v5 offset:1920
    v_mfma_f32_16x16x32_bf16 v[104:107], v[72:75], v[168:171], v[104:107]
    s_add_u32 s11, s22, 0
    buffer_load_dwordx4 a[16:19], v10, s[40:43], s11 offen offset:0 sc1
    v_mfma_f32_16x16x32_bf16 v[104:107], v[76:79], v[172:175], v[104:107]
    ds_read_b64 v[40:41], v4 offset:3456
    ds_read_b128 v[236:239], v5 offset:1984
    v_mfma_f32_16x16x32_bf16 v[108:111], v[48:51], v[176:179], v[108:111]
    ds_read_b64 v[42:43], v4 offset:3464
    v_mfma_f32_16x16x32_bf16 v[108:111], v[52:55], v[180:183], v[108:111]
    ds_read_b64 v[44:45], v4 offset:3520
    v_mfma_f32_16x16x32_bf16 v[108:111], v[56:59], v[184:187], v[108:111]
    ds_read_b64 v[46:47], v4 offset:3528
    v_mfma_f32_16x16x32_bf16 v[108:111], v[60:63], v[188:191], v[108:111]
    s_add_u32 s11, s20, 5120
    buffer_load_dwordx4 a[20:23], v10, s[40:43], s11 offen offset:0 sc1
    v_mfma_f32_16x16x32_bf16 v[108:111], v[64:67], v[192:195], v[108:111]
    v_mfma_f32_16x16x32_bf16 v[108:111], v[68:71], v[196:199], v[108:111]
    v_mfma_f32_16x16x32_bf16 v[108:111], v[72:75], v[200:203], v[108:111]
    v_mfma_f32_16x16x32_bf16 v[108:111], v[76:79], v[204:207], v[108:111]
    s_waitcnt lgkmcnt(15)
    v_mfma_f32_16x16x32_bf16 v[104:107], v[16:19], v[112:115], v[104:107]
    ds_read_b64 v[48:49], v4 offset:3584
    ds_read_b64 v[50:51], v4 offset:3592
    v_lshlrev_b32 v11, 5, v2
    v_lshl_add_u32 v11, v3, 3, v11
    v_mfma_f32_16x16x32_bf16 v[104:107], v[20:23], v[116:119], v[104:107]
    ds_read_b64 v[52:53], v4 offset:3648
    ds_read_b128 v[176:179], v5 offset:1024
    s_mov_b32 exec_lo, 0xffffffff
    s_mov_b32 exec_hi, 0
    buffer_load_dwordx2 v[12:13], v8, s[44:47], s62 offen sc1
    s_mov_b64 exec, -1
    v_add_u32 v11, s61, v11
    v_mfma_f32_16x16x32_bf16 v[104:107], v[24:27], v[120:123], v[104:107]
    ds_read_b64 v[54:55], v4 offset:3656
    s_waitcnt lgkmcnt(15)
    v_mfma_f32_16x16x32_bf16 v[104:107], v[28:31], v[124:127], v[104:107]
    ds_read_b64 v[56:57], v4 offset:3712
    ds_read_b64 v[58:59], v4 offset:3720
    ds_read_b128 v[180:183], v5 offset:1088
    s_waitcnt lgkmcnt(15)
    v_mfma_f32_16x16x32_bf16 v[104:107], v[32:35], v[128:131], v[104:107]
    ds_read_b64 v[60:61], v4 offset:3776
    s_waitcnt lgkmcnt(15)
    v_mfma_f32_16x16x32_bf16 v[104:107], v[36:39], v[132:135], v[104:107]
    ds_read_b64 v[62:63], v4 offset:3784
    ds_read_b128 v[184:187], v5 offset:1152
    s_add_u32 s11, s20, 5120
    buffer_load_dwordx4 a[24:27], v10, s[40:43], s11 offen offset:1024 sc1
    s_waitcnt lgkmcnt(13)
    v_mfma_f32_16x16x32_bf16 v[104:107], v[40:43], v[136:139], v[104:107]
    ds_read_b64 v[64:65], v4 offset:3840
    ds_read_b64 v[66:67], v4 offset:3848
    s_waitcnt lgkmcnt(13)
    v_mfma_f32_16x16x32_bf16 v[104:107], v[44:47], v[140:143], v[104:107]
    ds_read_b64 v[68:69], v4 offset:3904
    ds_read_b128 v[188:191], v5 offset:1216
    v_mfma_f32_16x16x32_bf16 v[108:111], v[16:19], v[144:147], v[108:111]
    ds_read_b64 v[70:71], v4 offset:3912
    v_mfma_f32_16x16x32_bf16 v[108:111], v[20:23], v[148:151], v[108:111]
    ds_read_b64 v[72:73], v4 offset:3968
    ds_read_b64 v[74:75], v4 offset:3976
    ds_read_b128 v[192:195], v5 offset:1280
    v_mfma_f32_16x16x32_bf16 v[108:111], v[24:27], v[152:155], v[108:111]
    ds_read_b64 v[76:77], v4 offset:4032
    s_add_u32 s11, s21, 5120
    buffer_load_dwordx4 a[28:31], v10, s[40:43], s11 offen offset:0 sc1
    v_mfma_f32_16x16x32_bf16 v[108:111], v[28:31], v[156:159], v[108:111]
    ds_read_b64 v[78:79], v4 offset:4040
    ds_read_b128 v[196:199], v5 offset:1344
    v_mfma_f32_16x16x32_bf16 v[108:111], v[32:35], v[160:163], v[108:111]
    v_mfma_f32_16x16x32_bf16 v[108:111], v[36:39], v[164:167], v[108:111]
    ds_read_b128 v[200:203], v5 offset:1408
    v_mfma_f32_16x16x32_bf16 v[108:111], v[40:43], v[168:171], v[108:111]
    v_mfma_f32_16x16x32_bf16 v[108:111], v[44:47], v[172:175], v[108:111]
    ds_read_b128 v[204:207], v5 offset:1472
    s_add_u32 s11, s21, 5120
    buffer_load_dwordx4 a[32:35], v10, s[40:43], s11 offen offset:1024 sc1
    s_waitcnt lgkmcnt(15)
    v_mfma_f32_16x16x32_bf16 v[108:111], v[48:51], v[112:115], v[108:111]
    ds_read_b64 v[16:17], v4 offset:0
    ds_read_b64 v[18:19], v4 offset:8
    ds_read_b64 v[20:21], v4 offset:64
    ds_read_b64 v[22:23], v4 offset:72
    v_cvt_pk_bf16_f32 v80, v80, v81
    v_cvt_pk_bf16_f32 v81, v82, v83
    v_mfma_f32_16x16x32_bf16 v[108:111], v[52:55], v[116:119], v[108:111]
    ds_read_b64 v[24:25], v4 offset:128
    ds_read_b64 v[26:27], v4 offset:136
    ds_read_b64 v[28:29], v4 offset:192
    ds_read_b64 v[30:31], v4 offset:200
    ds_read_b128 v[144:147], v5 offset:512
    ds_write_b64 v11, v[80:81] offset:2112
    v_cvt_pk_bf16_f32 v84, v84, v85
    v_mfma_f32_16x16x32_bf16 v[108:111], v[56:59], v[120:123], v[108:111]
    ds_read_b64 v[32:33], v4 offset:256
    ds_read_b64 v[34:35], v4 offset:264
    ds_read_b64 v[36:37], v4 offset:320
    ds_read_b64 v[38:39], v4 offset:328
    v_cvt_pk_bf16_f32 v85, v86, v87
    ds_write_b64 v11, v[84:85] offset:2624
    s_waitcnt lgkmcnt(15)
    v_mfma_f32_16x16x32_bf16 v[108:111], v[60:63], v[124:127], v[108:111]
    ds_read_b64 v[40:41], v4 offset:384
    ds_read_b64 v[42:43], v4 offset:392
    ds_read_b64 v[44:45], v4 offset:448
    ds_read_b64 v[46:47], v4 offset:456
    ds_read_b128 v[148:151], v5 offset:576
    v_cvt_pk_bf16_f32 v88, v88, v89
    v_cvt_pk_bf16_f32 v89, v90, v91
    v_mfma_f32_16x16x32_bf16 v[108:111], v[64:67], v[128:131], v[108:111]
    s_add_u32 s11, s22, 5120
    buffer_load_dwordx4 a[36:39], v10, s[40:43], s11 offen offset:0 sc1
    ds_write_b64 v11, v[88:89] offset:3136
    v_cvt_pk_bf16_f32 v92, v92, v93
    v_mfma_f32_16x16x32_bf16 v[108:111], v[68:71], v[132:135], v[108:111]
    ds_read_b128 v[152:155], v5 offset:640
    v_cvt_pk_bf16_f32 v93, v94, v95
    ds_write_b64 v11, v[92:93] offset:3648
    v_mfma_f32_16x16x32_bf16 v[108:111], v[72:75], v[136:139], v[108:111]
    s_waitcnt lgkmcnt(0)
    s_barrier
    v_mfma_f32_16x16x32_bf16 v[108:111], v[76:79], v[140:143], v[108:111]
    ds_read_b128 v[156:159], v5 offset:704
    ds_read_b128 v[160:163], v5 offset:768
    ds_read_b128 v[164:167], v5 offset:832
    ds_read_b128 v[168:171], v5 offset:896
    ds_read_b128 v[172:175], v5 offset:960
    s_waitcnt vmcnt(4)
    v_mov_b32 v12, v12
    s_mov_b32 exec_lo, 0xffffffff
    s_mov_b32 exec_hi, 0
    v_cmp_eq_u64 vcc, s[100:101], v[12:13]
    s_nop 0
    s_cmp_eq_u64 vcc, exec
    s_mov_b64 exec, -1
    s_cbranch_scc1 interleave_layers__ssm_conv_h3__swiglu_ffn__prompt_kernel_ok7
    s_mov_b32 s23, 0
interleave_layers__ssm_conv_h3__swiglu_ffn__prompt_kernel_spin8:
    s_sleep 1
    s_mov_b32 exec_lo, 0xffffffff
    s_mov_b32 exec_hi, 0
    buffer_load_dwordx2 v[12:13], v8, s[44:47], s62 offen sc1
    s_mov_b64 exec, -1
    s_waitcnt vmcnt(0)
    s_add_u32 s23, s23, 1
    s_cmp_ge_u32 s23, 262144
    s_cbranch_scc1 interleave_layers__ssm_conv_h3__swiglu_ffn__prompt_kernel_ok7
    v_mov_b32 v12, v12
    s_mov_b32 exec_lo, 0xffffffff
    s_mov_b32 exec_hi, 0
    v_cmp_eq_u64 vcc, s[100:101], v[12:13]
    s_nop 0
    s_cmp_eq_u64 vcc, exec
    s_mov_b64 exec, -1
    s_cbranch_scc0 interleave_layers__ssm_conv_h3__swiglu_ffn__prompt_kernel_spin8
    s_nop 0
interleave_layers__ssm_conv_h3__swiglu_ffn__prompt_kernel_ok7:
    v_mfma_f32_16x16x32_bf16 v[96:99], v[16:19], v[208:211], v[96:99]
    v_mfma_f32_16x16x32_bf16 v[96:99], a[240:243], v[208:211], v[96:99]
    ds_read_b64 v[48:49], v4 offset:512
    v_bfe_u32 v8, v1, 2, 2
    v_mul_u32_u24 v8, 21248, v8
    v_mfma_f32_16x16x32_bf16 v[96:99], v[20:23], v[212:215], v[96:99]
    ds_read_b64 v[50:51], v4 offset:520
    ds_read_b128 v[112:115], v5 offset:0
    s_mov_b32 s13, 3145728
    buffer_load_dwordx2 v[240:241], v6, s[48:51], s13 offen offset:0 sc1
    v_and_b32 v9, 3, v1
    v_lshl_add_u32 v8, v9, 3, v8
    v_mfma_f32_16x16x32_bf16 v[96:99], v[24:27], v[216:219], v[96:99]
    v_lshl_add_u32 v8, v3, 5, v8
    s_lshl_b32 s10, s3, 9
    v_mfma_f32_16x16x32_bf16 v[96:99], v[28:31], v[220:223], v[96:99]
    ds_read_b64 v[52:53], v4 offset:576
    ds_read_b128 v[116:119], v5 offset:64
    s_add_u32 s12, s57, 46137344
    buffer_load_dwordx2 v[248:249], v7, s[48:51], s12 offen sc1
    s_add_u32 s10, s10, 78848
    v_add_u32 v8, s10, v8
    v_mfma_f32_16x16x32_bf16 v[96:99], v[32:35], v[224:227], v[96:99]
    v_and_b32 v0, 1, v3
    v_lshrrev_b32 v9, 1, v3
    v_mfma_f32_16x16x32_bf16 v[96:99], v[36:39], v[228:231], v[96:99]
    ds_read_b64 v[54:55], v4 offset:584
    ds_read_b128 v[120:123], v5 offset:128
    buffer_load_dwordx2 v[242:243], v6, s[48:51], s13 offen offset:512 sc1
    v_lshl_add_u32 v9, v0, 1, v9
    v_mul_u32_u24 v9, 40960, v9
    v_mfma_f32_16x16x32_bf16 v[96:99], v[40:43], v[232:235], v[96:99]
    v_lshl_add_u32 v9, v2, 4, v9
    v_mfma_f32_16x16x32_bf16 v[96:99], v[44:47], v[236:239], v[96:99]
    ds_read_b64 v[56:57], v4 offset:640
    ds_read_b128 v[124:127], v5 offset:192
    s_add_u32 s12, s57, 46219264
    buffer_load_dwordx2 v[250:251], v7, s[48:51], s12 offen sc1
    v_mfma_f32_16x16x32_bf16 v[100:103], v[16:19], v[176:179], v[100:103]
    v_mfma_f32_16x16x32_bf16 v[100:103], a[240:243], v[176:179], v[100:103]
    ds_read_b64 v[58:59], v4 offset:648
    v_mfma_f32_16x16x32_bf16 v[100:103], v[20:23], v[180:183], v[100:103]
    ds_read_b128 v[128:131], v5 offset:256
    buffer_load_dwordx2 v[244:245], v6, s[48:51], s13 offen offset:1024 sc1
    v_mfma_f32_16x16x32_bf16 v[100:103], v[24:27], v[184:187], v[100:103]
    ds_read_b64 v[60:61], v4 offset:704
    v_mfma_f32_16x16x32_bf16 v[100:103], v[28:31], v[188:191], v[100:103]
    ds_read_b128 v[132:135], v5 offset:320
    s_add_u32 s12, s57, 46301184
    buffer_load_dwordx2 v[252:253], v7, s[48:51], s12 offen sc1
    v_mfma_f32_16x16x32_bf16 v[100:103], v[32:35], v[192:195], v[100:103]
    ds_read_b64 v[62:63], v4 offset:712
    v_mfma_f32_16x16x32_bf16 v[100:103], v[36:39], v[196:199], v[100:103]
    ds_read_b128 v[136:139], v5 offset:384
    buffer_load_dwordx2 v[246:247], v6, s[48:51], s13 offen offset:1536 sc1
    v_mfma_f32_16x16x32_bf16 v[100:103], v[40:43], v[200:203], v[100:103]
    ds_read_b64 v[64:65], v4 offset:768
    v_mfma_f32_16x16x32_bf16 v[100:103], v[44:47], v[204:207], v[100:103]
    ds_read_b64 v[66:67], v4 offset:776
    ds_read_b128 v[140:143], v5 offset:448
    s_add_u32 s12, s57, 46383104
    buffer_load_dwordx2 v[254:255], v7, s[48:51], s12 offen sc1
    v_mfma_f32_16x16x32_bf16 v[104:107], v[16:19], v[144:147], v[104:107]
    v_mfma_f32_16x16x32_bf16 v[104:107], a[240:243], v[144:147], v[104:107]
    s_add_u32 s11, s20, 10240
    buffer_load_dwordx4 a[40:43], v10, s[40:43], s11 offen offset:0 sc1
    v_mfma_f32_16x16x32_bf16 v[104:107], v[20:23], v[148:151], v[104:107]
    ds_read_b64 v[68:69], v4 offset:832
    v_mfma_f32_16x16x32_bf16 v[104:107], v[24:27], v[152:155], v[104:107]
    s_waitcnt lgkmcnt(15)
    v_mfma_f32_16x16x32_bf16 v[104:107], v[28:31], v[156:159], v[104:107]
    ds_read_b64 v[70:71], v4 offset:840
    v_mfma_f32_16x16x32_bf16 v[104:107], v[32:35], v[160:163], v[104:107]
    v_mfma_f32_16x16x32_bf16 v[104:107], v[36:39], v[164:167], v[104:107]
    ds_read_b64 v[72:73], v4 offset:896
    s_add_u32 s11, s20, 10240
    buffer_load_dwordx4 a[44:47], v10, s[40:43], s11 offen offset:1024 sc1
    v_mfma_f32_16x16x32_bf16 v[104:107], v[40:43], v[168:171], v[104:107]
    ds_read_b64 v[74:75], v4 offset:904
    v_mfma_f32_16x16x32_bf16 v[104:107], v[44:47], v[172:175], v[104:107]
    v_mfma_f32_16x16x32_bf16 v[108:111], v[16:19], v[112:115], v[108:111]
    v_mfma_f32_16x16x32_bf16 v[108:111], a[240:243], v[112:115], v[108:111]
    ds_read_b64 v[76:77], v4 offset:960
    s_waitcnt lgkmcnt(15)
    v_mfma_f32_16x16x32_bf16 v[108:111], v[20:23], v[116:119], v[108:111]
    v_mfma_f32_16x16x32_bf16 v[108:111], v[24:27], v[120:123], v[108:111]
    ds_read_b64 v[78:79], v4 offset:968
    s_add_u32 s11, s21, 10240
    buffer_load_dwordx4 a[48:51], v10, s[40:43], s11 offen offset:0 sc1
    s_waitcnt lgkmcnt(15)
    v_mfma_f32_16x16x32_bf16 v[108:111], v[28:31], v[124:127], v[108:111]
    s_waitcnt lgkmcnt(13)
    v_mfma_f32_16x16x32_bf16 v[108:111], v[32:35], v[128:131], v[108:111]
    s_waitcnt lgkmcnt(11)
    v_mfma_f32_16x16x32_bf16 v[108:111], v[36:39], v[132:135], v[108:111]
    s_waitcnt lgkmcnt(9)
    v_mfma_f32_16x16x32_bf16 v[108:111], v[40:43], v[136:139], v[108:111]
    s_waitcnt lgkmcnt(6)
    v_mfma_f32_16x16x32_bf16 v[108:111], v[44:47], v[140:143], v[108:111]
    s_add_u32 s11, s21, 10240
    buffer_load_dwordx4 a[52:55], v10, s[40:43], s11 offen offset:1024 sc1
    v_mfma_f32_16x16x32_bf16 v[100:103], v[48:51], v[208:211], v[100:103]
    ds_read_b64 v[16:17], v4 offset:1024
    ds_read_b64_tr_b16 v[80:81], v8 offset:2112
    ds_read_b64_tr_b16 v[82:83], v8 offset:2240
    v_mfma_f32_16x16x32_bf16 v[100:103], v[52:55], v[212:215], v[100:103]
    ds_read_b64 v[18:19], v4 offset:1032
    s_mov_b32 s13, 3153920
    buffer_load_dwordx2 v[120:121], v6, s[48:51], s13 offen offset:0 sc1
    ds_read_b64_tr_b16 v[84:85], v8 offset:2368
    ds_read_b64_tr_b16 v[86:87], v8 offset:2496
    v_mfma_f32_16x16x32_bf16 v[100:103], v[56:59], v[216:219], v[100:103]
    ds_read_b64 v[20:21], v4 offset:1088
    s_waitcnt vmcnt(11)
    v_lshlrev_b32 v130, 16, v248
    v_and_b32 v131, 0xffff0000, v248
    v_mfma_f32_16x16x32_bf16 v[100:103], v[60:63], v[220:223], v[100:103]
    ds_read_b64 v[22:23], v4 offset:1096
    s_add_u32 s12, s57, 47448064
    buffer_load_dwordx2 v[112:113], v7, s[48:51], s12 offen sc1
    s_waitcnt lgkmcnt(6)
    v_lshlrev_b32 v128, 16, v80
    v_and_b32 v129, 0xffff0000, v80
    v_mfma_f32_16x16x32_bf16 v[100:103], v[64:67], v[224:227], v[100:103]
    v_fma_f32 v132, v130, v241, -v240
    v_fma_f32 v133, v131, v241, -v240
    v_mfma_f32_16x16x32_bf16 v[100:103], v[68:71], v[228:231], v[100:103]
    ds_read_b64 v[24:25], v4 offset:1152
    buffer_load_dwordx2 v[122:123], v6, s[48:51], s13 offen offset:512 sc1
    v_fmac_f32 v130, v132, v128
    v_fmac_f32 v131, v133, v129
    v_mfma_f32_16x16x32_bf16 v[100:103], v[72:75], v[232:235], v[100:103]
    ds_read_b64 v[26:27], v4 offset:1160
    v_cvt_pk_bf16_f32 v88, v130, v131
    v_lshlrev_b32 v130, 16, v249
    v_mfma_f32_16x16x32_bf16 v[100:103], v[76:79], v[236:239], v[100:103]
    ds_read_b64 v[28:29], v4 offset:1216
    s_add_u32 s12, s57, 47529984
    buffer_load_dwordx2 v[114:115], v7, s[48:51], s12 offen sc1
    v_and_b32 v131, 0xffff0000, v249
    v_lshlrev_b32 v128, 16, v81
    v_mfma_f32_16x16x32_bf16 v[104:107], v[48:51], v[176:179], v[104:107]
    ds_read_b64 v[30:31], v4 offset:1224
    v_and_b32 v129, 0xffff0000, v81
    v_fma_f32 v132, v130, v241, -v240
    v_mfma_f32_16x16x32_bf16 v[104:107], v[52:55], v[180:183], v[104:107]
    buffer_load_dwordx2 v[124:125], v6, s[48:51], s13 offen offset:1024 sc1
    v_fma_f32 v133, v131, v241, -v240
    v_fmac_f32 v130, v132, v128
    v_mfma_f32_16x16x32_bf16 v[104:107], v[56:59], v[184:187], v[104:107]
    ds_read_b64 v[32:33], v4 offset:1280
    v_fmac_f32 v131, v133, v129
    v_cvt_pk_bf16_f32 v89, v130, v131
    v_mfma_f32_16x16x32_bf16 v[104:107], v[60:63], v[188:191], v[104:107]
    ds_read_b64 v[34:35], v4 offset:1288
    s_add_u32 s12, s57, 47611904
    buffer_load_dwordx2 v[116:117], v7, s[48:51], s12 offen sc1
    s_waitcnt vmcnt(14)
    v_lshlrev_b32 v130, 16, v250
    v_and_b32 v131, 0xffff0000, v250
    v_mfma_f32_16x16x32_bf16 v[104:107], v[64:67], v[192:195], v[104:107]
    ds_read_b64 v[36:37], v4 offset:1344
    s_waitcnt lgkmcnt(12)
    v_lshlrev_b32 v128, 16, v82
    v_and_b32 v129, 0xffff0000, v82
    v_mfma_f32_16x16x32_bf16 v[104:107], v[68:71], v[196:199], v[104:107]
    ds_read_b64 v[38:39], v4 offset:1352
    buffer_load_dwordx2 v[126:127], v6, s[48:51], s13 offen offset:1536 sc1
    v_fma_f32 v132, v130, v243, -v242
    v_fma_f32 v133, v131, v243, -v242
    v_mfma_f32_16x16x32_bf16 v[104:107], v[72:75], v[200:203], v[104:107]
    v_fmac_f32 v130, v132, v128
    v_fmac_f32 v131, v133, v129
    v_mfma_f32_16x16x32_bf16 v[104:107], v[76:79], v[204:207], v[104:107]
    ds_read_b64 v[40:41], v4 offset:1408
    s_add_u32 s12, s57, 47693824
    buffer_load_dwordx2 v[118:119], v7, s[48:51], s12 offen sc1
    v_cvt_pk_bf16_f32 v90, v130, v131
    v_lshlrev_b32 v130, 16, v251
    v_mfma_f32_16x16x32_bf16 v[108:111], v[48:51], v[144:147], v[108:111]
    ds_read_b64 v[42:43], v4 offset:1416
    v_and_b32 v131, 0xffff0000, v251
    v_lshlrev_b32 v128, 16, v83
    v_mfma_f32_16x16x32_bf16 v[108:111], v[52:55], v[148:151], v[108:111]
    ds_read_b64 v[44:45], v4 offset:1472
    v_and_b32 v129, 0xffff0000, v83
    v_fma_f32 v132, v130, v243, -v242
    v_mfma_f32_16x16x32_bf16 v[108:111], v[56:59], v[152:155], v[108:111]
    ds_read_b64 v[46:47], v4 offset:1480
    v_fma_f32 v133, v131, v243, -v242
    v_fmac_f32 v130, v132, v128
    v_mfma_f32_16x16x32_bf16 v[108:111], v[60:63], v[156:159], v[108:111]
    v_fmac_f32 v131, v133, v129
    v_cvt_pk_bf16_f32 v91, v130, v131
    v_mfma_f32_16x16x32_bf16 v[108:111], v[64:67], v[160:163], v[108:111]
    v_permlane16_swap_b32 v80, v82
    v_permlane16_swap_b32 v81, v83
    v_mfma_f32_16x16x32_bf16 v[108:111], v[68:71], v[164:167], v[108:111]
    s_add_u32 s12, s58, 12582912
    buffer_store_dwordx4 v[80:83], v9, s[48:51], s12 offen sc1
    v_permlane16_swap_b32 v88, v90
    v_mfma_f32_16x16x32_bf16 v[108:111], v[72:75], v[168:171], v[108:111]
    v_permlane16_swap_b32 v89, v91
    s_add_u32 s12, s58, 15728640
    buffer_store_dwordx4 v[88:91], v9, s[48:51], s12 offen sc1
    v_mfma_f32_16x16x32_bf16 v[108:111], v[76:79], v[172:175], v[108:111]
    s_waitcnt vmcnt(16)
    v_lshlrev_b32 v130, 16, v252
    v_and_b32 v131, 0xffff0000, v252
    s_waitcnt lgkmcnt(15)
    v_mfma_f32_16x16x32_bf16 v[104:107], v[16:19], v[208:211], v[104:107]
    ds_read_b64 v[48:49], v4 offset:1536
    ds_read_b64 v[50:51], v4 offset:1544
    v_lshlrev_b32 v128, 16, v84
    v_and_b32 v129, 0xffff0000, v84
    s_waitcnt lgkmcnt(14)
    v_mfma_f32_16x16x32_bf16 v[104:107], v[20:23], v[212:215], v[104:107]
    ds_read_b64 v[52:53], v4 offset:1600
    v_fma_f32 v132, v130, v245, -v244
    v_fma_f32 v133, v131, v245, -v244
    s_waitcnt lgkmcnt(13)
    v_mfma_f32_16x16x32_bf16 v[104:107], v[24:27], v[216:219], v[104:107]
    ds_read_b64 v[54:55], v4 offset:1608
    v_fmac_f32 v130, v132, v128
    v_fmac_f32 v131, v133, v129
    s_waitcnt lgkmcnt(12)
    v_mfma_f32_16x16x32_bf16 v[104:107], v[28:31], v[220:223], v[104:107]
    ds_read_b64 v[56:57], v4 offset:1664
    ds_read_b64 v[58:59], v4 offset:1672
    v_cvt_pk_bf16_f32 v92, v130, v131
    v_lshlrev_b32 v130, 16, v253
    s_waitcnt lgkmcnt(12)
    v_mfma_f32_16x16x32_bf16 v[104:107], v[32:35], v[224:227], v[104:107]
    ds_read_b64 v[60:61], v4 offset:1728
    v_and_b32 v131, 0xffff0000, v253
    v_lshlrev_b32 v128, 16, v85
    s_waitcnt lgkmcnt(11)
    v_mfma_f32_16x16x32_bf16 v[104:107], v[36:39], v[228:231], v[104:107]
    ds_read_b64 v[62:63], v4 offset:1736
    v_and_b32 v129, 0xffff0000, v85
    v_fma_f32 v132, v130, v245, -v244
    s_waitcnt lgkmcnt(10)
    v_mfma_f32_16x16x32_bf16 v[104:107], v[40:43], v[232:235], v[104:107]
    ds_read_b64 v[64:65], v4 offset:1792
    ds_read_b64 v[66:67], v4 offset:1800
    v_fma_f32 v133, v131, v245, -v244
    v_fmac_f32 v130, v132, v128
    s_waitcnt lgkmcnt(10)
    v_mfma_f32_16x16x32_bf16 v[104:107], v[44:47], v[236:239], v[104:107]
    ds_read_b64 v[68:69], v4 offset:1856
    v_fmac_f32 v131, v133, v129
    v_cvt_pk_bf16_f32 v93, v130, v131
    v_mfma_f32_16x16x32_bf16 v[108:111], v[16:19], v[176:179], v[108:111]
    ds_read_b64 v[70:71], v4 offset:1864
    s_waitcnt vmcnt(14)
    v_lshlrev_b32 v130, 16, v254
    v_and_b32 v131, 0xffff0000, v254
    v_mfma_f32_16x16x32_bf16 v[108:111], v[20:23], v[180:183], v[108:111]
    ds_read_b64 v[72:73], v4 offset:1920
    ds_read_b64 v[74:75], v4 offset:1928
    v_lshlrev_b32 v128, 16, v86
    v_and_b32 v129, 0xffff0000, v86
    v_mfma_f32_16x16x32_bf16 v[108:111], v[24:27], v[184:187], v[108:111]
    ds_read_b64 v[76:77], v4 offset:1984
    v_fma_f32 v132, v130, v247, -v246
    v_fma_f32 v133, v131, v247, -v246
    v_mfma_f32_16x16x32_bf16 v[108:111], v[28:31], v[188:191], v[108:111]
    ds_read_b64 v[78:79], v4 offset:1992
    v_fmac_f32 v130, v132, v128
    v_fmac_f32 v131, v133, v129
    v_mfma_f32_16x16x32_bf16 v[108:111], v[32:35], v[192:195], v[108:111]
    v_cvt_pk_bf16_f32 v94, v130, v131
    v_lshlrev_b32 v130, 16, v255
    v_mfma_f32_16x16x32_bf16 v[108:111], v[36:39], v[196:199], v[108:111]
    v_and_b32 v131, 0xffff0000, v255
    v_lshlrev_b32 v128, 16, v87
    v_mfma_f32_16x16x32_bf16 v[108:111], v[40:43], v[200:203], v[108:111]
    v_and_b32 v129, 0xffff0000, v87
    v_fma_f32 v132, v130, v247, -v246
    v_mfma_f32_16x16x32_bf16 v[108:111], v[44:47], v[204:207], v[108:111]
    v_fma_f32 v133, v131, v247, -v246
    v_fmac_f32 v130, v132, v128
    s_waitcnt lgkmcnt(14)
    v_mfma_f32_16x16x32_bf16 v[108:111], v[48:51], v[208:211], v[108:111]
    v_fmac_f32 v131, v133, v129
    v_cvt_pk_bf16_f32 v95, v130, v131
    s_waitcnt lgkmcnt(12)
    v_mfma_f32_16x16x32_bf16 v[108:111], v[52:55], v[212:215], v[108:111]
    v_permlane16_swap_b32 v84, v86
    v_permlane16_swap_b32 v85, v87
    s_waitcnt lgkmcnt(10)
    v_mfma_f32_16x16x32_bf16 v[108:111], v[56:59], v[216:219], v[108:111]
    s_add_u32 s12, s58, 12746752
    buffer_store_dwordx4 v[84:87], v9, s[48:51], s12 offen sc1
    v_permlane16_swap_b32 v92, v94
    s_waitcnt lgkmcnt(8)
    v_mfma_f32_16x16x32_bf16 v[108:111], v[60:63], v[220:223], v[108:111]
    v_permlane16_swap_b32 v93, v95
    s_add_u32 s12, s58, 15892480
    buffer_store_dwordx4 v[92:95], v9, s[48:51], s12 offen sc1
    s_waitcnt lgkmcnt(6)
    v_mfma_f32_16x16x32_bf16 v[108:111], v[64:67], v[224:227], v[108:111]
    v_cvt_pk_bf16_f32 v96, v96, v97
    v_cvt_pk_bf16_f32 v97, v98, v99
    s_waitcnt lgkmcnt(4)
    v_mfma_f32_16x16x32_bf16 v[108:111], v[68:71], v[228:231], v[108:111]
    ds_write_b64 v11, v[96:97] offset:6272
    v_cvt_pk_bf16_f32 v100, v100, v101
    s_waitcnt lgkmcnt(3)
    v_mfma_f32_16x16x32_bf16 v[108:111], v[72:75], v[232:235], v[108:111]
    v_cvt_pk_bf16_f32 v101, v102, v103
    ds_write_b64 v11, v[100:101] offset:6784
    s_waitcnt lgkmcnt(2)
    v_mfma_f32_16x16x32_bf16 v[108:111], v[76:79], v[236:239], v[108:111]
    v_cvt_pk_bf16_f32 v104, v104, v105
    v_cvt_pk_bf16_f32 v105, v106, v107
    s_nop 5
    v_cvt_pk_bf16_f32 v108, v108, v109
    v_cvt_pk_bf16_f32 v109, v110, v111
    ds_write_b64 v11, v[108:109] offset:7808
    ds_write_b64 v11, v[104:105] offset:7296
    s_waitcnt lgkmcnt(0)
    s_barrier
    ds_read_b64_tr_b16 v[16:17], v8 offset:6272
    ds_read_b64_tr_b16 v[18:19], v8 offset:6400
    ds_read_b64_tr_b16 v[20:21], v8 offset:6528
    ds_read_b64_tr_b16 v[22:23], v8 offset:6656
    s_waitcnt vmcnt(10)
    v_lshlrev_b32 v34, 16, v112
    v_and_b32 v35, 0xffff0000, v112
    s_waitcnt lgkmcnt(3)
    v_lshlrev_b32 v32, 16, v16
    v_and_b32 v33, 0xffff0000, v16
    v_fma_f32 v36, v34, v121, -v120
    v_fma_f32 v37, v35, v121, -v120
    v_fmac_f32 v34, v36, v32
    v_fmac_f32 v35, v37, v33
    v_cvt_pk_bf16_f32 v24, v34, v35
    v_lshlrev_b32 v34, 16, v113
    v_and_b32 v35, 0xffff0000, v113
    v_lshlrev_b32 v32, 16, v17
    v_and_b32 v33, 0xffff0000, v17
    v_fma_f32 v36, v34, v121, -v120
    v_fma_f32 v37, v35, v121, -v120
    v_fmac_f32 v34, v36, v32
    v_fmac_f32 v35, v37, v33
    v_cvt_pk_bf16_f32 v25, v34, v35
    s_waitcnt vmcnt(8)
    v_lshlrev_b32 v34, 16, v114
    v_and_b32 v35, 0xffff0000, v114
    s_waitcnt lgkmcnt(2)
    v_lshlrev_b32 v32, 16, v18
    v_and_b32 v33, 0xffff0000, v18
    v_fma_f32 v36, v34, v123, -v122
    v_fma_f32 v37, v35, v123, -v122
    v_fmac_f32 v34, v36, v32
    v_fmac_f32 v35, v37, v33
    v_cvt_pk_bf16_f32 v26, v34, v35
    v_lshlrev_b32 v34, 16, v115
    v_and_b32 v35, 0xffff0000, v115
    v_lshlrev_b32 v32, 16, v19
    v_and_b32 v33, 0xffff0000, v19
    v_fma_f32 v36, v34, v123, -v122
    v_fma_f32 v37, v35, v123, -v122
    v_fmac_f32 v34, v36, v32
    v_fmac_f32 v35, v37, v33
    v_cvt_pk_bf16_f32 v27, v34, v35
    v_permlane16_swap_b32 v16, v18
    v_permlane16_swap_b32 v17, v19
    s_add_u32 s12, s58, 13893632
    buffer_store_dwordx4 v[16:19], v9, s[48:51], s12 offen sc1
    v_permlane16_swap_b32 v24, v26
    v_permlane16_swap_b32 v25, v27
    s_add_u32 s12, s58, 17039360
    buffer_store_dwordx4 v[24:27], v9, s[48:51], s12 offen sc1
    s_waitcnt vmcnt(8)
    v_lshlrev_b32 v34, 16, v116
    v_and_b32 v35, 0xffff0000, v116
    s_waitcnt lgkmcnt(1)
    v_lshlrev_b32 v32, 16, v20
    v_and_b32 v33, 0xffff0000, v20
    v_fma_f32 v36, v34, v125, -v124
    v_fma_f32 v37, v35, v125, -v124
    v_fmac_f32 v34, v36, v32
    v_fmac_f32 v35, v37, v33
    v_cvt_pk_bf16_f32 v28, v34, v35
    v_lshlrev_b32 v34, 16, v117
    v_and_b32 v35, 0xffff0000, v117
    v_lshlrev_b32 v32, 16, v21
    v_and_b32 v33, 0xffff0000, v21
    v_fma_f32 v36, v34, v125, -v124
    v_fma_f32 v37, v35, v125, -v124
    v_fmac_f32 v34, v36, v32
    v_fmac_f32 v35, v37, v33
    v_cvt_pk_bf16_f32 v29, v34, v35
    s_waitcnt vmcnt(6)
    v_lshlrev_b32 v34, 16, v118
    v_and_b32 v35, 0xffff0000, v118
    s_waitcnt lgkmcnt(0)
    v_lshlrev_b32 v32, 16, v22
    v_and_b32 v33, 0xffff0000, v22
    v_fma_f32 v36, v34, v127, -v126
    v_fma_f32 v37, v35, v127, -v126
    v_fmac_f32 v34, v36, v32
    v_fmac_f32 v35, v37, v33
    v_cvt_pk_bf16_f32 v30, v34, v35
    v_lshlrev_b32 v34, 16, v119
    v_and_b32 v35, 0xffff0000, v119
    v_lshlrev_b32 v32, 16, v23
    v_and_b32 v33, 0xffff0000, v23
    v_fma_f32 v36, v34, v127, -v126
    v_fma_f32 v37, v35, v127, -v126
    v_fmac_f32 v34, v36, v32
    v_fmac_f32 v35, v37, v33
    v_cvt_pk_bf16_f32 v31, v34, v35
    v_permlane16_swap_b32 v20, v22
    v_permlane16_swap_b32 v21, v23
    s_add_u32 s12, s58, 14057472
    buffer_store_dwordx4 v[20:23], v9, s[48:51], s12 offen sc1
    v_permlane16_swap_b32 v28, v30
    v_permlane16_swap_b32 v29, v31
    s_add_u32 s12, s58, 17203200
    buffer_store_dwordx4 v[28:31], v9, s[48:51], s12 offen sc1
    s_waitcnt vmcnt(4)
    s_mov_b64 exec, 0x1
    buffer_store_dwordx2 v[14:15], v1, s[44:47], s59 offen sc1
    s_mov_b64 exec, -1
    s_add_u32 s59, s59, 81920
    s_add_u32 s11, s22, 10240
    buffer_load_dwordx4 a[56:59], v10, s[40:43], s11 offen offset:0 sc1
    s_add_u32 s11, s20, 15360
    buffer_load_dwordx4 a[60:63], v10, s[40:43], s11 offen offset:0 sc1
    s_add_u32 s11, s20, 15360
    buffer_load_dwordx4 a[64:67], v10, s[40:43], s11 offen offset:1024 sc1
    s_add_u32 s11, s21, 15360
    buffer_load_dwordx4 a[68:71], v10, s[40:43], s11 offen offset:0 sc1
    s_add_u32 s11, s21, 15360
    buffer_load_dwordx4 a[72:75], v10, s[40:43], s11 offen offset:1024 sc1
    s_add_u32 s11, s22, 15360
    buffer_load_dwordx4 a[76:79], v10, s[40:43], s11 offen offset:0 sc1
    s_add_u32 s11, s20, 20480
    buffer_load_dwordx4 a[80:83], v10, s[40:43], s11 offen offset:0 sc1
    s_add_u32 s11, s20, 20480
    buffer_load_dwordx4 a[84:87], v10, s[40:43], s11 offen offset:1024 sc1
    s_add_u32 s11, s21, 20480
    buffer_load_dwordx4 a[88:91], v10, s[40:43], s11 offen offset:0 sc1
    s_add_u32 s11, s21, 20480
    buffer_load_dwordx4 a[92:95], v10, s[40:43], s11 offen offset:1024 sc1
    s_add_u32 s11, s22, 20480
    buffer_load_dwordx4 a[96:99], v10, s[40:43], s11 offen offset:0 sc1
    s_add_u32 s11, s20, 25600
    buffer_load_dwordx4 a[100:103], v10, s[40:43], s11 offen offset:0 sc1
    s_waitcnt vmcnt(13)
    s_mov_b64 exec, 0x1
    buffer_store_dwordx2 v[14:15], v1, s[44:47], s59 offen sc1
    s_mov_b64 exec, -1
    s_add_u32 s11, s20, 25600
    buffer_load_dwordx4 a[104:107], v10, s[40:43], s11 offen offset:1024 sc1
    s_add_u32 s11, s21, 25600
    buffer_load_dwordx4 a[108:111], v10, s[40:43], s11 offen offset:0 sc1
    s_add_u32 s11, s21, 25600
    buffer_load_dwordx4 a[112:115], v10, s[40:43], s11 offen offset:1024 sc1
    s_add_u32 s11, s22, 25600
    buffer_load_dwordx4 a[116:119], v10, s[40:43], s11 offen offset:0 sc1
    s_add_u32 s11, s20, 30720
    buffer_load_dwordx4 a[120:123], v10, s[40:43], s11 offen offset:0 sc1
    s_add_u32 s11, s20, 30720
    buffer_load_dwordx4 a[124:127], v10, s[40:43], s11 offen offset:1024 sc1
    s_branch main_join
main_prep:
    s_or_b32 s10, s2, s3
    s_cmp_lg_u32 s10, 0
    s_cbranch_scc1 main_nonce_done
    s_memrealtime s[56:57]
    s_waitcnt lgkmcnt(0)
    s_or_b32 s56, s56, 1
    v_mov_b32 v12, s56
    v_mov_b32 v13, s57
    s_mov_b64 exec, 0x1
    buffer_store_dwordx2 v[12:13], v1, s[52:55], 0 offen sc1
    s_mov_b64 exec, -1
main_nonce_done:
    s_and_b32 s10, s2, 1
    s_lshl_b32 s10, s10, 3
    s_add_u32 s10, s10, 56
    s_cmp_lt_u32 s2, 64
    s_cselect_b32 s10, s10, 72
    s_load_dwordx2 s[28:29], s[0:1], s10
    s_mov_b32 s30, 1966080
    s_mov_b32 s31, 0x00020000
    v_mov_b32 v14, 0x80000000
    s_mov_b32 s58, 0x05040100
    s_mov_b32 s59, 0x07060302
    v_mov_b32 v12, 0x3f803f80
    s_and_b32 s4, s2, 6
    s_lshr_b32 s10, s2, 7
    s_add_u32 s4, s4, s10
    s_bfe_u32 s5, s2, 0x40003
    s_and_b32 s10, s2, 1
    s_lshl_b32 s10, s10, 4
    s_add_u32 s5, s5, s10
    s_and_b32 s7, s5, 3
    s_lshr_b32 s8, s5, 2
    s_and_b32 s9, s3, 1
    s_lshr_b32 s14, s3, 1
    s_lshl_b32 s6, s4, 4
    s_lshl_b32 s10, s3, 1
    s_add_u32 s15, s6, s10
    s_lshl_b32 s10, s7, 1
    s_add_u32 s16, s6, s10
    s_add_u32 s16, s16, s9
    s_mul_i32 s17, s15, 20480
    s_mul_i32 s18, s3, 3072
    s_mul_i32 s19, s5, 122880
    s_add_u32 s19, s19, s18
    s_lshl_b32 s10, s8, 2
    s_add_u32 s10, s10, s3
    s_mul_i32 s10, s10, 61440
    s_lshl_b32 s11, s14, 11
    s_add_u32 s20, s10, s11
    s_xor_b32 s11, s11, 2048
    s_add_u32 s21, s10, s11
    s_add_u32 s22, s10, 4096
    s_waitcnt lgkmcnt(0)
    s_mov_b32 s48, s24
    s_mov_b32 s49, s25
    s_mov_b32 s50, 50331648
    s_mov_b32 s51, 0x00020000
    s_add_u32 s32, s24, 4194304
    s_addc_u32 s33, s25, 0
    s_mov_b32 s34, 3932160
    s_mov_b32 s35, 0x00020000
    s_add_u32 s40, s24, 9437184
    s_addc_u32 s41, s25, 0
    s_mov_b32 s42, 1966080
    s_mov_b32 s43, 0x00020000
    s_add_u32 s44, s24, 41943040
    s_addc_u32 s45, s25, 0
    s_mov_b32 s46, 1540096
    s_mov_b32 s47, 0x00020000
    v_mov_b32 v244, 0
    s_cmp_ge_u32 s2, 64
    s_cbranch_scc1 main_prep_wd
    v_add_u32 v8, 0, v0
    v_mul_u32_u24 v4, 2731, v8
    v_lshrrev_b32 v4, 16, v4
    v_mul_u32_u24 v5, 24, v4
    v_sub_u32 v5, v8, v5
    v_add_u32 v8, 256, v0
    v_mul_u32_u24 v6, 2731, v8
    v_lshrrev_b32 v6, 16, v6
    v_mul_u32_u24 v7, 24, v6
    v_sub_u32 v7, v8, v7
    s_bfe_u32 s60, s2, 0x30001
    s_lshr_b32 s61, s2, 4
    s_mul_i32 s10, s61, 491520
    s_mul_i32 s11, s60, 384
    s_add_u32 s10, s10, s11
    v_mul_u32_u24 v8, 24576, v4
    v_lshl_add_u32 v8, v5, 4, v8
    v_mul_u32_u24 v9, 24576, v6
    v_lshl_add_u32 v9, v7, 4, v9
    v_cmp_gt_u32 vcc, 224, v0
    s_nop 1
    v_cndmask_b32 v9, v14, v9, vcc
    s_mov_b32 s11, s10
    buffer_load_dwordx4 v[16:19], v8, s[28:31], s11 offen
    s_add_u32 s11, s11, 3072
    buffer_load_dwordx4 v[20:23], v8, s[28:31], s11 offen
    s_add_u32 s11, s11, 3072
    buffer_load_dwordx4 v[24:27], v8, s[28:31], s11 offen
    s_add_u32 s11, s11, 3072
    buffer_load_dwordx4 v[28:31], v8, s[28:31], s11 offen
    s_add_u32 s11, s11, 3072
    buffer_load_dwordx4 v[32:35], v8, s[28:31], s11 offen
    s_add_u32 s11, s11, 3072
    buffer_load_dwordx4 v[36:39], v8, s[28:31], s11 offen
    s_add_u32 s11, s11, 3072
    buffer_load_dwordx4 v[40:43], v8, s[28:31], s11 offen
    s_add_u32 s11, s11, 3072
    buffer_load_dwordx4 v[44:47], v8, s[28:31], s11 offen
    s_mov_b32 s11, s10
    buffer_load_dwordx4 v[48:51], v9, s[28:31], s11 offen
    s_add_u32 s11, s11, 3072
    buffer_load_dwordx4 v[52:55], v9, s[28:31], s11 offen
    s_add_u32 s11, s11, 3072
    buffer_load_dwordx4 v[56:59], v9, s[28:31], s11 offen
    s_add_u32 s11, s11, 3072
    buffer_load_dwordx4 v[60:63], v9, s[28:31], s11 offen
    s_add_u32 s11, s11, 3072
    buffer_load_dwordx4 v[64:67], v9, s[28:31], s11 offen
    s_add_u32 s11, s11, 3072
    buffer_load_dwordx4 v[68:71], v9, s[28:31], s11 offen
    s_add_u32 s11, s11, 3072
    buffer_load_dwordx4 v[72:75], v9, s[28:31], s11 offen
    s_add_u32 s11, s11, 3072
    buffer_load_dwordx4 v[76:79], v9, s[28:31], s11 offen
    s_mov_b64 exec, 0x1
    buffer_load_dwordx2 v[246:247], v1, s[52:55], 0 offen sc1
    s_mov_b64 exec, -1
    v_mov_b32 v240, 0
    v_mov_b32 v241, 0
    v_mov_b32 v242, 0
    v_mov_b32 v243, 0
    s_add_u32 s36, s24, 41943040
    s_addc_u32 s37, s25, 0
    s_mov_b32 s38, 589824
    s_mov_b32 s39, 0x00020000
    s_lshl_b32 s12, s2, 13
    v_lshlrev_b32 v204, 4, v0
    buffer_store_dwordx4 v[240:243], v204, s[36:39], s12 offen sc1
    s_add_u32 s12, s12, 4096
    buffer_store_dwordx4 v[240:243], v204, s[36:39], s12 offen sc1
    s_add_u32 s12, s12, 4096
    v_mul_u32_u24 v161, 43, v5
    v_lshrrev_b32 v161, 8, v161
    v_mul_u32_u24 v162, 6, v161
    v_sub_u32 v5, v5, v162
    v_lshrrev_b32 v160, 2, v4
    v_mul_u32_u24 v160, 3072, v160
    v_and_b32 v162, 3, v4
    v_lshl_add_u32 v160, v162, 8, v160
    v_mul_u32_u24 v161, 15360, v161
    v_add_u32 v160, v160, v161
    v_lshrrev_b32 v161, 2, v5
    v_mul_u32_u24 v161, 2048, v161
    v_add_u32 v160, v160, v161
    v_and_b32 v161, 3, v5
    v_lshlrev_b32 v162, 6, v161
    v_lshlrev_b32 v163, 7, v161
    v_cmp_gt_u32 vcc, 4, v5
    s_nop 1
    v_cndmask_b32 v162, v163, v162, vcc
    v_add_u32 v4, v160, v162
    v_mov_b32 v162, 64
    v_mov_b32 v163, 1024
    v_cndmask_b32 v162, v162, v163, vcc
    v_add_u32 v5, v4, v162
    v_mul_u32_u24 v161, 43, v7
    v_lshrrev_b32 v161, 8, v161
    v_mul_u32_u24 v162, 6, v161
    v_sub_u32 v7, v7, v162
    v_lshrrev_b32 v160, 2, v6
    v_mul_u32_u24 v160, 3072, v160
    v_and_b32 v162, 3, v6
    v_lshl_add_u32 v160, v162, 8, v160
    v_mul_u32_u24 v161, 15360, v161
    v_add_u32 v160, v160, v161
    v_lshrrev_b32 v161, 2, v7
    v_mul_u32_u24 v161, 2048, v161
    v_add_u32 v160, v160, v161
    v_and_b32 v161, 3, v7
    v_lshlrev_b32 v162, 6, v161
    v_lshlrev_b32 v163, 7, v161
    v_cmp_gt_u32 vcc, 4, v7
    s_nop 1
    v_cndmask_b32 v162, v163, v162, vcc
    v_add_u32 v6, v160, v162
    v_mov_b32 v162, 64
    v_mov_b32 v163, 1024
    v_cndmask_b32 v162, v162, v163, vcc
    v_add_u32 v7, v6, v162
    v_cmp_gt_u32 vcc, 224, v0
    v_mov_b32 v160, 61440
    s_nop 0
    v_cndmask_b32 v6, v160, v6, vcc
    v_cndmask_b32 v7, v160, v7, vcc
    s_mul_i32 s13, s3, 15360
    v_add_u32 v8, s13, v10
    s_lshl_b32 s62, s60, 2
    s_add_u32 s62, s62, s3
    s_mul_i32 s10, s62, 122880
    s_mul_i32 s11, s61, 30720
    s_add_u32 s10, s10, s11
    s_and_b32 s13, s2, 1
    s_mul_i32 s11, s13, 3072
    s_add_u32 s10, s10, s11
    s_add_u32 s10, s10, 4194304
    v_mov_b32 v196, 0
    v_mov_b32 v197, 0
    v_mov_b32 v198, 0
    s_waitcnt vmcnt(17)
    v_perm_b32 v160, v20, v16, s58
    s_waitcnt vmcnt(15)
    v_perm_b32 v161, v28, v24, s58
    s_waitcnt vmcnt(13)
    v_perm_b32 v162, v36, v32, s58
    s_waitcnt vmcnt(11)
    v_perm_b32 v163, v44, v40, s58
    ds_write_b128 v4, v[160:163] offset:0
    v_perm_b32 v164, v20, v16, s59
    v_perm_b32 v165, v28, v24, s59
    v_perm_b32 v166, v36, v32, s59
    v_perm_b32 v167, v44, v40, s59
    ds_write_b128 v4, v[164:167] offset:16
    v_perm_b32 v168, v21, v17, s58
    v_perm_b32 v169, v29, v25, s58
    v_perm_b32 v170, v37, v33, s58
    v_perm_b32 v171, v45, v41, s58
    ds_write_b128 v4, v[168:171] offset:32
    v_perm_b32 v172, v21, v17, s59
    v_perm_b32 v173, v29, v25, s59
    v_perm_b32 v174, v37, v33, s59
    v_perm_b32 v175, v45, v41, s59
    ds_write_b128 v4, v[172:175] offset:48
    v_perm_b32 v176, v22, v18, s58
    v_perm_b32 v177, v30, v26, s58
    v_perm_b32 v178, v38, v34, s58
    v_perm_b32 v179, v46, v42, s58
    ds_write_b128 v5, v[176:179] offset:0
    v_perm_b32 v180, v22, v18, s59
    v_perm_b32 v181, v30, v26, s59
    v_perm_b32 v182, v38, v34, s59
    v_perm_b32 v183, v46, v42, s59
    ds_write_b128 v5, v[180:183] offset:16
    v_perm_b32 v184, v23, v19, s58
    v_perm_b32 v185, v31, v27, s58
    v_perm_b32 v186, v39, v35, s58
    v_perm_b32 v187, v47, v43, s58
    ds_write_b128 v5, v[184:187] offset:32
    v_perm_b32 v188, v23, v19, s59
    v_perm_b32 v189, v31, v27, s59
    v_perm_b32 v190, v39, v35, s59
    v_perm_b32 v191, v47, v43, s59
    ds_write_b128 v5, v[188:191] offset:48
    s_waitcnt lgkmcnt(0)
    s_barrier
    ds_read_b128 v[80:83], v8 offset:0
    ds_read_b128 v[84:87], v8 offset:1024
    ds_read_b128 v[88:91], v8 offset:2048
    ds_read_b128 v[92:95], v8 offset:3072
    ds_read_b128 v[96:99], v8 offset:4096
    ds_read_b128 v[100:103], v8 offset:5120
    s_waitcnt lgkmcnt(5)
    buffer_store_dwordx4 v[80:83], v10, s[48:51], s10 offen offset:0 sc1
    v_dot2c_f32_bf16 v196, v80, v12
    v_dot2c_f32_bf16 v196, v81, v12
    v_dot2c_f32_bf16 v196, v82, v12
    v_dot2c_f32_bf16 v196, v83, v12
    s_waitcnt lgkmcnt(4)
    buffer_store_dwordx4 v[84:87], v10, s[48:51], s10 offen offset:1024 sc1
    v_dot2c_f32_bf16 v197, v84, v12
    v_dot2c_f32_bf16 v197, v85, v12
    v_dot2c_f32_bf16 v197, v86, v12
    v_dot2c_f32_bf16 v197, v87, v12
    s_waitcnt lgkmcnt(3)
    buffer_store_dwordx4 v[88:91], v10, s[48:51], s10 offen offset:2048 sc1
    s_add_u32 s10, s10, 6144
    v_dot2c_f32_bf16 v198, v88, v12
    v_dot2c_f32_bf16 v198, v89, v12
    v_dot2c_f32_bf16 v198, v90, v12
    v_dot2c_f32_bf16 v198, v91, v12
    s_waitcnt lgkmcnt(2)
    buffer_store_dwordx4 v[92:95], v10, s[48:51], s10 offen offset:0 sc1
    v_dot2c_f32_bf16 v196, v92, v12
    v_dot2c_f32_bf16 v196, v93, v12
    v_dot2c_f32_bf16 v196, v94, v12
    v_dot2c_f32_bf16 v196, v95, v12
    s_waitcnt lgkmcnt(1)
    buffer_store_dwordx4 v[96:99], v10, s[48:51], s10 offen offset:1024 sc1
    v_dot2c_f32_bf16 v197, v96, v12
    v_dot2c_f32_bf16 v197, v97, v12
    v_dot2c_f32_bf16 v197, v98, v12
    v_dot2c_f32_bf16 v197, v99, v12
    s_waitcnt lgkmcnt(0)
    buffer_store_dwordx4 v[100:103], v10, s[48:51], s10 offen offset:2048 sc1
    s_add_u32 s10, s10, 6144
    v_dot2c_f32_bf16 v198, v100, v12
    v_dot2c_f32_bf16 v198, v101, v12
    v_dot2c_f32_bf16 v198, v102, v12
    v_dot2c_f32_bf16 v198, v103, v12
    s_waitcnt vmcnt(15)
    v_perm_b32 v160, v52, v48, s58
    s_waitcnt vmcnt(13)
    v_perm_b32 v161, v60, v56, s58
    s_waitcnt vmcnt(11)
    v_perm_b32 v162, v68, v64, s58
    s_waitcnt vmcnt(9)
    v_perm_b32 v163, v76, v72, s58
    ds_write_b128 v6, v[160:163] offset:0
    v_perm_b32 v164, v52, v48, s59
    v_perm_b32 v165, v60, v56, s59
    v_perm_b32 v166, v68, v64, s59
    v_perm_b32 v167, v76, v72, s59
    ds_write_b128 v6, v[164:167] offset:16
    v_perm_b32 v168, v53, v49, s58
    v_perm_b32 v169, v61, v57, s58
    v_perm_b32 v170, v69, v65, s58
    v_perm_b32 v171, v77, v73, s58
    ds_write_b128 v6, v[168:171] offset:32
    v_perm_b32 v172, v53, v49, s59
    v_perm_b32 v173, v61, v57, s59
    v_perm_b32 v174, v69, v65, s59
    v_perm_b32 v175, v77, v73, s59
    ds_write_b128 v6, v[172:175] offset:48
    v_perm_b32 v176, v54, v50, s58
    v_perm_b32 v177, v62, v58, s58
    v_perm_b32 v178, v70, v66, s58
    v_perm_b32 v179, v78, v74, s58
    ds_write_b128 v7, v[176:179] offset:0
    v_perm_b32 v180, v54, v50, s59
    v_perm_b32 v181, v62, v58, s59
    v_perm_b32 v182, v70, v66, s59
    v_perm_b32 v183, v78, v74, s59
    ds_write_b128 v7, v[180:183] offset:16
    v_perm_b32 v184, v55, v51, s58
    v_perm_b32 v185, v63, v59, s58
    v_perm_b32 v186, v71, v67, s58
    v_perm_b32 v187, v79, v75, s58
    ds_write_b128 v7, v[184:187] offset:32
    v_perm_b32 v188, v55, v51, s59
    v_perm_b32 v189, v63, v59, s59
    v_perm_b32 v190, v71, v67, s59
    v_perm_b32 v191, v79, v75, s59
    ds_write_b128 v7, v[188:191] offset:48
    s_waitcnt lgkmcnt(0)
    s_barrier
    ds_read_b128 v[104:107], v8 offset:6144
    ds_read_b128 v[108:111], v8 offset:7168
    ds_read_b128 v[112:115], v8 offset:8192
    ds_read_b128 v[116:119], v8 offset:9216
    ds_read_b128 v[120:123], v8 offset:10240
    ds_read_b128 v[124:127], v8 offset:11264
    ds_read_b128 v[128:131], v8 offset:12288
    ds_read_b128 v[132:135], v8 offset:13312
    ds_read_b128 v[136:139], v8 offset:14336
    s_waitcnt lgkmcnt(8)
    buffer_store_dwordx4 v[104:107], v10, s[48:51], s10 offen offset:0 sc1
    v_dot2c_f32_bf16 v196, v104, v12
    v_dot2c_f32_bf16 v196, v105, v12
    v_dot2c_f32_bf16 v196, v106, v12
    v_dot2c_f32_bf16 v196, v107, v12
    s_waitcnt lgkmcnt(7)
    buffer_store_dwordx4 v[108:111], v10, s[48:51], s10 offen offset:1024 sc1
    v_dot2c_f32_bf16 v197, v108, v12
    v_dot2c_f32_bf16 v197, v109, v12
    v_dot2c_f32_bf16 v197, v110, v12
    v_dot2c_f32_bf16 v197, v111, v12
    s_waitcnt lgkmcnt(6)
    buffer_store_dwordx4 v[112:115], v10, s[48:51], s10 offen offset:2048 sc1
    s_add_u32 s10, s10, 6144
    v_dot2c_f32_bf16 v198, v112, v12
    v_dot2c_f32_bf16 v198, v113, v12
    v_dot2c_f32_bf16 v198, v114, v12
    v_dot2c_f32_bf16 v198, v115, v12
    s_waitcnt lgkmcnt(5)
    buffer_store_dwordx4 v[116:119], v10, s[48:51], s10 offen offset:0 sc1
    v_dot2c_f32_bf16 v196, v116, v12
    v_dot2c_f32_bf16 v196, v117, v12
    v_dot2c_f32_bf16 v196, v118, v12
    v_dot2c_f32_bf16 v196, v119, v12
    s_waitcnt lgkmcnt(4)
    buffer_store_dwordx4 v[120:123], v10, s[48:51], s10 offen offset:1024 sc1
    v_dot2c_f32_bf16 v197, v120, v12
    v_dot2c_f32_bf16 v197, v121, v12
    v_dot2c_f32_bf16 v197, v122, v12
    v_dot2c_f32_bf16 v197, v123, v12
    s_waitcnt lgkmcnt(3)
    buffer_store_dwordx4 v[124:127], v10, s[48:51], s10 offen offset:2048 sc1
    s_add_u32 s10, s10, 6144
    v_dot2c_f32_bf16 v198, v124, v12
    v_dot2c_f32_bf16 v198, v125, v12
    v_dot2c_f32_bf16 v198, v126, v12
    v_dot2c_f32_bf16 v198, v127, v12
    s_waitcnt lgkmcnt(2)
    buffer_store_dwordx4 v[128:131], v10, s[48:51], s10 offen offset:0 sc1
    v_dot2c_f32_bf16 v196, v128, v12
    v_dot2c_f32_bf16 v196, v129, v12
    v_dot2c_f32_bf16 v196, v130, v12
    v_dot2c_f32_bf16 v196, v131, v12
    s_waitcnt lgkmcnt(1)
    buffer_store_dwordx4 v[132:135], v10, s[48:51], s10 offen offset:1024 sc1
    v_dot2c_f32_bf16 v197, v132, v12
    v_dot2c_f32_bf16 v197, v133, v12
    v_dot2c_f32_bf16 v197, v134, v12
    v_dot2c_f32_bf16 v197, v135, v12
    s_waitcnt lgkmcnt(0)
    buffer_store_dwordx4 v[136:139], v10, s[48:51], s10 offen offset:2048 sc1
    s_add_u32 s10, s10, 6144
    v_dot2c_f32_bf16 v198, v136, v12
    v_dot2c_f32_bf16 v198, v137, v12
    v_dot2c_f32_bf16 v198, v138, v12
    v_dot2c_f32_bf16 v198, v139, v12
    s_waitcnt vmcnt(17)
    v_mov_b32 v246, v246
    s_mov_b64 exec, 0x1
    v_cmp_ne_u32 vcc, 0, v246
    s_nop 0
    s_cmp_eq_u64 vcc, exec
    s_mov_b64 exec, -1
    s_cbranch_scc1 interleave_layers__ssm_conv_h3__swiglu_ffn__prompt_kernel_ok9
    s_mov_b32 s23, 0
interleave_layers__ssm_conv_h3__swiglu_ffn__prompt_kernel_spin10:
    s_sleep 1
    s_mov_b64 exec, 0x1
    buffer_load_dwordx2 v[246:247], v1, s[52:55], 0 offen sc1
    s_mov_b64 exec, -1
    s_waitcnt vmcnt(0)
    s_add_u32 s23, s23, 1
    s_cmp_ge_u32 s23, 262144
    s_cbranch_scc1 interleave_layers__ssm_conv_h3__swiglu_ffn__prompt_kernel_ok9
    v_mov_b32 v246, v246
    s_mov_b64 exec, 0x1
    v_cmp_ne_u32 vcc, 0, v246
    s_nop 0
    s_cmp_eq_u64 vcc, exec
    s_mov_b64 exec, -1
    s_cbranch_scc0 interleave_layers__ssm_conv_h3__swiglu_ffn__prompt_kernel_spin10
    s_nop 0
interleave_layers__ssm_conv_h3__swiglu_ffn__prompt_kernel_ok9:
    v_readfirstlane_b32 s100, v246
    v_readfirstlane_b32 s101, v247
    v_mov_b32 v5, v196
    v_mov_b32 v6, v197
    v_mov_b32 v7, v198
    v_mov_b32 v8, v5
    s_nop 1
    v_permlane16_swap_b32 v5, v8
    v_add_f32 v5, v5, v8
    v_mov_b32 v8, v5
    s_nop 1
    v_permlane32_swap_b32 v5, v8
    v_add_f32 v5, v5, v8
    v_mov_b32 v8, v6
    s_nop 1
    v_permlane16_swap_b32 v6, v8
    v_add_f32 v6, v6, v8
    v_mov_b32 v8, v6
    s_nop 1
    v_permlane32_swap_b32 v6, v8
    v_add_f32 v6, v6, v8
    v_mov_b32 v8, v7
    s_nop 1
    v_permlane16_swap_b32 v7, v8
    v_add_f32 v7, v7, v8
    v_mov_b32 v8, v7
    s_nop 1
    v_permlane32_swap_b32 v7, v8
    v_add_f32 v7, v7, v8
    v_cmp_eq_u32 vcc, 1, v3
    s_nop 1
    v_cndmask_b32 v5, v5, v6, vcc
    v_cmp_eq_u32 vcc, 2, v3
    s_nop 1
    v_cndmask_b32 v5, v5, v7, vcc
    v_lshlrev_b32 v6, 2, v1
    v_cmp_gt_u32 vcc, 48, v1
    s_nop 1
    v_cndmask_b32 v6, v14, v6, vcc
    s_lshl_b32 s10, s62, 11
    s_lshl_b32 s11, s61, 9
    s_add_u32 s10, s10, s11
    s_mul_i32 s11, s13, 192
    s_add_u32 s10, s10, s11
    s_add_u32 s10, s10, 8388608
    buffer_store_dword v5, v6, s[48:51], s10 offen sc1
    s_mov_b32 s36, s26
    s_mov_b32 s37, s27
    s_mov_b32 s38, 2621440
    s_mov_b32 s39, 0x00020000
    s_mul_i32 s62, s3, 96
    s_add_u32 s62, s62, s2
    s_cmp_lt_u32 s62, 128
    s_cselect_b32 s63, 0, 0x40000000
    s_mul_i32 s56, s62, 20480
    s_add_u32 s56, s56, s63
    v_mul_u32_u24 v11, 1280, v2
    v_lshl_add_u32 v11, v3, 4, v11
    buffer_load_dwordx4 v[80:83], v11, s[36:39], s56 offen offset:0
    buffer_load_dwordx4 v[84:87], v11, s[36:39], s56 offen offset:64
    buffer_load_dwordx4 v[88:91], v11, s[36:39], s56 offen offset:128
    buffer_load_dwordx4 v[92:95], v11, s[36:39], s56 offen offset:192
    buffer_load_dwordx4 v[96:99], v11, s[36:39], s56 offen offset:256
    buffer_load_dwordx4 v[100:103], v11, s[36:39], s56 offen offset:320
    buffer_load_dwordx4 v[104:107], v11, s[36:39], s56 offen offset:384
    buffer_load_dwordx4 v[108:111], v11, s[36:39], s56 offen offset:448
    buffer_load_dwordx4 v[112:115], v11, s[36:39], s56 offen offset:512
    buffer_load_dwordx4 v[116:119], v11, s[36:39], s56 offen offset:576
    buffer_load_dwordx4 v[120:123], v11, s[36:39], s56 offen offset:640
    buffer_load_dwordx4 v[124:127], v11, s[36:39], s56 offen offset:704
    buffer_load_dwordx4 v[128:131], v11, s[36:39], s56 offen offset:768
    buffer_load_dwordx4 v[132:135], v11, s[36:39], s56 offen offset:832
    buffer_load_dwordx4 v[136:139], v11, s[36:39], s56 offen offset:896
    buffer_load_dwordx4 v[140:143], v11, s[36:39], s56 offen offset:960
    buffer_load_dwordx4 v[144:147], v11, s[36:39], s56 offen offset:1024
    buffer_load_dwordx4 v[148:151], v11, s[36:39], s56 offen offset:1088
    buffer_load_dwordx4 v[152:155], v11, s[36:39], s56 offen offset:1152
    buffer_load_dwordx4 v[156:159], v11, s[36:39], s56 offen offset:1216
    s_waitcnt vmcnt(20)
    s_branch main_prep_pub
main_prep_wd:
    v_add_u32 v8, 0, v0
    v_mul_u32_u24 v4, 820, v8
    v_lshrrev_b32 v4, 16, v4
    v_mul_u32_u24 v5, 80, v4
    v_sub_u32 v5, v8, v5
    v_add_u32 v8, 256, v0
    v_mul_u32_u24 v6, 820, v8
    v_lshrrev_b32 v6, 16, v6
    v_mul_u32_u24 v7, 80, v6
    v_sub_u32 v7, v8, v7
    s_sub_u32 s60, s2, 64
    s_mul_i32 s10, s60, 61440
    v_mul_u32_u24 v8, 10240, v4
    v_lshl_add_u32 v8, v5, 4, v8
    v_mul_u32_u24 v9, 10240, v6
    v_lshl_add_u32 v9, v7, 4, v9
    v_cmp_gt_u32 vcc, 224, v0
    s_nop 1
    v_cndmask_b32 v9, v14, v9, vcc
    s_mov_b32 s11, s10
    buffer_load_dwordx4 v[16:19], v8, s[28:31], s11 offen
    s_add_u32 s11, s11, 1280
    buffer_load_dwordx4 v[20:23], v8, s[28:31], s11 offen
    s_add_u32 s11, s11, 1280
    buffer_load_dwordx4 v[24:27], v8, s[28:31], s11 offen
    s_add_u32 s11, s11, 1280
    buffer_load_dwordx4 v[28:31], v8, s[28:31], s11 offen
    s_add_u32 s11, s11, 1280
    buffer_load_dwordx4 v[32:35], v8, s[28:31], s11 offen
    s_add_u32 s11, s11, 1280
    buffer_load_dwordx4 v[36:39], v8, s[28:31], s11 offen
    s_add_u32 s11, s11, 1280
    buffer_load_dwordx4 v[40:43], v8, s[28:31], s11 offen
    s_add_u32 s11, s11, 1280
    buffer_load_dwordx4 v[44:47], v8, s[28:31], s11 offen
    s_mov_b32 s11, s10
    buffer_load_dwordx4 v[48:51], v9, s[28:31], s11 offen
    s_add_u32 s11, s11, 1280
    buffer_load_dwordx4 v[52:55], v9, s[28:31], s11 offen
    s_add_u32 s11, s11, 1280
    buffer_load_dwordx4 v[56:59], v9, s[28:31], s11 offen
    s_add_u32 s11, s11, 1280
    buffer_load_dwordx4 v[60:63], v9, s[28:31], s11 offen
    s_add_u32 s11, s11, 1280
    buffer_load_dwordx4 v[64:67], v9, s[28:31], s11 offen
    s_add_u32 s11, s11, 1280
    buffer_load_dwordx4 v[68:71], v9, s[28:31], s11 offen
    s_add_u32 s11, s11, 1280
    buffer_load_dwordx4 v[72:75], v9, s[28:31], s11 offen
    s_add_u32 s11, s11, 1280
    buffer_load_dwordx4 v[76:79], v9, s[28:31], s11 offen
    s_mov_b64 exec, 0x1
    buffer_load_dwordx2 v[246:247], v1, s[52:55], 0 offen sc1
    s_mov_b64 exec, -1
    v_mov_b32 v240, 0
    v_mov_b32 v241, 0
    v_mov_b32 v242, 0
    v_mov_b32 v243, 0
    s_add_u32 s36, s24, 41943040
    s_addc_u32 s37, s25, 0
    s_mov_b32 s38, 589824
    s_mov_b32 s39, 0x00020000
    s_lshl_b32 s12, s2, 13
    v_lshlrev_b32 v204, 4, v0
    buffer_store_dwordx4 v[240:243], v204, s[36:39], s12 offen sc1
    s_add_u32 s12, s12, 4096
    buffer_store_dwordx4 v[240:243], v204, s[36:39], s12 offen sc1
    s_add_u32 s12, s12, 4096
    v_mul_u32_u24 v161, 205, v5
    v_lshrrev_b32 v161, 11, v161
    v_mul_u32_u24 v162, 10, v161
    v_sub_u32 v5, v5, v162
    v_lshlrev_b32 v160, 8, v4
    v_mul_u32_u24 v161, 7680, v161
    v_add_u32 v160, v160, v161
    v_lshrrev_b32 v161, 2, v5
    v_mul_u32_u24 v161, 3072, v161
    v_add_u32 v160, v160, v161
    v_and_b32 v161, 3, v5
    v_lshlrev_b32 v162, 6, v161
    v_lshlrev_b32 v163, 7, v161
    v_cmp_gt_u32 vcc, 8, v5
    s_nop 1
    v_cndmask_b32 v162, v163, v162, vcc
    v_add_u32 v4, v160, v162
    v_mov_b32 v162, 64
    v_mov_b32 v163, 1536
    v_cndmask_b32 v162, v162, v163, vcc
    v_add_u32 v5, v4, v162
    v_mul_u32_u24 v161, 205, v7
    v_lshrrev_b32 v161, 11, v161
    v_mul_u32_u24 v162, 10, v161
    v_sub_u32 v7, v7, v162
    v_lshlrev_b32 v160, 8, v6
    v_mul_u32_u24 v161, 7680, v161
    v_add_u32 v160, v160, v161
    v_lshrrev_b32 v161, 2, v7
    v_mul_u32_u24 v161, 3072, v161
    v_add_u32 v160, v160, v161
    v_and_b32 v161, 3, v7
    v_lshlrev_b32 v162, 6, v161
    v_lshlrev_b32 v163, 7, v161
    v_cmp_gt_u32 vcc, 8, v7
    s_nop 1
    v_cndmask_b32 v162, v163, v162, vcc
    v_add_u32 v6, v160, v162
    v_mov_b32 v162, 64
    v_mov_b32 v163, 1536
    v_cndmask_b32 v162, v162, v163, vcc
    v_add_u32 v7, v6, v162
    v_cmp_gt_u32 vcc, 224, v0
    v_mov_b32 v160, 61440
    s_nop 0
    v_cndmask_b32 v6, v160, v6, vcc
    v_cndmask_b32 v7, v160, v7, vcc
    s_mul_i32 s13, s3, 15360
    v_add_u32 v8, s13, v10
    s_mul_i32 s11, s60, 6
    v_cmp_gt_u32 vcc, 3, v3
    v_add3_u32 v196, v3, s11, 0
    v_lshrrev_b32 v13, 2, v196
    v_mul_u32_u24 v13, 5120, v13
    v_and_b32 v196, 3, v196
    v_lshl_add_u32 v196, v196, 8, v13
    v_lshl_add_u32 v196, v2, 4, v196
    v_cndmask_b32 v196, v14, v196, vcc
    v_add3_u32 v197, v3, s11, 3
    v_lshrrev_b32 v13, 2, v197
    v_mul_u32_u24 v13, 5120, v13
    v_and_b32 v197, 3, v197
    v_lshl_add_u32 v197, v197, 8, v13
    v_lshl_add_u32 v197, v2, 4, v197
    v_cndmask_b32 v197, v14, v197, vcc
    s_mul_i32 s10, s3, 491520
    s_add_u32 s10, s10, 9437184
    s_waitcnt vmcnt(17)
    v_perm_b32 v160, v20, v16, s58
    s_waitcnt vmcnt(15)
    v_perm_b32 v161, v28, v24, s58
    s_waitcnt vmcnt(13)
    v_perm_b32 v162, v36, v32, s58
    s_waitcnt vmcnt(11)
    v_perm_b32 v163, v44, v40, s58
    ds_write_b128 v4, v[160:163] offset:0
    v_perm_b32 v164, v20, v16, s59
    v_perm_b32 v165, v28, v24, s59
    v_perm_b32 v166, v36, v32, s59
    v_perm_b32 v167, v44, v40, s59
    ds_write_b128 v4, v[164:167] offset:16
    v_perm_b32 v168, v21, v17, s58
    v_perm_b32 v169, v29, v25, s58
    v_perm_b32 v170, v37, v33, s58
    v_perm_b32 v171, v45, v41, s58
    ds_write_b128 v4, v[168:171] offset:32
    v_perm_b32 v172, v21, v17, s59
    v_perm_b32 v173, v29, v25, s59
    v_perm_b32 v174, v37, v33, s59
    v_perm_b32 v175, v45, v41, s59
    ds_write_b128 v4, v[172:175] offset:48
    v_perm_b32 v176, v22, v18, s58
    v_perm_b32 v177, v30, v26, s58
    v_perm_b32 v178, v38, v34, s58
    v_perm_b32 v179, v46, v42, s58
    ds_write_b128 v5, v[176:179] offset:0
    v_perm_b32 v180, v22, v18, s59
    v_perm_b32 v181, v30, v26, s59
    v_perm_b32 v182, v38, v34, s59
    v_perm_b32 v183, v46, v42, s59
    ds_write_b128 v5, v[180:183] offset:16
    v_perm_b32 v184, v23, v19, s58
    v_perm_b32 v185, v31, v27, s58
    v_perm_b32 v186, v39, v35, s58
    v_perm_b32 v187, v47, v43, s58
    ds_write_b128 v5, v[184:187] offset:32
    v_perm_b32 v188, v23, v19, s59
    v_perm_b32 v189, v31, v27, s59
    v_perm_b32 v190, v39, v35, s59
    v_perm_b32 v191, v47, v43, s59
    ds_write_b128 v5, v[188:191] offset:48
    s_waitcnt lgkmcnt(0)
    s_barrier
    ds_read_b128 v[80:83], v8 offset:0
    ds_read_b128 v[84:87], v8 offset:1536
    ds_read_b128 v[88:91], v8 offset:3072
    ds_read_b128 v[92:95], v8 offset:4608
    ds_read_b128 v[96:99], v8 offset:6144
    ds_read_b128 v[100:103], v8 offset:7680
    ds_read_b128 v[104:107], v8 offset:9216
    ds_read_b128 v[108:111], v8 offset:10752
    ds_read_b128 v[112:115], v8 offset:12288
    ds_read_b128 v[116:119], v8 offset:13824
    s_add_u32 s11, s10, 0
    s_waitcnt lgkmcnt(9)
    buffer_store_dwordx4 v[80:83], v196, s[48:51], s11 offen sc1
    s_add_u32 s11, s10, 1024
    s_waitcnt lgkmcnt(8)
    buffer_store_dwordx4 v[84:87], v196, s[48:51], s11 offen sc1
    s_add_u32 s11, s10, 2048
    s_waitcnt lgkmcnt(7)
    buffer_store_dwordx4 v[88:91], v196, s[48:51], s11 offen sc1
    s_add_u32 s11, s10, 3072
    s_waitcnt lgkmcnt(6)
    buffer_store_dwordx4 v[92:95], v196, s[48:51], s11 offen sc1
    s_add_u32 s11, s10, 4096
    s_waitcnt lgkmcnt(5)
    buffer_store_dwordx4 v[96:99], v196, s[48:51], s11 offen sc1
    s_add_u32 s11, s10, 245760
    s_waitcnt lgkmcnt(4)
    buffer_store_dwordx4 v[100:103], v196, s[48:51], s11 offen sc1
    s_add_u32 s11, s10, 246784
    s_waitcnt lgkmcnt(3)
    buffer_store_dwordx4 v[104:107], v196, s[48:51], s11 offen sc1
    s_add_u32 s11, s10, 247808
    s_waitcnt lgkmcnt(2)
    buffer_store_dwordx4 v[108:111], v196, s[48:51], s11 offen sc1
    s_add_u32 s11, s10, 248832
    s_waitcnt lgkmcnt(1)
    buffer_store_dwordx4 v[112:115], v196, s[48:51], s11 offen sc1
    s_add_u32 s11, s10, 249856
    s_waitcnt lgkmcnt(0)
    buffer_store_dwordx4 v[116:119], v196, s[48:51], s11 offen sc1
    s_waitcnt vmcnt(19)
    v_perm_b32 v160, v52, v48, s58
    s_waitcnt vmcnt(17)
    v_perm_b32 v161, v60, v56, s58
    s_waitcnt vmcnt(15)
    v_perm_b32 v162, v68, v64, s58
    s_waitcnt vmcnt(13)
    v_perm_b32 v163, v76, v72, s58
    ds_write_b128 v6, v[160:163] offset:0
    v_perm_b32 v164, v52, v48, s59
    v_perm_b32 v165, v60, v56, s59
    v_perm_b32 v166, v68, v64, s59
    v_perm_b32 v167, v76, v72, s59
    ds_write_b128 v6, v[164:167] offset:16
    v_perm_b32 v168, v53, v49, s58
    v_perm_b32 v169, v61, v57, s58
    v_perm_b32 v170, v69, v65, s58
    v_perm_b32 v171, v77, v73, s58
    ds_write_b128 v6, v[168:171] offset:32
    v_perm_b32 v172, v53, v49, s59
    v_perm_b32 v173, v61, v57, s59
    v_perm_b32 v174, v69, v65, s59
    v_perm_b32 v175, v77, v73, s59
    ds_write_b128 v6, v[172:175] offset:48
    v_perm_b32 v176, v54, v50, s58
    v_perm_b32 v177, v62, v58, s58
    v_perm_b32 v178, v70, v66, s58
    v_perm_b32 v179, v78, v74, s58
    ds_write_b128 v7, v[176:179] offset:0
    v_perm_b32 v180, v54, v50, s59
    v_perm_b32 v181, v62, v58, s59
    v_perm_b32 v182, v70, v66, s59
    v_perm_b32 v183, v78, v74, s59
    ds_write_b128 v7, v[180:183] offset:16
    v_perm_b32 v184, v55, v51, s58
    v_perm_b32 v185, v63, v59, s58
    v_perm_b32 v186, v71, v67, s58
    v_perm_b32 v187, v79, v75, s58
    ds_write_b128 v7, v[184:187] offset:32
    v_perm_b32 v188, v55, v51, s59
    v_perm_b32 v189, v63, v59, s59
    v_perm_b32 v190, v71, v67, s59
    v_perm_b32 v191, v79, v75, s59
    ds_write_b128 v7, v[188:191] offset:48
    s_waitcnt lgkmcnt(0)
    s_barrier
    ds_read_b128 v[120:123], v8 offset:768
    ds_read_b128 v[124:127], v8 offset:2304
    ds_read_b128 v[128:131], v8 offset:3840
    ds_read_b128 v[132:135], v8 offset:5376
    ds_read_b128 v[136:139], v8 offset:6912
    ds_read_b128 v[140:143], v8 offset:8448
    ds_read_b128 v[144:147], v8 offset:9984
    ds_read_b128 v[148:151], v8 offset:11520
    ds_read_b128 v[152:155], v8 offset:13056
    ds_read_b128 v[156:159], v8 offset:14592
    s_add_u32 s11, s10, 0
    s_waitcnt lgkmcnt(9)
    buffer_store_dwordx4 v[120:123], v197, s[48:51], s11 offen sc1
    s_add_u32 s11, s10, 1024
    s_waitcnt lgkmcnt(8)
    buffer_store_dwordx4 v[124:127], v197, s[48:51], s11 offen sc1
    s_add_u32 s11, s10, 2048
    s_waitcnt lgkmcnt(7)
    buffer_store_dwordx4 v[128:131], v197, s[48:51], s11 offen sc1
    s_add_u32 s11, s10, 3072
    s_waitcnt lgkmcnt(6)
    buffer_store_dwordx4 v[132:135], v197, s[48:51], s11 offen sc1
    s_add_u32 s11, s10, 4096
    s_waitcnt lgkmcnt(5)
    buffer_store_dwordx4 v[136:139], v197, s[48:51], s11 offen sc1
    s_add_u32 s11, s10, 245760
    s_waitcnt lgkmcnt(4)
    buffer_store_dwordx4 v[140:143], v197, s[48:51], s11 offen sc1
    s_add_u32 s11, s10, 246784
    s_waitcnt lgkmcnt(3)
    buffer_store_dwordx4 v[144:147], v197, s[48:51], s11 offen sc1
    s_add_u32 s11, s10, 247808
    s_waitcnt lgkmcnt(2)
    buffer_store_dwordx4 v[148:151], v197, s[48:51], s11 offen sc1
    s_add_u32 s11, s10, 248832
    s_waitcnt lgkmcnt(1)
    buffer_store_dwordx4 v[152:155], v197, s[48:51], s11 offen sc1
    s_add_u32 s11, s10, 249856
    s_waitcnt lgkmcnt(0)
    buffer_store_dwordx4 v[156:159], v197, s[48:51], s11 offen sc1
    s_waitcnt vmcnt(22)
    v_mov_b32 v246, v246
    s_mov_b64 exec, 0x1
    v_cmp_ne_u32 vcc, 0, v246
    s_nop 0
    s_cmp_eq_u64 vcc, exec
    s_mov_b64 exec, -1
    s_cbranch_scc1 interleave_layers__ssm_conv_h3__swiglu_ffn__prompt_kernel_ok11
    s_mov_b32 s23, 0
interleave_layers__ssm_conv_h3__swiglu_ffn__prompt_kernel_spin12:
    s_sleep 1
    s_mov_b64 exec, 0x1
    buffer_load_dwordx2 v[246:247], v1, s[52:55], 0 offen sc1
    s_mov_b64 exec, -1
    s_waitcnt vmcnt(0)
    s_add_u32 s23, s23, 1
    s_cmp_ge_u32 s23, 262144
    s_cbranch_scc1 interleave_layers__ssm_conv_h3__swiglu_ffn__prompt_kernel_ok11
    v_mov_b32 v246, v246
    s_mov_b64 exec, 0x1
    v_cmp_ne_u32 vcc, 0, v246
    s_nop 0
    s_cmp_eq_u64 vcc, exec
    s_mov_b64 exec, -1
    s_cbranch_scc0 interleave_layers__ssm_conv_h3__swiglu_ffn__prompt_kernel_spin12
    s_nop 0
interleave_layers__ssm_conv_h3__swiglu_ffn__prompt_kernel_ok11:
    v_readfirstlane_b32 s100, v246
    v_readfirstlane_b32 s101, v247
    s_mov_b32 s36, s26
    s_mov_b32 s37, s27
    s_mov_b32 s38, 2621440
    s_mov_b32 s39, 0x00020000
    s_mul_i32 s62, s3, 96
    s_add_u32 s62, s62, s2
    s_cmp_lt_u32 s62, 128
    s_cselect_b32 s63, 0, 0x40000000
    s_mul_i32 s56, s62, 20480
    s_add_u32 s56, s56, s63
    v_mul_u32_u24 v11, 1280, v2
    v_lshl_add_u32 v11, v3, 4, v11
    buffer_load_dwordx4 v[80:83], v11, s[36:39], s56 offen offset:0
    buffer_load_dwordx4 v[84:87], v11, s[36:39], s56 offen offset:64
    buffer_load_dwordx4 v[88:91], v11, s[36:39], s56 offen offset:128
    buffer_load_dwordx4 v[92:95], v11, s[36:39], s56 offen offset:192
    buffer_load_dwordx4 v[96:99], v11, s[36:39], s56 offen offset:256
    buffer_load_dwordx4 v[100:103], v11, s[36:39], s56 offen offset:320
    buffer_load_dwordx4 v[104:107], v11, s[36:39], s56 offen offset:384
    buffer_load_dwordx4 v[108:111], v11, s[36:39], s56 offen offset:448
    buffer_load_dwordx4 v[112:115], v11, s[36:39], s56 offen offset:512
    buffer_load_dwordx4 v[116:119], v11, s[36:39], s56 offen offset:576
    buffer_load_dwordx4 v[120:123], v11, s[36:39], s56 offen offset:640
    buffer_load_dwordx4 v[124:127], v11, s[36:39], s56 offen offset:704
    buffer_load_dwordx4 v[128:131], v11, s[36:39], s56 offen offset:768
    buffer_load_dwordx4 v[132:135], v11, s[36:39], s56 offen offset:832
    buffer_load_dwordx4 v[136:139], v11, s[36:39], s56 offen offset:896
    buffer_load_dwordx4 v[140:143], v11, s[36:39], s56 offen offset:960
    buffer_load_dwordx4 v[144:147], v11, s[36:39], s56 offen offset:1024
    buffer_load_dwordx4 v[148:151], v11, s[36:39], s56 offen offset:1088
    buffer_load_dwordx4 v[152:155], v11, s[36:39], s56 offen offset:1152
    buffer_load_dwordx4 v[156:159], v11, s[36:39], s56 offen offset:1216
    s_waitcnt vmcnt(20)
main_prep_pub:
    s_barrier
    s_lshl_b32 s10, s2, 7
    s_add_u32 s10, s10, 1196032
    s_cmp_eq_u32 s3, 0
    s_cselect_b32 s10, s10, 0x40000000
    v_mov_b32 v204, 0
    s_mov_b64 exec, 0x1
    buffer_store_dwordx2 v[246:247], v1, s[44:47], s10 offen sc1
    s_mov_b64 exec, -1
    s_add_u32 s12, s56, 46137344
    v_mov_b32 v200, 0
    v_mov_b32 v201, 0
    s_waitcnt vmcnt(20)
    buffer_store_dwordx4 v[80:83], v10, s[48:51], s12 offen offset:0 sc1
    v_dot2c_f32_bf16 v200, v80, v12
    v_dot2c_f32_bf16 v201, v80, v80
    v_dot2c_f32_bf16 v200, v81, v12
    v_dot2c_f32_bf16 v201, v81, v81
    v_dot2c_f32_bf16 v200, v82, v12
    v_dot2c_f32_bf16 v201, v82, v82
    v_dot2c_f32_bf16 v200, v83, v12
    v_dot2c_f32_bf16 v201, v83, v83
    s_waitcnt vmcnt(20)
    buffer_store_dwordx4 v[84:87], v10, s[48:51], s12 offen offset:1024 sc1
    v_dot2c_f32_bf16 v200, v84, v12
    v_dot2c_f32_bf16 v201, v84, v84
    v_dot2c_f32_bf16 v200, v85, v12
    v_dot2c_f32_bf16 v201, v85, v85
    v_dot2c_f32_bf16 v200, v86, v12
    v_dot2c_f32_bf16 v201, v86, v86
    v_dot2c_f32_bf16 v200, v87, v12
    v_dot2c_f32_bf16 v201, v87, v87
    s_waitcnt vmcnt(20)
    buffer_store_dwordx4 v[88:91], v10, s[48:51], s12 offen offset:2048 sc1
    v_dot2c_f32_bf16 v200, v88, v12
    v_dot2c_f32_bf16 v201, v88, v88
    v_dot2c_f32_bf16 v200, v89, v12
    v_dot2c_f32_bf16 v201, v89, v89
    v_dot2c_f32_bf16 v200, v90, v12
    v_dot2c_f32_bf16 v201, v90, v90
    v_dot2c_f32_bf16 v200, v91, v12
    v_dot2c_f32_bf16 v201, v91, v91
    s_waitcnt vmcnt(20)
    buffer_store_dwordx4 v[92:95], v10, s[48:51], s12 offen offset:3072 sc1
    v_dot2c_f32_bf16 v200, v92, v12
    v_dot2c_f32_bf16 v201, v92, v92
    v_dot2c_f32_bf16 v200, v93, v12
    v_dot2c_f32_bf16 v201, v93, v93
    v_dot2c_f32_bf16 v200, v94, v12
    v_dot2c_f32_bf16 v201, v94, v94
    v_dot2c_f32_bf16 v200, v95, v12
    v_dot2c_f32_bf16 v201, v95, v95
    s_add_u32 s12, s12, 4096
    s_waitcnt vmcnt(20)
    buffer_store_dwordx4 v[96:99], v10, s[48:51], s12 offen offset:0 sc1
    v_dot2c_f32_bf16 v200, v96, v12
    v_dot2c_f32_bf16 v201, v96, v96
    v_dot2c_f32_bf16 v200, v97, v12
    v_dot2c_f32_bf16 v201, v97, v97
    v_dot2c_f32_bf16 v200, v98, v12
    v_dot2c_f32_bf16 v201, v98, v98
    v_dot2c_f32_bf16 v200, v99, v12
    v_dot2c_f32_bf16 v201, v99, v99
    s_waitcnt vmcnt(20)
    buffer_store_dwordx4 v[100:103], v10, s[48:51], s12 offen offset:1024 sc1
    v_dot2c_f32_bf16 v200, v100, v12
    v_dot2c_f32_bf16 v201, v100, v100
    v_dot2c_f32_bf16 v200, v101, v12
    v_dot2c_f32_bf16 v201, v101, v101
    v_dot2c_f32_bf16 v200, v102, v12
    v_dot2c_f32_bf16 v201, v102, v102
    v_dot2c_f32_bf16 v200, v103, v12
    v_dot2c_f32_bf16 v201, v103, v103
    s_waitcnt vmcnt(20)
    buffer_store_dwordx4 v[104:107], v10, s[48:51], s12 offen offset:2048 sc1
    v_dot2c_f32_bf16 v200, v104, v12
    v_dot2c_f32_bf16 v201, v104, v104
    v_dot2c_f32_bf16 v200, v105, v12
    v_dot2c_f32_bf16 v201, v105, v105
    v_dot2c_f32_bf16 v200, v106, v12
    v_dot2c_f32_bf16 v201, v106, v106
    v_dot2c_f32_bf16 v200, v107, v12
    v_dot2c_f32_bf16 v201, v107, v107
    s_waitcnt vmcnt(20)
    buffer_store_dwordx4 v[108:111], v10, s[48:51], s12 offen offset:3072 sc1
    v_dot2c_f32_bf16 v200, v108, v12
    v_dot2c_f32_bf16 v201, v108, v108
    v_dot2c_f32_bf16 v200, v109, v12
    v_dot2c_f32_bf16 v201, v109, v109
    v_dot2c_f32_bf16 v200, v110, v12
    v_dot2c_f32_bf16 v201, v110, v110
    v_dot2c_f32_bf16 v200, v111, v12
    v_dot2c_f32_bf16 v201, v111, v111
    s_add_u32 s12, s12, 4096
    s_waitcnt vmcnt(20)
    buffer_store_dwordx4 v[112:115], v10, s[48:51], s12 offen offset:0 sc1
    v_dot2c_f32_bf16 v200, v112, v12
    v_dot2c_f32_bf16 v201, v112, v112
    v_dot2c_f32_bf16 v200, v113, v12
    v_dot2c_f32_bf16 v201, v113, v113
    v_dot2c_f32_bf16 v200, v114, v12
    v_dot2c_f32_bf16 v201, v114, v114
    v_dot2c_f32_bf16 v200, v115, v12
    v_dot2c_f32_bf16 v201, v115, v115
    s_waitcnt vmcnt(20)
    buffer_store_dwordx4 v[116:119], v10, s[48:51], s12 offen offset:1024 sc1
    v_dot2c_f32_bf16 v200, v116, v12
    v_dot2c_f32_bf16 v201, v116, v116
    v_dot2c_f32_bf16 v200, v117, v12
    v_dot2c_f32_bf16 v201, v117, v117
    v_dot2c_f32_bf16 v200, v118, v12
    v_dot2c_f32_bf16 v201, v118, v118
    v_dot2c_f32_bf16 v200, v119, v12
    v_dot2c_f32_bf16 v201, v119, v119
    s_waitcnt vmcnt(20)
    buffer_store_dwordx4 v[120:123], v10, s[48:51], s12 offen offset:2048 sc1
    v_dot2c_f32_bf16 v200, v120, v12
    v_dot2c_f32_bf16 v201, v120, v120
    v_dot2c_f32_bf16 v200, v121, v12
    v_dot2c_f32_bf16 v201, v121, v121
    v_dot2c_f32_bf16 v200, v122, v12
    v_dot2c_f32_bf16 v201, v122, v122
    v_dot2c_f32_bf16 v200, v123, v12
    v_dot2c_f32_bf16 v201, v123, v123
    s_waitcnt vmcnt(20)
    buffer_store_dwordx4 v[124:127], v10, s[48:51], s12 offen offset:3072 sc1
    v_dot2c_f32_bf16 v200, v124, v12
    v_dot2c_f32_bf16 v201, v124, v124
    v_dot2c_f32_bf16 v200, v125, v12
    v_dot2c_f32_bf16 v201, v125, v125
    v_dot2c_f32_bf16 v200, v126, v12
    v_dot2c_f32_bf16 v201, v126, v126
    v_dot2c_f32_bf16 v200, v127, v12
    v_dot2c_f32_bf16 v201, v127, v127
    s_add_u32 s12, s12, 4096
    s_waitcnt vmcnt(20)
    buffer_store_dwordx4 v[128:131], v10, s[48:51], s12 offen offset:0 sc1
    v_dot2c_f32_bf16 v200, v128, v12
    v_dot2c_f32_bf16 v201, v128, v128
    v_dot2c_f32_bf16 v200, v129, v12
    v_dot2c_f32_bf16 v201, v129, v129
    v_dot2c_f32_bf16 v200, v130, v12
    v_dot2c_f32_bf16 v201, v130, v130
    v_dot2c_f32_bf16 v200, v131, v12
    v_dot2c_f32_bf16 v201, v131, v131
    s_waitcnt vmcnt(20)
    buffer_store_dwordx4 v[132:135], v10, s[48:51], s12 offen offset:1024 sc1
    v_dot2c_f32_bf16 v200, v132, v12
    v_dot2c_f32_bf16 v201, v132, v132
    v_dot2c_f32_bf16 v200, v133, v12
    v_dot2c_f32_bf16 v201, v133, v133
    v_dot2c_f32_bf16 v200, v134, v12
    v_dot2c_f32_bf16 v201, v134, v134
    v_dot2c_f32_bf16 v200, v135, v12
    v_dot2c_f32_bf16 v201, v135, v135
    s_waitcnt vmcnt(20)
    buffer_store_dwordx4 v[136:139], v10, s[48:51], s12 offen offset:2048 sc1
    v_dot2c_f32_bf16 v200, v136, v12
    v_dot2c_f32_bf16 v201, v136, v136
    v_dot2c_f32_bf16 v200, v137, v12
    v_dot2c_f32_bf16 v201, v137, v137
    v_dot2c_f32_bf16 v200, v138, v12
    v_dot2c_f32_bf16 v201, v138, v138
    v_dot2c_f32_bf16 v200, v139, v12
    v_dot2c_f32_bf16 v201, v139, v139
    s_waitcnt vmcnt(20)
    buffer_store_dwordx4 v[140:143], v10, s[48:51], s12 offen offset:3072 sc1
    v_dot2c_f32_bf16 v200, v140, v12
    v_dot2c_f32_bf16 v201, v140, v140
    v_dot2c_f32_bf16 v200, v141, v12
    v_dot2c_f32_bf16 v201, v141, v141
    v_dot2c_f32_bf16 v200, v142, v12
    v_dot2c_f32_bf16 v201, v142, v142
    v_dot2c_f32_bf16 v200, v143, v12
    v_dot2c_f32_bf16 v201, v143, v143
    s_add_u32 s12, s12, 4096
    s_waitcnt vmcnt(20)
    buffer_store_dwordx4 v[144:147], v10, s[48:51], s12 offen offset:0 sc1
    v_dot2c_f32_bf16 v200, v144, v12
    v_dot2c_f32_bf16 v201, v144, v144
    v_dot2c_f32_bf16 v200, v145, v12
    v_dot2c_f32_bf16 v201, v145, v145
    v_dot2c_f32_bf16 v200, v146, v12
    v_dot2c_f32_bf16 v201, v146, v146
    v_dot2c_f32_bf16 v200, v147, v12
    v_dot2c_f32_bf16 v201, v147, v147
    s_waitcnt vmcnt(20)
    buffer_store_dwordx4 v[148:151], v10, s[48:51], s12 offen offset:1024 sc1
    v_dot2c_f32_bf16 v200, v148, v12
    v_dot2c_f32_bf16 v201, v148, v148
    v_dot2c_f32_bf16 v200, v149, v12
    v_dot2c_f32_bf16 v201, v149, v149
    v_dot2c_f32_bf16 v200, v150, v12
    v_dot2c_f32_bf16 v201, v150, v150
    v_dot2c_f32_bf16 v200, v151, v12
    v_dot2c_f32_bf16 v201, v151, v151
    s_waitcnt vmcnt(20)
    buffer_store_dwordx4 v[152:155], v10, s[48:51], s12 offen offset:2048 sc1
    v_dot2c_f32_bf16 v200, v152, v12
    v_dot2c_f32_bf16 v201, v152, v152
    v_dot2c_f32_bf16 v200, v153, v12
    v_dot2c_f32_bf16 v201, v153, v153
    v_dot2c_f32_bf16 v200, v154, v12
    v_dot2c_f32_bf16 v201, v154, v154
    v_dot2c_f32_bf16 v200, v155, v12
    v_dot2c_f32_bf16 v201, v155, v155
    s_waitcnt vmcnt(20)
    buffer_store_dwordx4 v[156:159], v10, s[48:51], s12 offen offset:3072 sc1
    v_dot2c_f32_bf16 v200, v156, v12
    v_dot2c_f32_bf16 v201, v156, v156
    v_dot2c_f32_bf16 v200, v157, v12
    v_dot2c_f32_bf16 v201, v157, v157
    v_dot2c_f32_bf16 v200, v158, v12
    v_dot2c_f32_bf16 v201, v158, v158
    v_dot2c_f32_bf16 v200, v159, v12
    v_dot2c_f32_bf16 v201, v159, v159
    s_nop 1
    v_mov_b32 v205, v200
    s_nop 1
    v_permlane16_swap_b32 v200, v205
    v_add_f32 v200, v200, v205
    v_mov_b32 v205, v200
    s_nop 1
    v_permlane32_swap_b32 v200, v205
    v_add_f32 v200, v200, v205
    v_mov_b32 v205, v201
    s_nop 1
    v_permlane16_swap_b32 v201, v205
    v_add_f32 v201, v201, v205
    v_mov_b32 v205, v201
    s_nop 1
    v_permlane32_swap_b32 v201, v205
    v_add_f32 v201, v201, v205
    v_mul_f32 v200, 0x3acccccd, v200
    v_mul_f32 v201, 0x3acccccd, v201
    v_fma_f32 v201, -v200, v200, v201
    v_max_f32 v201, 0, v201
    v_add_f32 v201, 0x3727c5ac, v201
    v_rsq_f32 v203, v201
    s_nop 0
    v_mul_f32 v202, v200, v203
    s_lshl_b32 s57, s62, 7
    s_add_u32 s57, s57, s63
    s_add_u32 s12, s57, 3145728
    v_lshlrev_b32 v205, 3, v1
    s_mov_b32 exec_lo, 0xffff
    s_mov_b32 exec_hi, 0
    buffer_store_dwordx2 v[202:203], v205, s[48:51], s12 offen sc1
    s_mov_b64 exec, -1
    s_add_u32 s12, s57, 1310720
    s_waitcnt vmcnt(0)
    s_mov_b64 exec, 0x1
    buffer_store_dwordx2 v[246:247], v1, s[44:47], s12 offen sc1
    s_mov_b64 exec, -1
    v_lshrrev_b32 v8, 1, v1
    v_lshlrev_b32 v8, 4, v8
    v_and_b32 v9, 1, v1
    s_lshr_b32 s10, s5, 2
    s_lshl_b32 s10, s10, 1
    v_add3_u32 v8, v8, v9, s10
    s_lshl_b32 s10, s3, 3
    s_add_u32 s10, s10, 56
    v_add_u32 v9, s10, v1
    v_cmp_gt_u32 vcc, 8, v1
    s_nop 1
    v_cndmask_b32 v8, v9, v8, vcc
    v_lshlrev_b32 v8, 7, v8
    v_add_u32 v8, 1196032, v8
    s_mov_b32 exec_lo, 0xffff
    s_mov_b32 exec_hi, 0
    buffer_load_dwordx2 v[12:13], v8, s[44:47], 0 offen sc1
    s_mov_b64 exec, -1
    s_waitcnt vmcnt(0)
    v_mov_b32 v12, v12
    s_mov_b32 exec_lo, 0xffff
    s_mov_b32 exec_hi, 0
    v_cmp_eq_u64 vcc, s[100:101], v[12:13]
    s_nop 0
    s_cmp_eq_u64 vcc, exec
    s_mov_b64 exec, -1
    s_cbranch_scc1 interleave_layers__ssm_conv_h3__swiglu_ffn__prompt_kernel_ok13
    s_mov_b32 s23, 0
interleave_layers__ssm_conv_h3__swiglu_ffn__prompt_kernel_spin14:
    s_sleep 1
    s_mov_b32 exec_lo, 0xffff
    s_mov_b32 exec_hi, 0
    buffer_load_dwordx2 v[12:13], v8, s[44:47], 0 offen sc1
    s_mov_b64 exec, -1
    s_waitcnt vmcnt(0)
    s_add_u32 s23, s23, 1
    s_cmp_ge_u32 s23, 262144
    s_cbranch_scc1 interleave_layers__ssm_conv_h3__swiglu_ffn__prompt_kernel_ok13
    v_mov_b32 v12, v12
    s_mov_b32 exec_lo, 0xffff
    s_mov_b32 exec_hi, 0
    v_cmp_eq_u64 vcc, s[100:101], v[12:13]
    s_nop 0
    s_cmp_eq_u64 vcc, exec
    s_mov_b64 exec, -1
    s_cbranch_scc0 interleave_layers__ssm_conv_h3__swiglu_ffn__prompt_kernel_spin14
    s_nop 0
interleave_layers__ssm_conv_h3__swiglu_ffn__prompt_kernel_ok13:
    s_add_u32 m0, s18, 0
    s_add_u32 s11, s19, 0
    buffer_load_dwordx4 v10, s[32:35], s11 offen offset:0 sc1 lds
    buffer_load_dwordx4 v10, s[32:35], s11 offen offset:1024 sc1 lds
    buffer_load_dwordx4 v10, s[32:35], s11 offen offset:2048 sc1 lds
    s_add_u32 m0, s18, 12288
    s_add_u32 s11, s19, 12288
    buffer_load_dwordx4 v10, s[32:35], s11 offen offset:0 sc1 lds
    buffer_load_dwordx4 v10, s[32:35], s11 offen offset:1024 sc1 lds
    buffer_load_dwordx4 v10, s[32:35], s11 offen offset:2048 sc1 lds
    s_add_u32 m0, s18, 24576
    s_add_u32 s11, s19, 24576
    buffer_load_dwordx4 v10, s[32:35], s11 offen offset:0 sc1 lds
    buffer_load_dwordx4 v10, s[32:35], s11 offen offset:1024 sc1 lds
    buffer_load_dwordx4 v10, s[32:35], s11 offen offset:2048 sc1 lds
    s_add_u32 m0, s18, 36864
    s_add_u32 s11, s19, 36864
    buffer_load_dwordx4 v10, s[32:35], s11 offen offset:0 sc1 lds
    buffer_load_dwordx4 v10, s[32:35], s11 offen offset:1024 sc1 lds
    buffer_load_dwordx4 v10, s[32:35], s11 offen offset:2048 sc1 lds
    s_add_u32 m0, s18, 49152
    s_add_u32 s11, s19, 49152
    buffer_load_dwordx4 v10, s[32:35], s11 offen offset:0 sc1 lds
    buffer_load_dwordx4 v10, s[32:35], s11 offen offset:1024 sc1 lds
    buffer_load_dwordx4 v10, s[32:35], s11 offen offset:2048 sc1 lds
    s_add_u32 m0, s18, 61440
    s_add_u32 s11, s19, 61440
    buffer_load_dwordx4 v10, s[32:35], s11 offen offset:0 sc1 lds
    buffer_load_dwordx4 v10, s[32:35], s11 offen offset:1024 sc1 lds
    buffer_load_dwordx4 v10, s[32:35], s11 offen offset:2048 sc1 lds
    s_add_u32 m0, s18, 73728
    s_add_u32 s11, s19, 73728
    buffer_load_dwordx4 v10, s[32:35], s11 offen offset:0 sc1 lds
    buffer_load_dwordx4 v10, s[32:35], s11 offen offset:1024 sc1 lds
    buffer_load_dwordx4 v10, s[32:35], s11 offen offset:2048 sc1 lds
    s_add_u32 m0, s18, 86016
    s_add_u32 s11, s19, 86016
    buffer_load_dwordx4 v10, s[32:35], s11 offen offset:0 sc1 lds
    buffer_load_dwordx4 v10, s[32:35], s11 offen offset:1024 sc1 lds
    buffer_load_dwordx4 v10, s[32:35], s11 offen offset:2048 sc1 lds
    s_add_u32 m0, s18, 98304
    s_add_u32 s11, s19, 98304
    buffer_load_dwordx4 v10, s[32:35], s11 offen offset:0 sc1 lds
    buffer_load_dwordx4 v10, s[32:35], s11 offen offset:1024 sc1 lds
    buffer_load_dwordx4 v10, s[32:35], s11 offen offset:2048 sc1 lds
    s_add_u32 m0, s18, 110592
    s_add_u32 s11, s19, 110592
    buffer_load_dwordx4 v10, s[32:35], s11 offen offset:0 sc1 lds
    buffer_load_dwordx4 v10, s[32:35], s11 offen offset:1024 sc1 lds
    buffer_load_dwordx4 v10, s[32:35], s11 offen offset:2048 sc1 lds
    s_add_u32 s11, s20, 0
    buffer_load_dwordx4 a[0:3], v10, s[40:43], s11 offen offset:0 sc1
    s_add_u32 s11, s20, 0
    buffer_load_dwordx4 a[4:7], v10, s[40:43], s11 offen offset:1024 sc1
    s_add_u32 s11, s21, 0
    buffer_load_dwordx4 a[8:11], v10, s[40:43], s11 offen offset:0 sc1
    s_add_u32 s11, s21, 0
    buffer_load_dwordx4 a[12:15], v10, s[40:43], s11 offen offset:1024 sc1
    s_add_u32 s11, s22, 0
    buffer_load_dwordx4 a[16:19], v10, s[40:43], s11 offen offset:0 sc1
    s_add_u32 s11, s20, 5120
    buffer_load_dwordx4 a[20:23], v10, s[40:43], s11 offen offset:0 sc1
    s_add_u32 s11, s20, 5120
    buffer_load_dwordx4 a[24:27], v10, s[40:43], s11 offen offset:1024 sc1
    s_add_u32 s11, s21, 5120
    buffer_load_dwordx4 a[28:31], v10, s[40:43], s11 offen offset:0 sc1
    s_add_u32 s11, s21, 5120
    buffer_load_dwordx4 a[32:35], v10, s[40:43], s11 offen offset:1024 sc1
    s_add_u32 s11, s22, 5120
    buffer_load_dwordx4 a[36:39], v10, s[40:43], s11 offen offset:0 sc1
    s_add_u32 s11, s20, 10240
    buffer_load_dwordx4 a[40:43], v10, s[40:43], s11 offen offset:0 sc1
    s_add_u32 s11, s20, 10240
    buffer_load_dwordx4 a[44:47], v10, s[40:43], s11 offen offset:1024 sc1
    s_add_u32 s11, s21, 10240
    buffer_load_dwordx4 a[48:51], v10, s[40:43], s11 offen offset:0 sc1
    s_add_u32 s11, s21, 10240
    buffer_load_dwordx4 a[52:55], v10, s[40:43], s11 offen offset:1024 sc1
    s_add_u32 s11, s22, 10240
    buffer_load_dwordx4 a[56:59], v10, s[40:43], s11 offen offset:0 sc1
    s_add_u32 s11, s20, 15360
    buffer_load_dwordx4 a[60:63], v10, s[40:43], s11 offen offset:0 sc1
    s_add_u32 s11, s20, 15360
    buffer_load_dwordx4 a[64:67], v10, s[40:43], s11 offen offset:1024 sc1
    s_add_u32 s11, s21, 15360
    buffer_load_dwordx4 a[68:71], v10, s[40:43], s11 offen offset:0 sc1
    s_add_u32 s11, s21, 15360
    buffer_load_dwordx4 a[72:75], v10, s[40:43], s11 offen offset:1024 sc1
    s_add_u32 s11, s22, 15360
    buffer_load_dwordx4 a[76:79], v10, s[40:43], s11 offen offset:0 sc1
    s_add_u32 s11, s20, 20480
    buffer_load_dwordx4 a[80:83], v10, s[40:43], s11 offen offset:0 sc1
    s_add_u32 s11, s20, 20480
    buffer_load_dwordx4 a[84:87], v10, s[40:43], s11 offen offset:1024 sc1
    s_add_u32 s11, s21, 20480
    buffer_load_dwordx4 a[88:91], v10, s[40:43], s11 offen offset:0 sc1
    s_add_u32 s11, s21, 20480
    buffer_load_dwordx4 a[92:95], v10, s[40:43], s11 offen offset:1024 sc1
    s_add_u32 s11, s22, 20480
    buffer_load_dwordx4 a[96:99], v10, s[40:43], s11 offen offset:0 sc1
    s_add_u32 s11, s20, 25600
    buffer_load_dwordx4 a[100:103], v10, s[40:43], s11 offen offset:0 sc1
    s_add_u32 s11, s20, 25600
    buffer_load_dwordx4 a[104:107], v10, s[40:43], s11 offen offset:1024 sc1
    s_add_u32 s11, s21, 25600
    buffer_load_dwordx4 a[108:111], v10, s[40:43], s11 offen offset:0 sc1
    s_add_u32 s11, s21, 25600
    buffer_load_dwordx4 a[112:115], v10, s[40:43], s11 offen offset:1024 sc1
    s_add_u32 s11, s22, 25600
    buffer_load_dwordx4 a[116:119], v10, s[40:43], s11 offen offset:0 sc1
    s_add_u32 s11, s20, 30720
    buffer_load_dwordx4 a[120:123], v10, s[40:43], s11 offen offset:0 sc1
    s_add_u32 s11, s20, 30720
    buffer_load_dwordx4 a[124:127], v10, s[40:43], s11 offen offset:1024 sc1
    s_add_u32 s11, s21, 30720
    buffer_load_dwordx4 a[128:131], v10, s[40:43], s11 offen offset:0 sc1
    s_add_u32 s11, s21, 30720
    buffer_load_dwordx4 a[132:135], v10, s[40:43], s11 offen offset:1024 sc1
    s_add_u32 s11, s22, 30720
    buffer_load_dwordx4 a[136:139], v10, s[40:43], s11 offen offset:0 sc1
    s_add_u32 s11, s20, 35840
    buffer_load_dwordx4 a[140:143], v10, s[40:43], s11 offen offset:0 sc1
    s_add_u32 s11, s20, 35840
    buffer_load_dwordx4 a[144:147], v10, s[40:43], s11 offen offset:1024 sc1
    s_add_u32 s11, s21, 35840
    buffer_load_dwordx4 a[148:151], v10, s[40:43], s11 offen offset:0 sc1
    s_add_u32 s11, s21, 35840
    buffer_load_dwordx4 a[152:155], v10, s[40:43], s11 offen offset:1024 sc1
    s_add_u32 s11, s22, 35840
    buffer_load_dwordx4 a[156:159], v10, s[40:43], s11 offen offset:0 sc1
main_join:
    s_load_dwordx2 s[26:27], s[0:1], 80
    v_add_u32 v11, 61440, v10
    s_add_u32 s28, s24, 15728640
    s_addc_u32 s29, s25, 0
    s_mov_b32 s30, 17301504
    s_mov_b32 s31, 0x00020000
    s_add_u32 s36, s24, 18874368
    s_addc_u32 s37, s25, 0
    s_mov_b32 s38, 20971520
    s_mov_b32 s39, 0x00020000
    s_add_u32 s52, s24, 12582912
    s_addc_u32 s53, s25, 0
    s_mov_b32 s54, 2621440
    s_mov_b32 s55, 0x00020000
    s_mul_i32 s56, s15, 49152
    s_mul_i32 s10, s5, 1536
    s_add_u32 s56, s56, s10
    s_mul_i32 s10, s3, 12288
    s_mul_i32 s57, s16, 49152
    s_add_u32 s57, s57, s10
    s_xor_b32 s11, s16, 1
    s_mul_i32 s58, s11, 49152
    s_add_u32 s58, s58, s10
    s_mul_i32 s59, s16, 20480
    s_mul_i32 s10, s8, 2560
    s_add_u32 s59, s59, s10
    v_and_b32 v204, 1, v3
    v_lshrrev_b32 v205, 1, v3
    v_mul_u32_u24 v8, 49152, v204
    v_lshlrev_b32 v206, 4, v2
    v_lshl_add_u32 v206, v205, 8, v206
    v_add_u32 v8, v8, v206
    v_lshl_add_u32 v9, v204, 3, v206
    s_lshl_b32 s10, s14, 31
    v_or_b32 v12, s10, v9
    s_lshl_b32 s10, s16, 4
    v_add_u32 v13, s10, v2
    v_lshlrev_b32 v15, 3, v2
    v_cmp_eq_u32 vcc, 0, v3
    v_mov_b32 v204, 0x80000000
    s_nop 0
    v_cndmask_b32 v14, v204, v15, vcc
    v_lshl_add_u32 v0, v3, 7, v15
    v_lshl_add_u32 v15, v3, 9, v15
    v_cmp_eq_u32 vcc, 0, v1
    s_nop 1
    v_cndmask_b32 v252, v204, v1, vcc
    s_lshl_b32 s10, s4, 3
    s_add_u32 s10, s10, s7
    s_lshl_b32 s10, s10, 5
    s_lshl_b32 s11, s3, 3
    s_add_u32 s10, s10, s11
    v_and_b32 v253, 7, v1
    v_add_u32 v253, s10, v253
    v_lshlrev_b32 v253, 7, v253
    v_lshlrev_b32 v250, 4, v2
    v_lshl_add_u32 v250, v3, 9, v250
    s_lshr_b32 s10, s16, 1
    s_mul_i32 s62, s10, 40960
    s_mul_i32 s10, s8, 5120
    s_add_u32 s62, s62, s10
    s_lshl_b32 s10, s9, 3
    s_add_u32 s62, s62, s10
    s_lshr_b32 s10, s5, 2
    s_lshl_b32 s11, s4, 3
    s_add_u32 s63, s10, s11
    s_mul_i32 s60, s63, 40960
    s_mul_i32 s10, s3, 10240
    s_add_u32 s60, s60, s10
    s_and_b32 s61, s5, 3
    s_lshl_b32 s10, s61, 6
    s_add_u32 s60, s60, s10
    v_and_b32 v188, 3, v1
    v_lshrrev_b32 v189, 2, v1
    v_lshlrev_b32 v189, 8, v189
    v_lshl_add_u32 v189, v188, 4, v189
    v_cmp_gt_u32 vcc, 32, v1
    s_nop 1
    v_cndmask_b32 v190, v204, v189, vcc
    s_lshl_b32 s10, s5, 11
    s_add_u32 s10, s10, 8388608
    v_lshlrev_b32 v197, 3, v1
    buffer_load_dwordx2 v[208:209], v197, s[48:51], s10 offen offset:0 sc1
    buffer_load_dwordx2 v[210:211], v197, s[48:51], s10 offen offset:512 sc1
    buffer_load_dwordx2 v[212:213], v197, s[48:51], s10 offen offset:1024 sc1
    buffer_load_dwordx2 v[214:215], v197, s[48:51], s10 offen offset:1536 sc1
    s_waitcnt lgkmcnt(0)
    s_mov_b32 s48, s26
    s_mov_b32 s49, s27
    s_mov_b32 s50, 2621440
    s_mov_b32 s51, 0x00020000
    s_mul_i32 s10, s4, 160
    s_mul_i32 s11, s3, 40
    s_add_u32 s10, s10, s11
    s_lshl_b32 s10, s10, 7
    s_add_u32 s10, s10, 1376256
    s_mul_i32 s11, s3, 3072
    s_add_u32 s11, s11, 1190912
    v_mov_b32 v205, s10
    v_mov_b32 v206, s11
    v_cmp_gt_u32 vcc, 40, v1
    s_nop 1
    v_cndmask_b32 v205, v206, v205, vcc
    v_lshl_add_u32 v205, v1, 7, v205
    v_add_u32 v197, 122880, v197
    s_waitcnt vmcnt(2)
    v_pk_add_f32 v[208:209], v[208:209], v[210:211]
    s_waitcnt vmcnt(0)
    v_pk_add_f32 v[212:213], v[212:213], v[214:215]
    v_pk_add_f32 v[208:209], v[208:209], v[212:213]
    s_cmp_ge_u32 s2, 96
    s_cbranch_scc1 main_nogate
    s_mov_b64 exec, 0x1
    buffer_load_dwordx2 v[206:207], v205, s[44:47], 0 offen sc1
    s_mov_b64 exec, -1
    s_waitcnt vmcnt(0)
    v_mov_b32 v206, v206
    s_mov_b64 exec, 0x1
    v_cmp_eq_u64 vcc, s[100:101], v[206:207]
    s_nop 0
    s_cmp_eq_u64 vcc, exec
    s_mov_b64 exec, -1
    s_cbranch_scc1 interleave_layers__ssm_conv_h3__swiglu_ffn__prompt_kernel_ok15
    s_mov_b32 s23, 0
interleave_layers__ssm_conv_h3__swiglu_ffn__prompt_kernel_spin16:
    s_sleep 6
    s_mov_b64 exec, 0x1
    buffer_load_dwordx2 v[206:207], v205, s[44:47], 0 offen sc1
    s_mov_b64 exec, -1
    s_waitcnt vmcnt(0)
    s_add_u32 s23, s23, 1
    s_cmp_ge_u32 s23, 262144
    s_cbranch_scc1 interleave_layers__ssm_conv_h3__swiglu_ffn__prompt_kernel_ok15
    v_mov_b32 v206, v206
    s_mov_b64 exec, 0x1
    v_cmp_eq_u64 vcc, s[100:101], v[206:207]
    s_nop 0
    s_cmp_eq_u64 vcc, exec
    s_mov_b64 exec, -1
    s_cbranch_scc0 interleave_layers__ssm_conv_h3__swiglu_ffn__prompt_kernel_spin16
    s_nop 0
interleave_layers__ssm_conv_h3__swiglu_ffn__prompt_kernel_ok15:
    s_nop 0
main_nogate:
    buffer_load_dwordx2 v[206:207], v205, s[44:47], 0 offen sc1
    s_waitcnt vmcnt(0)
    v_cmp_eq_u64 vcc, s[100:101], v[206:207]
    s_nop 0
    s_cmp_eq_u64 vcc, -1
    s_cbranch_scc1 interleave_layers__ssm_conv_h3__swiglu_ffn__prompt_kernel_ok17
    s_mov_b32 s23, 0
interleave_layers__ssm_conv_h3__swiglu_ffn__prompt_kernel_spin18:
    s_sleep 1
    buffer_load_dwordx2 v[206:207], v205, s[44:47], 0 offen sc1
    s_waitcnt vmcnt(0)
    s_add_u32 s23, s23, 1
    s_cmp_ge_u32 s23, 262144
    s_cbranch_scc1 interleave_layers__ssm_conv_h3__swiglu_ffn__prompt_kernel_ok17
    v_cmp_eq_u64 vcc, s[100:101], v[206:207]
    s_nop 0
    s_cmp_eq_u64 vcc, -1
    s_cbranch_scc0 interleave_layers__ssm_conv_h3__swiglu_ffn__prompt_kernel_spin18
    s_nop 1
interleave_layers__ssm_conv_h3__swiglu_ffn__prompt_kernel_ok17:
    s_barrier
    ds_write_b64 v197, v[208:209]
    s_add_u32 s10, s17, 0
    buffer_load_dwordx4 v[16:19], v250, s[28:31], s10 offen offset:0 sc1
    buffer_load_dwordx4 v[20:23], v250, s[28:31], s10 offen offset:256 sc1
    s_add_u32 s10, s17, 2048
    buffer_load_dwordx4 v[24:27], v250, s[28:31], s10 offen offset:0 sc1
    buffer_load_dwordx4 v[28:31], v250, s[28:31], s10 offen offset:256 sc1
    s_add_u32 s10, s17, 4096
    buffer_load_dwordx4 v[32:35], v250, s[28:31], s10 offen offset:0 sc1
    buffer_load_dwordx4 v[36:39], v250, s[28:31], s10 offen offset:256 sc1
    s_add_u32 s10, s17, 6144
    buffer_load_dwordx4 v[40:43], v250, s[28:31], s10 offen offset:0 sc1
    buffer_load_dwordx4 v[44:47], v250, s[28:31], s10 offen offset:256 sc1
    s_add_u32 s12, s60, 0
    buffer_load_dwordx4 v[192:195], v189, s[28:31], s12 offen sc1
    s_add_u32 s12, s60, 4096
    buffer_load_dwordx4 v[196:199], v189, s[28:31], s12 offen sc1
    s_add_u32 s12, s60, 8192
    buffer_load_dwordx4 v[200:203], v190, s[28:31], s12 offen sc1
    s_add_u32 s10, s17, 8192
    buffer_load_dwordx4 v[48:51], v250, s[28:31], s10 offen offset:0 sc1
    buffer_load_dwordx4 v[52:55], v250, s[28:31], s10 offen offset:256 sc1
    s_add_u32 s10, s17, 10240
    buffer_load_dwordx4 v[56:59], v250, s[28:31], s10 offen offset:0 sc1
    buffer_load_dwordx4 v[60:63], v250, s[28:31], s10 offen offset:256 sc1
    s_add_u32 s10, s17, 12288
    buffer_load_dwordx4 v[64:67], v250, s[28:31], s10 offen offset:0 sc1
    buffer_load_dwordx4 v[68:71], v250, s[28:31], s10 offen offset:256 sc1
    s_add_u32 s10, s17, 14336
    buffer_load_dwordx4 v[72:75], v250, s[28:31], s10 offen offset:0 sc1
    buffer_load_dwordx4 v[76:79], v250, s[28:31], s10 offen offset:256 sc1
    s_lshl_b32 s10, s3, 13
    s_add_u32 s10, s10, 131072
    v_add_u32 v249, s10, v10
    s_cmp_eq_u32 s14, 0
    s_cselect_b32 s26, 1.0, 0
    s_mov_b32 s27, s26
    s_lshl_b32 s60, s16, 4
    s_lshl_b32 s13, s8, 1
    s_add_u32 s60, s60, s13
    s_add_u32 s60, s60, s14
    s_lshl_b32 s60, s60, 7
    ds_read_b128 v[160:163], v10 offset:0
    ds_read_b128 v[164:167], v10 offset:1024
    ds_read_b128 v[168:171], v10 offset:2048
    ds_read_b128 v[172:175], v10 offset:3072
    ds_read_b128 v[176:179], v10 offset:4096
    ds_read_b128 v[180:183], v10 offset:5120
    s_waitcnt vmcnt(17)
    v_swap_b32 v18, v20
    v_swap_b32 v19, v21
    s_waitcnt lgkmcnt(5)
    s_nop 0
    v_mfma_f32_16x16x32_bf16 v[112:115], v[160:163], v[16:19], 0
    s_add_u32 m0, s18, 73728
    s_add_u32 s11, s19, 73728
    buffer_load_dwordx4 v10, s[32:35], s11 offen offset:0 sc1 lds
    s_waitcnt lgkmcnt(4)
    v_mfma_f32_16x16x32_bf16 v[116:119], v[160:163], v[20:23], 0
    ds_read_b128 v[160:163], v10 offset:6144
    v_mfma_f32_16x16x32_bf16 v[120:123], v[164:167], v[16:19], 0
    buffer_load_dwordx4 v10, s[32:35], s11 offen offset:1024 sc1 lds
    s_waitcnt lgkmcnt(4)
    v_mfma_f32_16x16x32_bf16 v[124:127], v[164:167], v[20:23], 0
    ds_read_b128 v[164:167], v10 offset:7168
    v_mfma_f32_16x16x32_bf16 v[128:131], v[168:171], v[16:19], 0
    buffer_load_dwordx4 v10, s[32:35], s11 offen offset:2048 sc1 lds
    s_waitcnt lgkmcnt(4)
    v_mfma_f32_16x16x32_bf16 v[132:135], v[168:171], v[20:23], 0
    ds_read_b128 v[168:171], v10 offset:8192
    v_mfma_f32_16x16x32_bf16 v[136:139], v[172:175], v[16:19], 0
    s_waitcnt lgkmcnt(4)
    v_mfma_f32_16x16x32_bf16 v[140:143], v[172:175], v[20:23], 0
    s_add_u32 s10, s17, 16384
    s_waitcnt vmcnt(18)
    v_swap_b32 v26, v28
    v_swap_b32 v27, v29
    ds_read_b128 v[172:175], v10 offset:9216
    v_mfma_f32_16x16x32_bf16 v[144:147], v[176:179], v[16:19], 0
    buffer_load_dwordx4 v[80:83], v250, s[28:31], s10 offen offset:0 sc1
    s_waitcnt lgkmcnt(4)
    v_mfma_f32_16x16x32_bf16 v[148:151], v[176:179], v[20:23], 0
    ds_read_b128 v[176:179], v10 offset:10240
    v_mfma_f32_16x16x32_bf16 v[152:155], v[180:183], v[16:19], 0
    buffer_load_dwordx4 v[84:87], v250, s[28:31], s10 offen offset:256 sc1
    s_waitcnt lgkmcnt(4)
    v_mfma_f32_16x16x32_bf16 v[156:159], v[180:183], v[20:23], 0
    ds_read_b128 v[180:183], v10 offset:11264
    v_mfma_f32_16x16x32_bf16 v[112:115], v[160:163], v[24:27], v[112:115]
    s_add_u32 m0, s18, 86016
    s_add_u32 s11, s19, 86016
    buffer_load_dwordx4 v10, s[32:35], s11 offen offset:0 sc1 lds
    s_waitcnt lgkmcnt(4)
    v_mfma_f32_16x16x32_bf16 v[116:119], v[160:163], v[28:31], v[116:119]
    ds_read_b128 v[160:163], v10 offset:12288
    v_mfma_f32_16x16x32_bf16 v[120:123], v[164:167], v[24:27], v[120:123]
    buffer_load_dwordx4 v10, s[32:35], s11 offen offset:1024 sc1 lds
    s_waitcnt lgkmcnt(4)
    v_mfma_f32_16x16x32_bf16 v[124:127], v[164:167], v[28:31], v[124:127]
    ds_read_b128 v[164:167], v10 offset:13312
    v_mfma_f32_16x16x32_bf16 v[128:131], v[168:171], v[24:27], v[128:131]
    buffer_load_dwordx4 v10, s[32:35], s11 offen offset:2048 sc1 lds
    s_waitcnt lgkmcnt(4)
    v_mfma_f32_16x16x32_bf16 v[132:135], v[168:171], v[28:31], v[132:135]
    ds_read_b128 v[168:171], v10 offset:14336
    v_mfma_f32_16x16x32_bf16 v[136:139], v[172:175], v[24:27], v[136:139]
    s_waitcnt lgkmcnt(4)
    v_mfma_f32_16x16x32_bf16 v[140:143], v[172:175], v[28:31], v[140:143]
    s_add_u32 s10, s17, 18432
    s_waitcnt vmcnt(21)
    v_swap_b32 v34, v36
    v_swap_b32 v35, v37
    ds_read_b128 v[172:175], v10 offset:15360
    v_mfma_f32_16x16x32_bf16 v[144:147], v[176:179], v[24:27], v[144:147]
    buffer_load_dwordx4 v[88:91], v250, s[28:31], s10 offen offset:0 sc1
    s_waitcnt lgkmcnt(4)
    v_mfma_f32_16x16x32_bf16 v[148:151], v[176:179], v[28:31], v[148:151]
    ds_read_b128 v[176:179], v10 offset:16384
    v_mfma_f32_16x16x32_bf16 v[152:155], v[180:183], v[24:27], v[152:155]
    buffer_load_dwordx4 v[92:95], v250, s[28:31], s10 offen offset:256 sc1
    s_waitcnt lgkmcnt(4)
    v_mfma_f32_16x16x32_bf16 v[156:159], v[180:183], v[28:31], v[156:159]
    ds_read_b128 v[180:183], v10 offset:17408
    v_mfma_f32_16x16x32_bf16 v[112:115], v[160:163], v[32:35], v[112:115]
    s_waitcnt vmcnt(20)
    v_lshlrev_b32 v204, 16, v192
    v_and_b32 v205, 0xffff0000, v192
    v_add_f32 v184, v204, v205
    v_mul_f32 v185, v204, v204
    v_fmac_f32 v185, v205, v205
    v_lshlrev_b32 v204, 16, v193
    v_and_b32 v205, 0xffff0000, v193
    v_add_f32 v184, v184, v204
    v_add_f32 v184, v184, v205
    v_fmac_f32 v185, v204, v204
    v_fmac_f32 v185, v205, v205
    s_waitcnt vmcnt(19)
    v_lshlrev_b32 v204, 16, v196
    v_and_b32 v205, 0xffff0000, v196
    v_add_f32 v184, v184, v204
    v_add_f32 v184, v184, v205
    v_fmac_f32 v185, v204, v204
    v_fmac_f32 v185, v205, v205
    v_lshlrev_b32 v204, 16, v197
    v_and_b32 v205, 0xffff0000, v197
    v_add_f32 v184, v184, v204
    v_add_f32 v184, v184, v205
    v_fmac_f32 v185, v204, v204
    v_fmac_f32 v185, v205, v205
    s_waitcnt vmcnt(18)
    v_lshlrev_b32 v204, 16, v200
    v_and_b32 v205, 0xffff0000, v200
    v_add_f32 v184, v184, v204
    v_add_f32 v184, v184, v205
    v_fmac_f32 v185, v204, v204
    v_fmac_f32 v185, v205, v205
    v_lshlrev_b32 v204, 16, v201
    v_and_b32 v205, 0xffff0000, v201
    v_add_f32 v184, v184, v204
    v_add_f32 v184, v184, v205
    v_fmac_f32 v185, v204, v204
    v_fmac_f32 v185, v205, v205
    v_lshlrev_b32 v204, 16, v194
    v_and_b32 v205, 0xffff0000, v194
    v_add_f32 v186, v204, v205
    v_mul_f32 v187, v204, v204
    v_fmac_f32 v187, v205, v205
    v_lshlrev_b32 v204, 16, v195
    v_and_b32 v205, 0xffff0000, v195
    v_add_f32 v186, v186, v204
    v_add_f32 v186, v186, v205
    v_fmac_f32 v187, v204, v204
    v_fmac_f32 v187, v205, v205
    v_lshlrev_b32 v204, 16, v198
    v_and_b32 v205, 0xffff0000, v198
    v_add_f32 v186, v186, v204
    v_add_f32 v186, v186, v205
    v_fmac_f32 v187, v204, v204
    v_fmac_f32 v187, v205, v205
    v_lshlrev_b32 v204, 16, v199
    v_and_b32 v205, 0xffff0000, v199
    v_add_f32 v186, v186, v204
    v_add_f32 v186, v186, v205
    v_fmac_f32 v187, v204, v204
    v_fmac_f32 v187, v205, v205
    v_lshlrev_b32 v204, 16, v202
    v_and_b32 v205, 0xffff0000, v202
    v_add_f32 v186, v186, v204
    v_add_f32 v186, v186, v205
    v_fmac_f32 v187, v204, v204
    v_fmac_f32 v187, v205, v205
    v_lshlrev_b32 v204, 16, v203
    v_and_b32 v205, 0xffff0000, v203
    v_add_f32 v186, v186, v204
    v_add_f32 v186, v186, v205
    v_fmac_f32 v187, v204, v204
    v_fmac_f32 v187, v205, v205
    v_add_f32_dpp v184, v184, v184 row_ror:4 row_mask:0xf bank_mask:0xf
    v_add_f32_dpp v185, v185, v185 row_ror:4 row_mask:0xf bank_mask:0xf
    v_add_f32_dpp v186, v186, v186 row_ror:4 row_mask:0xf bank_mask:0xf
    v_add_f32_dpp v187, v187, v187 row_ror:4 row_mask:0xf bank_mask:0xf
    v_add_f32_dpp v184, v184, v184 row_ror:8 row_mask:0xf bank_mask:0xf
    v_add_f32_dpp v185, v185, v185 row_ror:8 row_mask:0xf bank_mask:0xf
    v_add_f32_dpp v186, v186, v186 row_ror:8 row_mask:0xf bank_mask:0xf
    v_add_f32_dpp v187, v187, v187 row_ror:8 row_mask:0xf bank_mask:0xf
    v_mov_b32 v204, v184
    s_nop 1
    v_permlane16_swap_b32 v184, v204
    v_add_f32 v184, v184, v204
    v_mov_b32 v204, v184
    s_nop 1
    v_permlane32_swap_b32 v184, v204
    v_add_f32 v184, v184, v204
    v_mov_b32 v204, v185
    s_nop 1
    v_permlane16_swap_b32 v185, v204
    v_add_f32 v185, v185, v204
    v_mov_b32 v204, v185
    s_nop 1
    v_permlane32_swap_b32 v185, v204
    v_add_f32 v185, v185, v204
    v_mov_b32 v204, v186
    s_nop 1
    v_permlane16_swap_b32 v186, v204
    v_add_f32 v186, v186, v204
    v_mov_b32 v204, v186
    s_nop 1
    v_permlane32_swap_b32 v186, v204
    v_add_f32 v186, v186, v204
    v_mov_b32 v204, v187
    s_nop 1
    v_permlane16_swap_b32 v187, v204
    v_add_f32 v187, v187, v204
    v_mov_b32 v204, v187
    s_nop 1
    v_permlane32_swap_b32 v187, v204
    v_add_f32 v187, v187, v204
    v_or_b32 v185, 0x80000000, v185
    v_or_b32 v187, 0x80000000, v187
    s_lshl_b32 s12, s63, 3
    s_add_u32 s12, s12, s3
    s_lshl_b32 s12, s12, 7
    s_lshl_b32 s13, s61, 5
    s_add_u32 s12, s12, s13
    s_add_u32 s12, s12, 0
    v_lshlrev_b32 v204, 3, v1
    s_mov_b64 exec, 0xf
    buffer_store_dwordx2 v[184:185], v204, s[44:47], s12 offen sc1
    buffer_store_dwordx2 v[186:187], v204, s[44:47], s12 offen offset:512 sc1
    s_mov_b64 exec, -1
    s_add_u32 m0, s18, 98304
    s_add_u32 s11, s19, 98304
    buffer_load_dwordx4 v10, s[32:35], s11 offen offset:0 sc1 lds
    s_waitcnt lgkmcnt(4)
    v_mfma_f32_16x16x32_bf16 v[116:119], v[160:163], v[36:39], v[116:119]
    ds_read_b128 v[160:163], v10 offset:18432
    v_mfma_f32_16x16x32_bf16 v[120:123], v[164:167], v[32:35], v[120:123]
    buffer_load_dwordx4 v10, s[32:35], s11 offen offset:1024 sc1 lds
    s_waitcnt lgkmcnt(4)
    v_mfma_f32_16x16x32_bf16 v[124:127], v[164:167], v[36:39], v[124:127]
    ds_read_b128 v[164:167], v10 offset:19456
    v_mfma_f32_16x16x32_bf16 v[128:131], v[168:171], v[32:35], v[128:131]
    buffer_load_dwordx4 v10, s[32:35], s11 offen offset:2048 sc1 lds
    s_waitcnt lgkmcnt(4)
    v_mfma_f32_16x16x32_bf16 v[132:135], v[168:171], v[36:39], v[132:135]
    ds_read_b128 v[168:171], v10 offset:20480
    v_mfma_f32_16x16x32_bf16 v[136:139], v[172:175], v[32:35], v[136:139]
    s_waitcnt lgkmcnt(4)
    v_mfma_f32_16x16x32_bf16 v[140:143], v[172:175], v[36:39], v[140:143]
    s_add_u32 s10, s17, 20480
    v_swap_b32 v42, v44
    v_swap_b32 v43, v45
    ds_read_b128 v[172:175], v10 offset:21504
    v_mfma_f32_16x16x32_bf16 v[144:147], v[176:179], v[32:35], v[144:147]
    buffer_load_dwordx4 v[96:99], v250, s[28:31], s10 offen offset:0 sc1
    s_waitcnt lgkmcnt(4)
    v_mfma_f32_16x16x32_bf16 v[148:151], v[176:179], v[36:39], v[148:151]
    ds_read_b128 v[176:179], v10 offset:22528
    v_mfma_f32_16x16x32_bf16 v[152:155], v[180:183], v[32:35], v[152:155]
    buffer_load_dwordx4 v[100:103], v250, s[28:31], s10 offen offset:256 sc1
    s_waitcnt lgkmcnt(4)
    v_mfma_f32_16x16x32_bf16 v[156:159], v[180:183], v[36:39], v[156:159]
    ds_read_b128 v[180:183], v10 offset:23552
    v_mfma_f32_16x16x32_bf16 v[112:115], v[160:163], v[40:43], v[112:115]
    s_add_u32 m0, s18, 110592
    s_add_u32 s11, s19, 110592
    buffer_load_dwordx4 v10, s[32:35], s11 offen offset:0 sc1 lds
    s_waitcnt lgkmcnt(4)
    v_mfma_f32_16x16x32_bf16 v[116:119], v[160:163], v[44:47], v[116:119]
    ds_read_b128 v[160:163], v10 offset:24576
    v_mfma_f32_16x16x32_bf16 v[120:123], v[164:167], v[40:43], v[120:123]
    buffer_load_dwordx4 v10, s[32:35], s11 offen offset:1024 sc1 lds
    s_waitcnt lgkmcnt(4)
    v_mfma_f32_16x16x32_bf16 v[124:127], v[164:167], v[44:47], v[124:127]
    ds_read_b128 v[164:167], v10 offset:25600
    v_mfma_f32_16x16x32_bf16 v[128:131], v[168:171], v[40:43], v[128:131]
    buffer_load_dwordx4 v10, s[32:35], s11 offen offset:2048 sc1 lds
    s_waitcnt lgkmcnt(4)
    v_mfma_f32_16x16x32_bf16 v[132:135], v[168:171], v[44:47], v[132:135]
    ds_read_b128 v[168:171], v10 offset:26624
    v_mfma_f32_16x16x32_bf16 v[136:139], v[172:175], v[40:43], v[136:139]
    s_waitcnt lgkmcnt(4)
    v_mfma_f32_16x16x32_bf16 v[140:143], v[172:175], v[44:47], v[140:143]
    s_add_u32 s10, s17, 22528
    s_waitcnt vmcnt(26)
    v_swap_b32 v50, v52
    v_swap_b32 v51, v53
    ds_read_b128 v[172:175], v10 offset:27648
    v_mfma_f32_16x16x32_bf16 v[144:147], v[176:179], v[40:43], v[144:147]
    buffer_load_dwordx4 v[104:107], v250, s[28:31], s10 offen offset:0 sc1
    s_waitcnt lgkmcnt(4)
    v_mfma_f32_16x16x32_bf16 v[148:151], v[176:179], v[44:47], v[148:151]
    ds_read_b128 v[176:179], v10 offset:28672
    v_mfma_f32_16x16x32_bf16 v[152:155], v[180:183], v[40:43], v[152:155]
    buffer_load_dwordx4 v[108:111], v250, s[28:31], s10 offen offset:256 sc1
    s_waitcnt lgkmcnt(4)
    v_mfma_f32_16x16x32_bf16 v[156:159], v[180:183], v[44:47], v[156:159]
    ds_read_b128 v[180:183], v10 offset:29696
    v_mfma_f32_16x16x32_bf16 v[112:115], v[160:163], v[48:51], v[112:115]
    s_waitcnt lgkmcnt(4)
    v_mfma_f32_16x16x32_bf16 v[116:119], v[160:163], v[52:55], v[116:119]
    s_add_u32 s10, s17, 24576
    ds_read_b128 v[160:163], v10 offset:30720
    v_mfma_f32_16x16x32_bf16 v[120:123], v[164:167], v[48:51], v[120:123]
    buffer_load_dwordx4 v[16:19], v250, s[28:31], s10 offen offset:0 sc1
    s_waitcnt lgkmcnt(4)
    v_mfma_f32_16x16x32_bf16 v[124:127], v[164:167], v[52:55], v[124:127]
    ds_read_b128 v[164:167], v10 offset:31744
    v_mfma_f32_16x16x32_bf16 v[128:131], v[168:171], v[48:51], v[128:131]
    s_waitcnt lgkmcnt(4)
    v_mfma_f32_16x16x32_bf16 v[132:135], v[168:171], v[52:55], v[132:135]
    ds_read_b128 v[168:171], v10 offset:32768
    v_mfma_f32_16x16x32_bf16 v[136:139], v[172:175], v[48:51], v[136:139]
    s_waitcnt lgkmcnt(4)
    v_mfma_f32_16x16x32_bf16 v[140:143], v[172:175], v[52:55], v[140:143]
    s_waitcnt vmcnt(27)
    v_swap_b32 v58, v60
    v_swap_b32 v59, v61
    ds_read_b128 v[172:175], v10 offset:33792
    v_mfma_f32_16x16x32_bf16 v[144:147], v[176:179], v[48:51], v[144:147]
    buffer_load_dwordx4 v[20:23], v250, s[28:31], s10 offen offset:256 sc1
    s_waitcnt lgkmcnt(4)
    v_mfma_f32_16x16x32_bf16 v[148:151], v[176:179], v[52:55], v[148:151]
    ds_read_b128 v[176:179], v10 offset:34816
    v_mfma_f32_16x16x32_bf16 v[152:155], v[180:183], v[48:51], v[152:155]
    s_waitcnt lgkmcnt(4)
    v_mfma_f32_16x16x32_bf16 v[156:159], v[180:183], v[52:55], v[156:159]
    ds_read_b128 v[180:183], v10 offset:35840
    v_mfma_f32_16x16x32_bf16 v[112:115], v[160:163], v[56:59], v[112:115]
    s_waitcnt lgkmcnt(4)
    v_mfma_f32_16x16x32_bf16 v[116:119], v[160:163], v[60:63], v[116:119]
    s_add_u32 s10, s17, 26624
    ds_read_b128 v[160:163], v10 offset:36864
    v_mfma_f32_16x16x32_bf16 v[120:123], v[164:167], v[56:59], v[120:123]
    buffer_load_dwordx4 v[24:27], v250, s[28:31], s10 offen offset:0 sc1
    s_waitcnt lgkmcnt(4)
    v_mfma_f32_16x16x32_bf16 v[124:127], v[164:167], v[60:63], v[124:127]
    ds_read_b128 v[164:167], v10 offset:37888
    v_mfma_f32_16x16x32_bf16 v[128:131], v[168:171], v[56:59], v[128:131]
    s_waitcnt lgkmcnt(4)
    v_mfma_f32_16x16x32_bf16 v[132:135], v[168:171], v[60:63], v[132:135]
    ds_read_b128 v[168:171], v10 offset:38912
    v_mfma_f32_16x16x32_bf16 v[136:139], v[172:175], v[56:59], v[136:139]
    s_waitcnt lgkmcnt(4)
    v_mfma_f32_16x16x32_bf16 v[140:143], v[172:175], v[60:63], v[140:143]
    s_waitcnt vmcnt(27)
    v_swap_b32 v66, v68
    v_swap_b32 v67, v69
    ds_read_b128 v[172:175], v10 offset:39936
    v_mfma_f32_16x16x32_bf16 v[144:147], v[176:179], v[56:59], v[144:147]
    buffer_load_dwordx4 v[28:31], v250, s[28:31], s10 offen offset:256 sc1
    s_waitcnt lgkmcnt(4)
    v_mfma_f32_16x16x32_bf16 v[148:151], v[176:179], v[60:63], v[148:151]
    ds_read_b128 v[176:179], v10 offset:40960
    v_mfma_f32_16x16x32_bf16 v[152:155], v[180:183], v[56:59], v[152:155]
    s_waitcnt lgkmcnt(4)
    v_mfma_f32_16x16x32_bf16 v[156:159], v[180:183], v[60:63], v[156:159]
    ds_read_b128 v[180:183], v10 offset:41984
    v_mfma_f32_16x16x32_bf16 v[112:115], v[160:163], v[64:67], v[112:115]
    s_waitcnt lgkmcnt(4)
    v_mfma_f32_16x16x32_bf16 v[116:119], v[160:163], v[68:71], v[116:119]
    s_add_u32 s10, s17, 28672
    ds_read_b128 v[160:163], v10 offset:43008
    v_mfma_f32_16x16x32_bf16 v[120:123], v[164:167], v[64:67], v[120:123]
    buffer_load_dwordx4 v[32:35], v250, s[28:31], s10 offen offset:0 sc1
    s_waitcnt lgkmcnt(4)
    v_mfma_f32_16x16x32_bf16 v[124:127], v[164:167], v[68:71], v[124:127]
    ds_read_b128 v[164:167], v10 offset:44032
    v_mfma_f32_16x16x32_bf16 v[128:131], v[168:171], v[64:67], v[128:131]
    s_waitcnt lgkmcnt(4)
    v_mfma_f32_16x16x32_bf16 v[132:135], v[168:171], v[68:71], v[132:135]
    ds_read_b128 v[168:171], v10 offset:45056
    v_mfma_f32_16x16x32_bf16 v[136:139], v[172:175], v[64:67], v[136:139]
    s_waitcnt lgkmcnt(4)
    v_mfma_f32_16x16x32_bf16 v[140:143], v[172:175], v[68:71], v[140:143]
    s_waitcnt vmcnt(27)
    v_swap_b32 v74, v76
    v_swap_b32 v75, v77
    ds_read_b128 v[172:175], v10 offset:46080
    v_mfma_f32_16x16x32_bf16 v[144:147], v[176:179], v[64:67], v[144:147]
    buffer_load_dwordx4 v[36:39], v250, s[28:31], s10 offen offset:256 sc1
    s_waitcnt lgkmcnt(4)
    v_mfma_f32_16x16x32_bf16 v[148:151], v[176:179], v[68:71], v[148:151]
    ds_read_b128 v[176:179], v10 offset:47104
    v_mfma_f32_16x16x32_bf16 v[152:155], v[180:183], v[64:67], v[152:155]
    s_waitcnt lgkmcnt(4)
    v_mfma_f32_16x16x32_bf16 v[156:159], v[180:183], v[68:71], v[156:159]
    ds_read_b128 v[180:183], v10 offset:48128
    v_mfma_f32_16x16x32_bf16 v[112:115], v[160:163], v[72:75], v[112:115]
    s_waitcnt lgkmcnt(4)
    v_mfma_f32_16x16x32_bf16 v[116:119], v[160:163], v[76:79], v[116:119]
    s_add_u32 s10, s17, 30720
    ds_read_b128 v[160:163], v10 offset:49152
    v_mfma_f32_16x16x32_bf16 v[120:123], v[164:167], v[72:75], v[120:123]
    buffer_load_dwordx4 v[40:43], v250, s[28:31], s10 offen offset:0 sc1
    s_waitcnt lgkmcnt(4)
    v_mfma_f32_16x16x32_bf16 v[124:127], v[164:167], v[76:79], v[124:127]
    ds_read_b128 v[164:167], v10 offset:50176
    v_mfma_f32_16x16x32_bf16 v[128:131], v[168:171], v[72:75], v[128:131]
    s_waitcnt lgkmcnt(4)
    v_mfma_f32_16x16x32_bf16 v[132:135], v[168:171], v[76:79], v[132:135]
    ds_read_b128 v[168:171], v10 offset:51200
    v_mfma_f32_16x16x32_bf16 v[136:139], v[172:175], v[72:75], v[136:139]
    s_waitcnt lgkmcnt(4)
    v_mfma_f32_16x16x32_bf16 v[140:143], v[172:175], v[76:79], v[140:143]
    s_waitcnt vmcnt(24)
    v_swap_b32 v82, v84
    v_swap_b32 v83, v85
    ds_read_b128 v[172:175], v10 offset:52224
    v_mfma_f32_16x16x32_bf16 v[144:147], v[176:179], v[72:75], v[144:147]
    buffer_load_dwordx4 v[44:47], v250, s[28:31], s10 offen offset:256 sc1
    s_waitcnt lgkmcnt(4)
    v_mfma_f32_16x16x32_bf16 v[148:151], v[176:179], v[76:79], v[148:151]
    ds_read_b128 v[176:179], v10 offset:53248
    v_mfma_f32_16x16x32_bf16 v[152:155], v[180:183], v[72:75], v[152:155]
    s_waitcnt lgkmcnt(4)
    v_mfma_f32_16x16x32_bf16 v[156:159], v[180:183], v[76:79], v[156:159]
    ds_read_b128 v[180:183], v10 offset:54272
    v_mfma_f32_16x16x32_bf16 v[112:115], v[160:163], v[80:83], v[112:115]
    s_waitcnt lgkmcnt(4)
    v_mfma_f32_16x16x32_bf16 v[116:119], v[160:163], v[84:87], v[116:119]
    s_add_u32 s10, s17, 32768
    ds_read_b128 v[160:163], v10 offset:55296
    v_mfma_f32_16x16x32_bf16 v[120:123], v[164:167], v[80:83], v[120:123]
    buffer_load_dwordx4 v[48:51], v250, s[28:31], s10 offen offset:0 sc1
    s_waitcnt lgkmcnt(4)
    v_mfma_f32_16x16x32_bf16 v[124:127], v[164:167], v[84:87], v[124:127]
    ds_read_b128 v[164:167], v10 offset:56320
    v_mfma_f32_16x16x32_bf16 v[128:131], v[168:171], v[80:83], v[128:131]
    s_waitcnt lgkmcnt(4)
    v_mfma_f32_16x16x32_bf16 v[132:135], v[168:171], v[84:87], v[132:135]
    ds_read_b128 v[168:171], v10 offset:57344
    v_mfma_f32_16x16x32_bf16 v[136:139], v[172:175], v[80:83], v[136:139]
    s_waitcnt lgkmcnt(4)
    v_mfma_f32_16x16x32_bf16 v[140:143], v[172:175], v[84:87], v[140:143]
    s_waitcnt vmcnt(21)
    v_swap_b32 v90, v92
    v_swap_b32 v91, v93
    ds_read_b128 v[172:175], v10 offset:58368
    v_mfma_f32_16x16x32_bf16 v[144:147], v[176:179], v[80:83], v[144:147]
    buffer_load_dwordx4 v[52:55], v250, s[28:31], s10 offen offset:256 sc1
    s_waitcnt lgkmcnt(4)
    v_mfma_f32_16x16x32_bf16 v[148:151], v[176:179], v[84:87], v[148:151]
    ds_read_b128 v[176:179], v10 offset:59392
    v_mfma_f32_16x16x32_bf16 v[152:155], v[180:183], v[80:83], v[152:155]
    s_waitcnt lgkmcnt(4)
    v_mfma_f32_16x16x32_bf16 v[156:159], v[180:183], v[84:87], v[156:159]
    ds_read_b128 v[180:183], v10 offset:60416
    v_mfma_f32_16x16x32_bf16 v[112:115], v[160:163], v[88:91], v[112:115]
    s_waitcnt lgkmcnt(4)
    v_mfma_f32_16x16x32_bf16 v[116:119], v[160:163], v[92:95], v[116:119]
    s_add_u32 s10, s17, 34816
    ds_read_b128 v[160:163], v11 offset:0
    v_mfma_f32_16x16x32_bf16 v[120:123], v[164:167], v[88:91], v[120:123]
    buffer_load_dwordx4 v[56:59], v250, s[28:31], s10 offen offset:0 sc1
    s_waitcnt lgkmcnt(4)
    v_mfma_f32_16x16x32_bf16 v[124:127], v[164:167], v[92:95], v[124:127]
    ds_read_b128 v[164:167], v11 offset:1024
    v_mfma_f32_16x16x32_bf16 v[128:131], v[168:171], v[88:91], v[128:131]
    s_waitcnt lgkmcnt(4)
    v_mfma_f32_16x16x32_bf16 v[132:135], v[168:171], v[92:95], v[132:135]
    ds_read_b128 v[168:171], v11 offset:2048
    v_mfma_f32_16x16x32_bf16 v[136:139], v[172:175], v[88:91], v[136:139]
    s_waitcnt lgkmcnt(4)
    v_mfma_f32_16x16x32_bf16 v[140:143], v[172:175], v[92:95], v[140:143]
    s_waitcnt vmcnt(16)
    v_swap_b32 v98, v100
    v_swap_b32 v99, v101
    ds_read_b128 v[172:175], v11 offset:3072
    v_mfma_f32_16x16x32_bf16 v[144:147], v[176:179], v[88:91], v[144:147]
    buffer_load_dwordx4 v[60:63], v250, s[28:31], s10 offen offset:256 sc1
    s_waitcnt lgkmcnt(4)
    v_mfma_f32_16x16x32_bf16 v[148:151], v[176:179], v[92:95], v[148:151]
    ds_read_b128 v[176:179], v11 offset:4096
    v_mfma_f32_16x16x32_bf16 v[152:155], v[180:183], v[88:91], v[152:155]
    s_waitcnt lgkmcnt(4)
    v_mfma_f32_16x16x32_bf16 v[156:159], v[180:183], v[92:95], v[156:159]
    ds_read_b128 v[180:183], v11 offset:5120
    v_mfma_f32_16x16x32_bf16 v[112:115], v[160:163], v[96:99], v[112:115]
    s_add_u32 s10, s17, 36864
    buffer_load_dwordx4 v[64:67], v250, s[28:31], s10 offen offset:0 sc1
    s_waitcnt lgkmcnt(4)
    v_mfma_f32_16x16x32_bf16 v[116:119], v[160:163], v[100:103], v[116:119]
    ds_read_b128 v[160:163], v11 offset:6144
    v_mfma_f32_16x16x32_bf16 v[120:123], v[164:167], v[96:99], v[120:123]
    s_waitcnt lgkmcnt(4)
    v_mfma_f32_16x16x32_bf16 v[124:127], v[164:167], v[100:103], v[124:127]
    ds_read_b128 v[164:167], v11 offset:7168
    v_mfma_f32_16x16x32_bf16 v[128:131], v[168:171], v[96:99], v[128:131]
    buffer_load_dwordx4 v[68:71], v250, s[28:31], s10 offen offset:256 sc1
    s_waitcnt lgkmcnt(4)
    v_mfma_f32_16x16x32_bf16 v[132:135], v[168:171], v[100:103], v[132:135]
    ds_read_b128 v[168:171], v11 offset:8192
    v_mfma_f32_16x16x32_bf16 v[136:139], v[172:175], v[96:99], v[136:139]
    s_waitcnt lgkmcnt(4)
    v_mfma_f32_16x16x32_bf16 v[140:143], v[172:175], v[100:103], v[140:143]
    s_waitcnt vmcnt(14)
    v_swap_b32 v106, v108
    v_swap_b32 v107, v109
    ds_read_b128 v[172:175], v11 offset:9216
    v_mfma_f32_16x16x32_bf16 v[144:147], v[176:179], v[96:99], v[144:147]
    s_add_u32 s11, s21, 30720
    buffer_load_dwordx4 a[128:131], v10, s[40:43], s11 offen offset:0 sc1
    s_waitcnt lgkmcnt(4)
    v_mfma_f32_16x16x32_bf16 v[148:151], v[176:179], v[100:103], v[148:151]
    ds_read_b128 v[176:179], v11 offset:10240
    v_mfma_f32_16x16x32_bf16 v[152:155], v[180:183], v[96:99], v[152:155]
    s_waitcnt lgkmcnt(4)
    v_mfma_f32_16x16x32_bf16 v[156:159], v[180:183], v[100:103], v[156:159]
    ds_read_b128 v[180:183], v11 offset:11264
    s_barrier
    v_mfma_f32_16x16x32_bf16 v[112:115], v[160:163], v[104:107], v[112:115]
    s_add_u32 s10, s17, 38912
    buffer_load_dwordx4 v[72:75], v250, s[28:31], s10 offen offset:0 sc1
    s_waitcnt lgkmcnt(4)
    v_mfma_f32_16x16x32_bf16 v[116:119], v[160:163], v[108:111], v[116:119]
    ds_read_b128 v[160:163], v11 offset:12288
    v_mfma_f32_16x16x32_bf16 v[120:123], v[164:167], v[104:107], v[120:123]
    s_waitcnt lgkmcnt(4)
    v_mfma_f32_16x16x32_bf16 v[124:127], v[164:167], v[108:111], v[124:127]
    ds_read_b128 v[164:167], v11 offset:13312
    v_mfma_f32_16x16x32_bf16 v[128:131], v[168:171], v[104:107], v[128:131]
    buffer_load_dwordx4 v[76:79], v250, s[28:31], s10 offen offset:256 sc1
    s_waitcnt lgkmcnt(4)
    v_mfma_f32_16x16x32_bf16 v[132:135], v[168:171], v[108:111], v[132:135]
    ds_read_b128 v[168:171], v11 offset:14336
    v_mfma_f32_16x16x32_bf16 v[136:139], v[172:175], v[104:107], v[136:139]
    s_waitcnt lgkmcnt(4)
    v_mfma_f32_16x16x32_bf16 v[140:143], v[172:175], v[108:111], v[140:143]
    s_waitcnt vmcnt(15)
    v_swap_b32 v18, v20
    v_swap_b32 v19, v21
    ds_read_b128 v[172:175], v11 offset:15360
    v_mfma_f32_16x16x32_bf16 v[144:147], v[176:179], v[104:107], v[144:147]
    s_add_u32 s11, s21, 30720
    buffer_load_dwordx4 a[132:135], v10, s[40:43], s11 offen offset:1024 sc1
    s_waitcnt lgkmcnt(4)
    v_mfma_f32_16x16x32_bf16 v[148:151], v[176:179], v[108:111], v[148:151]
    ds_read_b128 v[176:179], v11 offset:16384
    v_mfma_f32_16x16x32_bf16 v[152:155], v[180:183], v[104:107], v[152:155]
    s_waitcnt lgkmcnt(4)
    v_mfma_f32_16x16x32_bf16 v[156:159], v[180:183], v[108:111], v[156:159]
    ds_read_b128 v[180:183], v11 offset:17408
    v_mfma_f32_16x16x32_bf16 v[112:115], v[160:163], v[16:19], v[112:115]
    s_add_u32 s10, s17, 163840
    buffer_load_dwordx4 v[80:83], v250, s[28:31], s10 offen offset:0 sc1
    s_waitcnt lgkmcnt(4)
    v_mfma_f32_16x16x32_bf16 v[116:119], v[160:163], v[20:23], v[116:119]
    ds_read_b128 v[160:163], v11 offset:18432
    v_mfma_f32_16x16x32_bf16 v[120:123], v[164:167], v[16:19], v[120:123]
    s_waitcnt lgkmcnt(4)
    v_mfma_f32_16x16x32_bf16 v[124:127], v[164:167], v[20:23], v[124:127]
    ds_read_b128 v[164:167], v11 offset:19456
    v_mfma_f32_16x16x32_bf16 v[128:131], v[168:171], v[16:19], v[128:131]
    buffer_load_dwordx4 v[84:87], v250, s[28:31], s10 offen offset:256 sc1
    s_waitcnt lgkmcnt(4)
    v_mfma_f32_16x16x32_bf16 v[132:135], v[168:171], v[20:23], v[132:135]
    ds_read_b128 v[168:171], v11 offset:20480
    v_mfma_f32_16x16x32_bf16 v[136:139], v[172:175], v[16:19], v[136:139]
    s_waitcnt lgkmcnt(4)
    v_mfma_f32_16x16x32_bf16 v[140:143], v[172:175], v[20:23], v[140:143]
    s_waitcnt vmcnt(16)
    v_swap_b32 v26, v28
    v_swap_b32 v27, v29
    ds_read_b128 v[172:175], v11 offset:21504
    v_mfma_f32_16x16x32_bf16 v[144:147], v[176:179], v[16:19], v[144:147]
    s_add_u32 s11, s22, 30720
    buffer_load_dwordx4 a[136:139], v10, s[40:43], s11 offen offset:0 sc1
    s_waitcnt lgkmcnt(4)
    v_mfma_f32_16x16x32_bf16 v[148:151], v[176:179], v[20:23], v[148:151]
    ds_read_b128 v[176:179], v11 offset:22528
    v_mfma_f32_16x16x32_bf16 v[152:155], v[180:183], v[16:19], v[152:155]
    s_waitcnt lgkmcnt(4)
    v_mfma_f32_16x16x32_bf16 v[156:159], v[180:183], v[20:23], v[156:159]
    ds_read_b128 v[180:183], v11 offset:23552
    v_mfma_f32_16x16x32_bf16 v[112:115], v[160:163], v[24:27], v[112:115]
    s_add_u32 s10, s17, 165888
    buffer_load_dwordx4 v[88:91], v250, s[28:31], s10 offen offset:0 sc1
    s_waitcnt lgkmcnt(4)
    v_mfma_f32_16x16x32_bf16 v[116:119], v[160:163], v[28:31], v[116:119]
    ds_read_b128 v[160:163], v11 offset:24576
    v_mfma_f32_16x16x32_bf16 v[120:123], v[164:167], v[24:27], v[120:123]
    s_waitcnt lgkmcnt(4)
    v_mfma_f32_16x16x32_bf16 v[124:127], v[164:167], v[28:31], v[124:127]
    ds_read_b128 v[164:167], v11 offset:25600
    v_mfma_f32_16x16x32_bf16 v[128:131], v[168:171], v[24:27], v[128:131]
    buffer_load_dwordx4 v[92:95], v250, s[28:31], s10 offen offset:256 sc1
    s_waitcnt lgkmcnt(4)
    v_mfma_f32_16x16x32_bf16 v[132:135], v[168:171], v[28:31], v[132:135]
    ds_read_b128 v[168:171], v11 offset:26624
    v_mfma_f32_16x16x32_bf16 v[136:139], v[172:175], v[24:27], v[136:139]
    s_waitcnt lgkmcnt(4)
    v_mfma_f32_16x16x32_bf16 v[140:143], v[172:175], v[28:31], v[140:143]
    s_waitcnt vmcnt(17)
    v_swap_b32 v34, v36
    v_swap_b32 v35, v37
    ds_read_b128 v[172:175], v11 offset:27648
    v_mfma_f32_16x16x32_bf16 v[144:147], v[176:179], v[24:27], v[144:147]
    s_add_u32 s11, s20, 35840
    buffer_load_dwordx4 a[140:143], v10, s[40:43], s11 offen offset:0 sc1
    s_waitcnt lgkmcnt(4)
    v_mfma_f32_16x16x32_bf16 v[148:151], v[176:179], v[28:31], v[148:151]
    ds_read_b128 v[176:179], v11 offset:28672
    v_mfma_f32_16x16x32_bf16 v[152:155], v[180:183], v[24:27], v[152:155]
    s_waitcnt lgkmcnt(4)
    v_mfma_f32_16x16x32_bf16 v[156:159], v[180:183], v[28:31], v[156:159]
    ds_read_b128 v[180:183], v11 offset:29696
    v_mfma_f32_16x16x32_bf16 v[112:115], v[160:163], v[32:35], v[112:115]
    s_lshl_b32 s13, s15, 9
    s_add_u32 s13, s13, 0
    buffer_load_dwordx2 v[208:209], v0, s[44:47], s13 offen offset:0 sc1
    s_waitcnt lgkmcnt(4)
    v_mfma_f32_16x16x32_bf16 v[116:119], v[160:163], v[36:39], v[116:119]
    ds_read_b128 v[160:163], v11 offset:30720
    v_mfma_f32_16x16x32_bf16 v[120:123], v[164:167], v[32:35], v[120:123]
    buffer_load_dwordx2 v[210:211], v0, s[44:47], s13 offen offset:512 sc1
    s_waitcnt lgkmcnt(4)
    v_mfma_f32_16x16x32_bf16 v[124:127], v[164:167], v[36:39], v[124:127]
    s_add_u32 s10, s17, 167936
    ds_read_b128 v[164:167], v11 offset:31744
    v_mfma_f32_16x16x32_bf16 v[128:131], v[168:171], v[32:35], v[128:131]
    buffer_load_dwordx4 v[96:99], v250, s[28:31], s10 offen offset:0 sc1
    s_waitcnt lgkmcnt(4)
    v_mfma_f32_16x16x32_bf16 v[132:135], v[168:171], v[36:39], v[132:135]
    ds_read_b128 v[168:171], v11 offset:32768
    v_mfma_f32_16x16x32_bf16 v[136:139], v[172:175], v[32:35], v[136:139]
    s_waitcnt lgkmcnt(4)
    v_mfma_f32_16x16x32_bf16 v[140:143], v[172:175], v[36:39], v[140:143]
    s_waitcnt vmcnt(19)
    v_swap_b32 v42, v44
    v_swap_b32 v43, v45
    ds_read_b128 v[172:175], v11 offset:33792
    v_mfma_f32_16x16x32_bf16 v[144:147], v[176:179], v[32:35], v[144:147]
    buffer_load_dwordx4 v[100:103], v250, s[28:31], s10 offen offset:256 sc1
    s_waitcnt lgkmcnt(4)
    v_mfma_f32_16x16x32_bf16 v[148:151], v[176:179], v[36:39], v[148:151]
    ds_read_b128 v[176:179], v11 offset:34816
    v_mfma_f32_16x16x32_bf16 v[152:155], v[180:183], v[32:35], v[152:155]
    s_add_u32 s11, s20, 35840
    buffer_load_dwordx4 a[144:147], v10, s[40:43], s11 offen offset:1024 sc1
    s_waitcnt lgkmcnt(4)
    v_mfma_f32_16x16x32_bf16 v[156:159], v[180:183], v[36:39], v[156:159]
    ds_read_b128 v[180:183], v11 offset:35840
    v_mfma_f32_16x16x32_bf16 v[112:115], v[160:163], v[40:43], v[112:115]
    s_add_u32 s10, s17, 169984
    buffer_load_dwordx4 v[104:107], v250, s[28:31], s10 offen offset:0 sc1
    s_waitcnt lgkmcnt(4)
    v_mfma_f32_16x16x32_bf16 v[116:119], v[160:163], v[44:47], v[116:119]
    ds_read_b128 v[160:163], v11 offset:36864
    v_mfma_f32_16x16x32_bf16 v[120:123], v[164:167], v[40:43], v[120:123]
    s_waitcnt lgkmcnt(4)
    v_mfma_f32_16x16x32_bf16 v[124:127], v[164:167], v[44:47], v[124:127]
    ds_read_b128 v[164:167], v11 offset:37888
    v_mfma_f32_16x16x32_bf16 v[128:131], v[168:171], v[40:43], v[128:131]
    buffer_load_dwordx4 v[108:111], v250, s[28:31], s10 offen offset:256 sc1
    s_waitcnt lgkmcnt(4)
    v_mfma_f32_16x16x32_bf16 v[132:135], v[168:171], v[44:47], v[132:135]
    ds_read_b128 v[168:171], v11 offset:38912
    v_mfma_f32_16x16x32_bf16 v[136:139], v[172:175], v[40:43], v[136:139]
    s_waitcnt lgkmcnt(4)
    v_mfma_f32_16x16x32_bf16 v[140:143], v[172:175], v[44:47], v[140:143]
    s_waitcnt vmcnt(21)
    v_swap_b32 v50, v52
    v_swap_b32 v51, v53
    ds_read_b128 v[172:175], v11 offset:39936
    v_mfma_f32_16x16x32_bf16 v[144:147], v[176:179], v[40:43], v[144:147]
    s_add_u32 s11, s21, 35840
    buffer_load_dwordx4 a[148:151], v10, s[40:43], s11 offen offset:0 sc1
    s_waitcnt lgkmcnt(4)
    v_mfma_f32_16x16x32_bf16 v[148:151], v[176:179], v[44:47], v[148:151]
    ds_read_b128 v[176:179], v11 offset:40960
    v_mfma_f32_16x16x32_bf16 v[152:155], v[180:183], v[40:43], v[152:155]
    s_waitcnt lgkmcnt(4)
    v_mfma_f32_16x16x32_bf16 v[156:159], v[180:183], v[44:47], v[156:159]
    ds_read_b128 v[180:183], v11 offset:41984
    v_mfma_f32_16x16x32_bf16 v[112:115], v[160:163], v[48:51], v[112:115]
    s_add_u32 s10, s17, 172032
    buffer_load_dwordx4 v[16:19], v250, s[28:31], s10 offen offset:0 sc1
    s_waitcnt lgkmcnt(4)
    v_mfma_f32_16x16x32_bf16 v[116:119], v[160:163], v[52:55], v[116:119]
    ds_read_b128 v[160:163], v11 offset:43008
    v_mfma_f32_16x16x32_bf16 v[120:123], v[164:167], v[48:51], v[120:123]
    s_waitcnt lgkmcnt(4)
    v_mfma_f32_16x16x32_bf16 v[124:127], v[164:167], v[52:55], v[124:127]
    ds_read_b128 v[164:167], v11 offset:44032
    v_mfma_f32_16x16x32_bf16 v[128:131], v[168:171], v[48:51], v[128:131]
    buffer_load_dwordx4 v[20:23], v250, s[28:31], s10 offen offset:256 sc1
    s_waitcnt lgkmcnt(4)
    v_mfma_f32_16x16x32_bf16 v[132:135], v[168:171], v[52:55], v[132:135]
    ds_read_b128 v[168:171], v11 offset:45056
    v_mfma_f32_16x16x32_bf16 v[136:139], v[172:175], v[48:51], v[136:139]
    s_waitcnt lgkmcnt(4)
    v_mfma_f32_16x16x32_bf16 v[140:143], v[172:175], v[52:55], v[140:143]
    s_waitcnt vmcnt(22)
    v_swap_b32 v58, v60
    v_swap_b32 v59, v61
    ds_read_b128 v[172:175], v11 offset:46080
    v_mfma_f32_16x16x32_bf16 v[144:147], v[176:179], v[48:51], v[144:147]
    s_add_u32 s11, s21, 35840
    buffer_load_dwordx4 a[152:155], v10, s[40:43], s11 offen offset:1024 sc1
    s_waitcnt lgkmcnt(4)
    v_mfma_f32_16x16x32_bf16 v[148:151], v[176:179], v[52:55], v[148:151]
    ds_read_b128 v[176:179], v11 offset:47104
    v_mfma_f32_16x16x32_bf16 v[152:155], v[180:183], v[48:51], v[152:155]
    s_waitcnt lgkmcnt(4)
    v_mfma_f32_16x16x32_bf16 v[156:159], v[180:183], v[52:55], v[156:159]
    ds_read_b128 v[180:183], v11 offset:48128
    v_mfma_f32_16x16x32_bf16 v[112:115], v[160:163], v[56:59], v[112:115]
    s_add_u32 s10, s17, 174080
    buffer_load_dwordx4 v[24:27], v250, s[28:31], s10 offen offset:0 sc1
    s_waitcnt lgkmcnt(4)
    v_mfma_f32_16x16x32_bf16 v[116:119], v[160:163], v[60:63], v[116:119]
    ds_read_b128 v[160:163], v11 offset:49152
    v_mfma_f32_16x16x32_bf16 v[120:123], v[164:167], v[56:59], v[120:123]
    s_waitcnt lgkmcnt(4)
    v_mfma_f32_16x16x32_bf16 v[124:127], v[164:167], v[60:63], v[124:127]
    ds_read_b128 v[164:167], v11 offset:50176
    v_mfma_f32_16x16x32_bf16 v[128:131], v[168:171], v[56:59], v[128:131]
    buffer_load_dwordx4 v[28:31], v250, s[28:31], s10 offen offset:256 sc1
    s_waitcnt lgkmcnt(4)
    v_mfma_f32_16x16x32_bf16 v[132:135], v[168:171], v[60:63], v[132:135]
    ds_read_b128 v[168:171], v11 offset:51200
    v_mfma_f32_16x16x32_bf16 v[136:139], v[172:175], v[56:59], v[136:139]
    s_waitcnt lgkmcnt(4)
    v_mfma_f32_16x16x32_bf16 v[140:143], v[172:175], v[60:63], v[140:143]
    s_waitcnt vmcnt(23)
    v_swap_b32 v66, v68
    v_swap_b32 v67, v69
    ds_read_b128 v[172:175], v11 offset:52224
    v_mfma_f32_16x16x32_bf16 v[144:147], v[176:179], v[56:59], v[144:147]
    s_add_u32 s11, s22, 35840
    buffer_load_dwordx4 a[156:159], v10, s[40:43], s11 offen offset:0 sc1
    s_waitcnt lgkmcnt(4)
    v_mfma_f32_16x16x32_bf16 v[148:151], v[176:179], v[60:63], v[148:151]
    ds_read_b128 v[176:179], v11 offset:53248
    v_mfma_f32_16x16x32_bf16 v[152:155], v[180:183], v[56:59], v[152:155]
    s_waitcnt lgkmcnt(4)
    v_mfma_f32_16x16x32_bf16 v[156:159], v[180:183], v[60:63], v[156:159]
    ds_read_b128 v[180:183], v11 offset:54272
    v_mfma_f32_16x16x32_bf16 v[112:115], v[160:163], v[64:67], v[112:115]
    s_add_u32 s10, s17, 176128
    buffer_load_dwordx4 v[32:35], v250, s[28:31], s10 offen offset:0 sc1
    s_waitcnt lgkmcnt(4)
    v_mfma_f32_16x16x32_bf16 v[116:119], v[160:163], v[68:71], v[116:119]
    ds_read_b128 v[160:163], v11 offset:55296
    v_mfma_f32_16x16x32_bf16 v[120:123], v[164:167], v[64:67], v[120:123]
    s_waitcnt lgkmcnt(4)
    v_mfma_f32_16x16x32_bf16 v[124:127], v[164:167], v[68:71], v[124:127]
    ds_read_b128 v[164:167], v11 offset:56320
    v_mfma_f32_16x16x32_bf16 v[128:131], v[168:171], v[64:67], v[128:131]
    buffer_load_dwordx4 v[36:39], v250, s[28:31], s10 offen offset:256 sc1
    s_waitcnt lgkmcnt(4)
    v_mfma_f32_16x16x32_bf16 v[132:135], v[168:171], v[68:71], v[132:135]
    ds_read_b128 v[168:171], v11 offset:57344
    v_mfma_f32_16x16x32_bf16 v[136:139], v[172:175], v[64:67], v[136:139]
    s_waitcnt lgkmcnt(4)
    v_mfma_f32_16x16x32_bf16 v[140:143], v[172:175], v[68:71], v[140:143]
    s_waitcnt vmcnt(23)
    v_swap_b32 v74, v76
    v_swap_b32 v75, v77
    ds_read_b128 v[172:175], v11 offset:58368
    v_mfma_f32_16x16x32_bf16 v[144:147], v[176:179], v[64:67], v[144:147]
    s_add_u32 s11, s20, 40960
    buffer_load_dwordx4 a[160:163], v10, s[40:43], s11 offen offset:0 sc1
    s_waitcnt lgkmcnt(4)
    v_mfma_f32_16x16x32_bf16 v[148:151], v[176:179], v[68:71], v[148:151]
    ds_read_b128 v[176:179], v11 offset:59392
    v_mfma_f32_16x16x32_bf16 v[152:155], v[180:183], v[64:67], v[152:155]
    s_waitcnt lgkmcnt(4)
    v_mfma_f32_16x16x32_bf16 v[156:159], v[180:183], v[68:71], v[156:159]
    ds_read_b128 v[180:183], v11 offset:60416
    v_mfma_f32_16x16x32_bf16 v[112:115], v[160:163], v[72:75], v[112:115]
    s_add_u32 s10, s17, 178176
    buffer_load_dwordx4 v[40:43], v250, s[28:31], s10 offen offset:0 sc1
    s_waitcnt lgkmcnt(4)
    v_mfma_f32_16x16x32_bf16 v[116:119], v[160:163], v[76:79], v[116:119]
    v_lshlrev_b32 v255, 4, v3
    v_add_u32 v255, 122880, v255
    ds_read_b128 v[160:163], v255 offset:0
    v_mfma_f32_16x16x32_bf16 v[120:123], v[164:167], v[72:75], v[120:123]
    s_waitcnt lgkmcnt(4)
    v_mfma_f32_16x16x32_bf16 v[124:127], v[164:167], v[76:79], v[124:127]
    ds_read_b128 v[164:167], v255 offset:64
    v_mfma_f32_16x16x32_bf16 v[128:131], v[168:171], v[72:75], v[128:131]
    buffer_load_dwordx4 v[44:47], v250, s[28:31], s10 offen offset:256 sc1
    s_waitcnt lgkmcnt(4)
    v_mfma_f32_16x16x32_bf16 v[132:135], v[168:171], v[76:79], v[132:135]
    ds_read_b128 v[168:171], v255 offset:128
    v_mfma_f32_16x16x32_bf16 v[136:139], v[172:175], v[72:75], v[136:139]
    s_waitcnt lgkmcnt(4)
    v_mfma_f32_16x16x32_bf16 v[140:143], v[172:175], v[76:79], v[140:143]
    ds_read_b128 v[172:175], v255 offset:192
    v_mfma_f32_16x16x32_bf16 v[144:147], v[176:179], v[72:75], v[144:147]
    s_add_u32 s11, s20, 40960
    buffer_load_dwordx4 a[164:167], v10, s[40:43], s11 offen offset:1024 sc1
    s_waitcnt lgkmcnt(4)
    v_mfma_f32_16x16x32_bf16 v[148:151], v[176:179], v[76:79], v[148:151]
    ds_read_b128 v[176:179], v255 offset:256
    v_mfma_f32_16x16x32_bf16 v[152:155], v[180:183], v[72:75], v[152:155]
    v_mfma_f32_16x16x32_bf16 v[156:159], v[180:183], v[76:79], v[156:159]
    ds_read_b128 v[180:183], v255 offset:320
    s_waitcnt vmcnt(18)
    v_min_u32 v204, v209, v211
    v_cmp_ne_u32 vcc, 0, v204
    s_nop 0
    s_cmp_eq_u64 vcc, -1
    s_cbranch_scc1 interleave_layers__ssm_conv_h3__swiglu_ffn__prompt_kernel_ok19
    s_mov_b32 s23, 0
interleave_layers__ssm_conv_h3__swiglu_ffn__prompt_kernel_spin20:
    s_sleep 1
    s_lshl_b32 s13, s15, 9
    s_add_u32 s13, s13, 0
    buffer_load_dwordx2 v[208:209], v0, s[44:47], s13 offen offset:0 sc1
    buffer_load_dwordx2 v[210:211], v0, s[44:47], s13 offen offset:512 sc1
    s_waitcnt vmcnt(0)
    s_add_u32 s23, s23, 1
    s_cmp_ge_u32 s23, 262144
    s_cbranch_scc1 interleave_layers__ssm_conv_h3__swiglu_ffn__prompt_kernel_ok19
    v_min_u32 v204, v209, v211
    v_cmp_ne_u32 vcc, 0, v204
    s_nop 0
    s_cmp_eq_u64 vcc, -1
    s_cbranch_scc0 interleave_layers__ssm_conv_h3__swiglu_ffn__prompt_kernel_spin20
    s_nop 1
interleave_layers__ssm_conv_h3__swiglu_ffn__prompt_kernel_ok19:
    v_mov_b32 v204, v208
    s_nop 1
    v_permlane16_swap_b32 v208, v204
    v_add_f32 v208, v208, v204
    v_mov_b32 v204, v208
    s_nop 1
    v_permlane32_swap_b32 v208, v204
    v_add_f32 v208, v208, v204
    v_mov_b32 v204, v209
    s_nop 1
    v_permlane16_swap_b32 v209, v204
    v_add_f32 v209, v209, v204
    v_mov_b32 v204, v209
    s_nop 1
    v_permlane32_swap_b32 v209, v204
    v_add_f32 v209, v209, v204
    v_mul_f32 v4, 0xbacccccd, v208
    v_mul_f32 v209, 0xbacccccd, v209
    v_fma_f32 v209, -v4, v4, v209
    v_max_f32 v209, 0, v209
    v_add_f32 v209, 0x3727c5ac, v209
    v_rsq_f32 v5, v209
    v_mov_b32 v204, v210
    s_nop 1
    v_permlane16_swap_b32 v210, v204
    v_add_f32 v210, v210, v204
    v_mov_b32 v204, v210
    s_nop 1
    v_permlane32_swap_b32 v210, v204
    v_add_f32 v210, v210, v204
    v_mov_b32 v204, v211
    s_nop 1
    v_permlane16_swap_b32 v211, v204
    v_add_f32 v211, v211, v204
    v_mov_b32 v204, v211
    s_nop 1
    v_permlane32_swap_b32 v211, v204
    v_add_f32 v211, v211, v204
    v_mul_f32 v6, 0xbacccccd, v210
    v_mul_f32 v211, 0xbacccccd, v211
    v_fma_f32 v211, -v6, v6, v211
    v_max_f32 v211, 0, v211
    v_add_f32 v211, 0x3727c5ac, v211
    v_rsq_f32 v7, v211
    s_add_u32 s12, s56, 0
    v_mul_f32 v212, 0xbfb8aa3b, v5
    v_mul_f32 v213, v5, v5
    v_rcp_f32 v213, v213
    s_waitcnt lgkmcnt(5)
    v_pk_fma_f32 v[112:113], v[160:161], v[4:5], v[112:113] op_sel:[0,0,0] op_sel_hi:[1,0,1]
    v_pk_fma_f32 v[114:115], v[162:163], v[4:5], v[114:115] op_sel:[0,0,0] op_sel_hi:[1,0,1]
    s_waitcnt lgkmcnt(4)
    v_pk_fma_f32 v[120:121], v[164:165], v[4:5], v[120:121] op_sel:[0,0,0] op_sel_hi:[1,0,1]
    v_pk_fma_f32 v[122:123], v[166:167], v[4:5], v[122:123] op_sel:[0,0,0] op_sel_hi:[1,0,1]
    s_waitcnt lgkmcnt(3)
    v_pk_fma_f32 v[128:129], v[168:169], v[4:5], v[128:129] op_sel:[0,0,0] op_sel_hi:[1,0,1]
    v_pk_fma_f32 v[130:131], v[170:171], v[4:5], v[130:131] op_sel:[0,0,0] op_sel_hi:[1,0,1]
    s_waitcnt lgkmcnt(2)
    v_pk_fma_f32 v[136:137], v[172:173], v[4:5], v[136:137] op_sel:[0,0,0] op_sel_hi:[1,0,1]
    v_pk_fma_f32 v[138:139], v[174:175], v[4:5], v[138:139] op_sel:[0,0,0] op_sel_hi:[1,0,1]
    s_waitcnt lgkmcnt(1)
    v_pk_fma_f32 v[144:145], v[176:177], v[4:5], v[144:145] op_sel:[0,0,0] op_sel_hi:[1,0,1]
    v_pk_fma_f32 v[146:147], v[178:179], v[4:5], v[146:147] op_sel:[0,0,0] op_sel_hi:[1,0,1]
    s_waitcnt lgkmcnt(0)
    v_pk_fma_f32 v[152:153], v[180:181], v[4:5], v[152:153] op_sel:[0,0,0] op_sel_hi:[1,0,1]
    v_pk_fma_f32 v[154:155], v[182:183], v[4:5], v[154:155] op_sel:[0,0,0] op_sel_hi:[1,0,1]
    v_pk_mul_f32 v[184:185], v[112:113], v[212:213] op_sel:[0,0] op_sel_hi:[1,0]
    v_pk_mul_f32 v[186:187], v[114:115], v[212:213] op_sel:[0,0] op_sel_hi:[1,0]
    v_pk_mul_f32 v[188:189], v[120:121], v[212:213] op_sel:[0,0] op_sel_hi:[1,0]
    v_pk_mul_f32 v[190:191], v[122:123], v[212:213] op_sel:[0,0] op_sel_hi:[1,0]
    v_pk_mul_f32 v[192:193], v[128:129], v[212:213] op_sel:[0,0] op_sel_hi:[1,0]
    v_pk_mul_f32 v[194:195], v[130:131], v[212:213] op_sel:[0,0] op_sel_hi:[1,0]
    v_exp_f32 v184, v184
    s_add_u32 s11, s21, 40960
    buffer_load_dwordx4 a[168:171], v10, s[40:43], s11 offen offset:0 sc1
    v_exp_f32 v185, v185
    v_exp_f32 v186, v186
    v_exp_f32 v187, v187
    v_exp_f32 v188, v188
    s_add_u32 s11, s21, 40960
    buffer_load_dwordx4 a[172:175], v10, s[40:43], s11 offen offset:1024 sc1
    v_exp_f32 v189, v189
    v_exp_f32 v190, v190
    v_exp_f32 v191, v191
    v_exp_f32 v192, v192
    s_add_u32 s11, s22, 40960
    buffer_load_dwordx4 a[176:179], v10, s[40:43], s11 offen offset:0 sc1
    v_exp_f32 v193, v193
    v_exp_f32 v194, v194
    v_exp_f32 v195, v195
    v_pk_mul_f32 v[112:113], v[112:113], v[136:137]
    v_pk_mul_f32 v[114:115], v[114:115], v[138:139]
    v_pk_mul_f32 v[120:121], v[120:121], v[144:145]
    v_pk_mul_f32 v[122:123], v[122:123], v[146:147]
    v_pk_mul_f32 v[128:129], v[128:129], v[152:153]
    v_pk_mul_f32 v[130:131], v[130:131], v[154:155]
    v_pk_fma_f32 v[184:185], v[184:185], v[212:213], v[212:213] op_sel:[0,1,1] op_sel_hi:[1,1,1]
    v_pk_fma_f32 v[186:187], v[186:187], v[212:213], v[212:213] op_sel:[0,1,1] op_sel_hi:[1,1,1]
    v_pk_fma_f32 v[188:189], v[188:189], v[212:213], v[212:213] op_sel:[0,1,1] op_sel_hi:[1,1,1]
    v_pk_fma_f32 v[190:191], v[190:191], v[212:213], v[212:213] op_sel:[0,1,1] op_sel_hi:[1,1,1]
    v_pk_fma_f32 v[192:193], v[192:193], v[212:213], v[212:213] op_sel:[0,1,1] op_sel_hi:[1,1,1]
    v_pk_fma_f32 v[194:195], v[194:195], v[212:213], v[212:213] op_sel:[0,1,1] op_sel_hi:[1,1,1]
    v_rcp_f32 v184, v184
    s_add_u32 s11, s20, 46080
    buffer_load_dwordx4 a[180:183], v10, s[40:43], s11 offen offset:0 sc1
    v_rcp_f32 v185, v185
    v_rcp_f32 v186, v186
    v_rcp_f32 v187, v187
    v_rcp_f32 v188, v188
    s_add_u32 s11, s20, 46080
    buffer_load_dwordx4 a[184:187], v10, s[40:43], s11 offen offset:1024 sc1
    v_rcp_f32 v189, v189
    v_rcp_f32 v190, v190
    v_rcp_f32 v191, v191
    v_rcp_f32 v192, v192
    s_add_u32 s11, s21, 46080
    buffer_load_dwordx4 a[188:191], v10, s[40:43], s11 offen offset:0 sc1
    v_rcp_f32 v193, v193
    v_rcp_f32 v194, v194
    v_rcp_f32 v195, v195
    v_pk_mul_f32 v[184:185], v[184:185], v[112:113]
    v_pk_mul_f32 v[186:187], v[186:187], v[114:115]
    v_pk_mul_f32 v[188:189], v[188:189], v[120:121]
    v_pk_mul_f32 v[190:191], v[190:191], v[122:123]
    v_pk_mul_f32 v[192:193], v[192:193], v[128:129]
    v_pk_mul_f32 v[194:195], v[194:195], v[130:131]
    v_cvt_pk_bf16_f32 v196, v184, v185
    v_cvt_pk_bf16_f32 v197, v186, v187
    v_cvt_pk_bf16_f32 v198, v188, v189
    v_cvt_pk_bf16_f32 v199, v190, v191
    v_cvt_pk_bf16_f32 v204, v192, v193
    v_cvt_pk_bf16_f32 v205, v194, v195
    buffer_store_dwordx4 v[196:199], v10, s[36:39], s12 offen sc1
    v_mul_f32 v212, 0xbfb8aa3b, v7
    v_mul_f32 v213, v7, v7
    v_rcp_f32 v213, v213
    v_pk_fma_f32 v[116:117], v[160:161], v[6:7], v[116:117] op_sel:[0,0,0] op_sel_hi:[1,0,1]
    v_pk_fma_f32 v[118:119], v[162:163], v[6:7], v[118:119] op_sel:[0,0,0] op_sel_hi:[1,0,1]
    v_pk_fma_f32 v[124:125], v[164:165], v[6:7], v[124:125] op_sel:[0,0,0] op_sel_hi:[1,0,1]
    v_pk_fma_f32 v[126:127], v[166:167], v[6:7], v[126:127] op_sel:[0,0,0] op_sel_hi:[1,0,1]
    v_pk_fma_f32 v[132:133], v[168:169], v[6:7], v[132:133] op_sel:[0,0,0] op_sel_hi:[1,0,1]
    v_pk_fma_f32 v[134:135], v[170:171], v[6:7], v[134:135] op_sel:[0,0,0] op_sel_hi:[1,0,1]
    v_pk_fma_f32 v[140:141], v[172:173], v[6:7], v[140:141] op_sel:[0,0,0] op_sel_hi:[1,0,1]
    v_pk_fma_f32 v[142:143], v[174:175], v[6:7], v[142:143] op_sel:[0,0,0] op_sel_hi:[1,0,1]
    v_pk_fma_f32 v[148:149], v[176:177], v[6:7], v[148:149] op_sel:[0,0,0] op_sel_hi:[1,0,1]
    v_pk_fma_f32 v[150:151], v[178:179], v[6:7], v[150:151] op_sel:[0,0,0] op_sel_hi:[1,0,1]
    v_pk_fma_f32 v[156:157], v[180:181], v[6:7], v[156:157] op_sel:[0,0,0] op_sel_hi:[1,0,1]
    v_pk_fma_f32 v[158:159], v[182:183], v[6:7], v[158:159] op_sel:[0,0,0] op_sel_hi:[1,0,1]
    v_pk_mul_f32 v[184:185], v[116:117], v[212:213] op_sel:[0,0] op_sel_hi:[1,0]
    v_pk_mul_f32 v[186:187], v[118:119], v[212:213] op_sel:[0,0] op_sel_hi:[1,0]
    v_pk_mul_f32 v[188:189], v[124:125], v[212:213] op_sel:[0,0] op_sel_hi:[1,0]
    v_pk_mul_f32 v[190:191], v[126:127], v[212:213] op_sel:[0,0] op_sel_hi:[1,0]
    v_pk_mul_f32 v[192:193], v[132:133], v[212:213] op_sel:[0,0] op_sel_hi:[1,0]
    v_pk_mul_f32 v[194:195], v[134:135], v[212:213] op_sel:[0,0] op_sel_hi:[1,0]
    v_exp_f32 v184, v184
    s_add_u32 s11, s21, 46080
    buffer_load_dwordx4 a[192:195], v10, s[40:43], s11 offen offset:1024 sc1
    v_exp_f32 v185, v185
    v_exp_f32 v186, v186
    v_exp_f32 v187, v187
    v_exp_f32 v188, v188
    s_add_u32 s11, s22, 46080
    buffer_load_dwordx4 a[196:199], v10, s[40:43], s11 offen offset:0 sc1
    v_exp_f32 v189, v189
    v_exp_f32 v190, v190
    v_exp_f32 v191, v191
    v_exp_f32 v192, v192
    s_add_u32 s11, s20, 51200
    buffer_load_dwordx4 a[200:203], v10, s[40:43], s11 offen offset:0 sc1
    v_exp_f32 v193, v193
    v_exp_f32 v194, v194
    v_exp_f32 v195, v195
    v_pk_mul_f32 v[116:117], v[116:117], v[140:141]
    v_pk_mul_f32 v[118:119], v[118:119], v[142:143]
    v_pk_mul_f32 v[124:125], v[124:125], v[148:149]
    v_pk_mul_f32 v[126:127], v[126:127], v[150:151]
    v_pk_mul_f32 v[132:133], v[132:133], v[156:157]
    v_pk_mul_f32 v[134:135], v[134:135], v[158:159]
    v_pk_fma_f32 v[184:185], v[184:185], v[212:213], v[212:213] op_sel:[0,1,1] op_sel_hi:[1,1,1]
    v_pk_fma_f32 v[186:187], v[186:187], v[212:213], v[212:213] op_sel:[0,1,1] op_sel_hi:[1,1,1]
    v_pk_fma_f32 v[188:189], v[188:189], v[212:213], v[212:213] op_sel:[0,1,1] op_sel_hi:[1,1,1]
    v_pk_fma_f32 v[190:191], v[190:191], v[212:213], v[212:213] op_sel:[0,1,1] op_sel_hi:[1,1,1]
    v_pk_fma_f32 v[192:193], v[192:193], v[212:213], v[212:213] op_sel:[0,1,1] op_sel_hi:[1,1,1]
    v_pk_fma_f32 v[194:195], v[194:195], v[212:213], v[212:213] op_sel:[0,1,1] op_sel_hi:[1,1,1]
    v_rcp_f32 v184, v184
    s_add_u32 s11, s20, 51200
    buffer_load_dwordx4 a[204:207], v10, s[40:43], s11 offen offset:1024 sc1
    v_rcp_f32 v185, v185
    v_rcp_f32 v186, v186
    v_rcp_f32 v187, v187
    v_rcp_f32 v188, v188
    s_add_u32 s11, s21, 51200
    buffer_load_dwordx4 a[208:211], v10, s[40:43], s11 offen offset:0 sc1
    v_rcp_f32 v189, v189
    v_rcp_f32 v190, v190
    v_rcp_f32 v191, v191
    v_rcp_f32 v192, v192
    s_add_u32 s11, s21, 51200
    buffer_load_dwordx4 a[212:215], v10, s[40:43], s11 offen offset:1024 sc1
    v_rcp_f32 v193, v193
    v_rcp_f32 v194, v194
    v_rcp_f32 v195, v195
    v_pk_mul_f32 v[184:185], v[184:185], v[116:117]
    v_pk_mul_f32 v[186:187], v[186:187], v[118:119]
    v_pk_mul_f32 v[188:189], v[188:189], v[124:125]
    v_pk_mul_f32 v[190:191], v[190:191], v[126:127]
    v_pk_mul_f32 v[192:193], v[192:193], v[132:133]
    v_pk_mul_f32 v[194:195], v[194:195], v[134:135]
    v_cvt_pk_bf16_f32 v200, v184, v185
    v_cvt_pk_bf16_f32 v201, v186, v187
    v_cvt_pk_bf16_f32 v202, v188, v189
    v_cvt_pk_bf16_f32 v203, v190, v191
    v_cvt_pk_bf16_f32 v206, v192, v193
    v_cvt_pk_bf16_f32 v207, v194, v195
    s_add_u32 s13, s12, 49152
    buffer_store_dwordx4 v[200:203], v10, s[36:39], s13 offen sc1
    v_permlane16_swap_b32 v204, v206
    v_permlane16_swap_b32 v205, v207
    buffer_store_dwordx4 v[204:207], v8, s[36:39], s12 offen offset:1024 sc1
    ds_read_b128 v[160:163], v10 offset:0
    ds_read_b128 v[164:167], v10 offset:1024
    ds_read_b128 v[168:171], v10 offset:2048
    ds_read_b128 v[172:175], v10 offset:3072
    ds_read_b128 v[176:179], v10 offset:4096
    ds_read_b128 v[180:183], v10 offset:5120
    v_swap_b32 v82, v84
    v_swap_b32 v83, v85
    s_waitcnt lgkmcnt(5)
    s_nop 0
    v_mfma_f32_16x16x32_bf16 v[112:115], v[160:163], v[80:83], 0
    s_add_u32 s10, s17, 180224
    buffer_load_dwordx4 v[48:51], v250, s[28:31], s10 offen offset:0 sc1
    s_waitcnt lgkmcnt(4)
    v_mfma_f32_16x16x32_bf16 v[116:119], v[160:163], v[84:87], 0
    ds_read_b128 v[160:163], v10 offset:6144
    v_mfma_f32_16x16x32_bf16 v[120:123], v[164:167], v[80:83], 0
    s_waitcnt lgkmcnt(4)
    v_mfma_f32_16x16x32_bf16 v[124:127], v[164:167], v[84:87], 0
    ds_read_b128 v[164:167], v10 offset:7168
    v_mfma_f32_16x16x32_bf16 v[128:131], v[168:171], v[80:83], 0
    buffer_load_dwordx4 v[52:55], v250, s[28:31], s10 offen offset:256 sc1
    s_waitcnt lgkmcnt(4)
    v_mfma_f32_16x16x32_bf16 v[132:135], v[168:171], v[84:87], 0
    ds_read_b128 v[168:171], v10 offset:8192
    v_mfma_f32_16x16x32_bf16 v[136:139], v[172:175], v[80:83], 0
    s_waitcnt lgkmcnt(4)
    v_mfma_f32_16x16x32_bf16 v[140:143], v[172:175], v[84:87], 0
    v_swap_b32 v90, v92
    v_swap_b32 v91, v93
    ds_read_b128 v[172:175], v10 offset:9216
    v_mfma_f32_16x16x32_bf16 v[144:147], v[176:179], v[80:83], 0
    s_add_u32 s11, s22, 51200
    buffer_load_dwordx4 a[216:219], v10, s[40:43], s11 offen offset:0 sc1
    s_waitcnt lgkmcnt(4)
    v_mfma_f32_16x16x32_bf16 v[148:151], v[176:179], v[84:87], 0
    ds_read_b128 v[176:179], v10 offset:10240
    v_mfma_f32_16x16x32_bf16 v[152:155], v[180:183], v[80:83], 0
    s_waitcnt lgkmcnt(4)
    v_mfma_f32_16x16x32_bf16 v[156:159], v[180:183], v[84:87], 0
    ds_read_b128 v[180:183], v10 offset:11264
    v_mfma_f32_16x16x32_bf16 v[112:115], v[160:163], v[88:91], v[112:115]
    s_add_u32 s10, s17, 182272
    buffer_load_dwordx4 v[56:59], v250, s[28:31], s10 offen offset:0 sc1
    s_waitcnt lgkmcnt(4)
    v_mfma_f32_16x16x32_bf16 v[116:119], v[160:163], v[92:95], v[116:119]
    ds_read_b128 v[160:163], v10 offset:12288
    v_mfma_f32_16x16x32_bf16 v[120:123], v[164:167], v[88:91], v[120:123]
    s_waitcnt lgkmcnt(4)
    v_mfma_f32_16x16x32_bf16 v[124:127], v[164:167], v[92:95], v[124:127]
    ds_read_b128 v[164:167], v10 offset:13312
    v_mfma_f32_16x16x32_bf16 v[128:131], v[168:171], v[88:91], v[128:131]
    buffer_load_dwordx4 v[60:63], v250, s[28:31], s10 offen offset:256 sc1
    s_waitcnt lgkmcnt(4)
    v_mfma_f32_16x16x32_bf16 v[132:135], v[168:171], v[92:95], v[132:135]
    ds_read_b128 v[168:171], v10 offset:14336
    v_mfma_f32_16x16x32_bf16 v[136:139], v[172:175], v[88:91], v[136:139]
    s_waitcnt lgkmcnt(4)
    v_mfma_f32_16x16x32_bf16 v[140:143], v[172:175], v[92:95], v[140:143]
    s_waitcnt vmcnt(36)
    v_swap_b32 v98, v100
    v_swap_b32 v99, v101
    ds_read_b128 v[172:175], v10 offset:15360
    v_mfma_f32_16x16x32_bf16 v[144:147], v[176:179], v[88:91], v[144:147]
    s_add_u32 s11, s20, 56320
    buffer_load_dwordx4 a[220:223], v10, s[40:43], s11 offen offset:0 sc1
    s_waitcnt lgkmcnt(4)
    v_mfma_f32_16x16x32_bf16 v[148:151], v[176:179], v[92:95], v[148:151]
    ds_read_b128 v[176:179], v10 offset:16384
    v_mfma_f32_16x16x32_bf16 v[152:155], v[180:183], v[88:91], v[152:155]
    s_waitcnt lgkmcnt(4)
    v_mfma_f32_16x16x32_bf16 v[156:159], v[180:183], v[92:95], v[156:159]
    ds_read_b128 v[180:183], v10 offset:17408
    v_mfma_f32_16x16x32_bf16 v[112:115], v[160:163], v[96:99], v[112:115]
    s_add_u32 s10, s17, 184320
    buffer_load_dwordx4 v[64:67], v250, s[28:31], s10 offen offset:0 sc1
    s_waitcnt lgkmcnt(4)
    v_mfma_f32_16x16x32_bf16 v[116:119], v[160:163], v[100:103], v[116:119]
    ds_read_b128 v[160:163], v10 offset:18432
    v_mfma_f32_16x16x32_bf16 v[120:123], v[164:167], v[96:99], v[120:123]
    s_waitcnt lgkmcnt(4)
    v_mfma_f32_16x16x32_bf16 v[124:127], v[164:167], v[100:103], v[124:127]
    ds_read_b128 v[164:167], v10 offset:19456
    v_mfma_f32_16x16x32_bf16 v[128:131], v[168:171], v[96:99], v[128:131]
    buffer_load_dwordx4 v[68:71], v250, s[28:31], s10 offen offset:256 sc1
    s_waitcnt lgkmcnt(4)
    v_mfma_f32_16x16x32_bf16 v[132:135], v[168:171], v[100:103], v[132:135]
    ds_read_b128 v[168:171], v10 offset:20480
    v_mfma_f32_16x16x32_bf16 v[136:139], v[172:175], v[96:99], v[136:139]
    s_waitcnt lgkmcnt(4)
    v_mfma_f32_16x16x32_bf16 v[140:143], v[172:175], v[100:103], v[140:143]
    s_waitcnt vmcnt(36)
    v_swap_b32 v106, v108
    v_swap_b32 v107, v109
    ds_read_b128 v[172:175], v10 offset:21504
    v_mfma_f32_16x16x32_bf16 v[144:147], v[176:179], v[96:99], v[144:147]
    s_add_u32 s11, s20, 56320
    buffer_load_dwordx4 a[224:227], v10, s[40:43], s11 offen offset:1024 sc1
    s_waitcnt lgkmcnt(4)
    v_mfma_f32_16x16x32_bf16 v[148:151], v[176:179], v[100:103], v[148:151]
    ds_read_b128 v[176:179], v10 offset:22528
    v_mfma_f32_16x16x32_bf16 v[152:155], v[180:183], v[96:99], v[152:155]
    s_waitcnt lgkmcnt(4)
    v_mfma_f32_16x16x32_bf16 v[156:159], v[180:183], v[100:103], v[156:159]
    ds_read_b128 v[180:183], v10 offset:23552
    v_mfma_f32_16x16x32_bf16 v[112:115], v[160:163], v[104:107], v[112:115]
    s_add_u32 s10, s17, 186368
    buffer_load_dwordx4 v[72:75], v250, s[28:31], s10 offen offset:0 sc1
    s_waitcnt lgkmcnt(4)
    v_mfma_f32_16x16x32_bf16 v[116:119], v[160:163], v[108:111], v[116:119]
    ds_read_b128 v[160:163], v10 offset:24576
    v_mfma_f32_16x16x32_bf16 v[120:123], v[164:167], v[104:107], v[120:123]
    s_waitcnt lgkmcnt(4)
    v_mfma_f32_16x16x32_bf16 v[124:127], v[164:167], v[108:111], v[124:127]
    ds_read_b128 v[164:167], v10 offset:25600
    v_mfma_f32_16x16x32_bf16 v[128:131], v[168:171], v[104:107], v[128:131]
    buffer_load_dwordx4 v[76:79], v250, s[28:31], s10 offen offset:256 sc1
    s_waitcnt lgkmcnt(4)
    v_mfma_f32_16x16x32_bf16 v[132:135], v[168:171], v[108:111], v[132:135]
    ds_read_b128 v[168:171], v10 offset:26624
    v_mfma_f32_16x16x32_bf16 v[136:139], v[172:175], v[104:107], v[136:139]
    s_waitcnt lgkmcnt(4)
    v_mfma_f32_16x16x32_bf16 v[140:143], v[172:175], v[108:111], v[140:143]
    s_waitcnt vmcnt(36)
    v_swap_b32 v18, v20
    v_swap_b32 v19, v21
    ds_read_b128 v[172:175], v10 offset:27648
    v_mfma_f32_16x16x32_bf16 v[144:147], v[176:179], v[104:107], v[144:147]
    s_add_u32 s11, s21, 56320
    buffer_load_dwordx4 a[228:231], v10, s[40:43], s11 offen offset:0 sc1
    s_waitcnt lgkmcnt(4)
    v_mfma_f32_16x16x32_bf16 v[148:151], v[176:179], v[108:111], v[148:151]
    ds_read_b128 v[176:179], v10 offset:28672
    v_mfma_f32_16x16x32_bf16 v[152:155], v[180:183], v[104:107], v[152:155]
    s_waitcnt lgkmcnt(4)
    v_mfma_f32_16x16x32_bf16 v[156:159], v[180:183], v[108:111], v[156:159]
    ds_read_b128 v[180:183], v10 offset:29696
    s_lshl_b32 s12, s4, 3
    s_add_u32 s12, s12, s3
    s_lshl_b32 s12, s12, 5
    s_add_u32 s12, s12, s5
    s_lshl_b32 s12, s12, 7
    s_add_u32 s12, s12, 589824
    v_mov_b32 v254, s100
    v_mov_b32 v255, s101
    s_waitcnt vmcnt(12)
    buffer_store_dwordx2 v[254:255], v252, s[44:47], s12 offen sc1
    v_mfma_f32_16x16x32_bf16 v[112:115], v[160:163], v[16:19], v[112:115]
    s_add_u32 s10, s17, 188416
    buffer_load_dwordx4 v[80:83], v250, s[28:31], s10 offen offset:0 sc1
    s_waitcnt lgkmcnt(4)
    v_mfma_f32_16x16x32_bf16 v[116:119], v[160:163], v[20:23], v[116:119]
    ds_read_b128 v[160:163], v10 offset:30720
    v_mfma_f32_16x16x32_bf16 v[120:123], v[164:167], v[16:19], v[120:123]
    s_waitcnt lgkmcnt(4)
    v_mfma_f32_16x16x32_bf16 v[124:127], v[164:167], v[20:23], v[124:127]
    ds_read_b128 v[164:167], v10 offset:31744
    v_mfma_f32_16x16x32_bf16 v[128:131], v[168:171], v[16:19], v[128:131]
    buffer_load_dwordx4 v[84:87], v250, s[28:31], s10 offen offset:256 sc1
    s_waitcnt lgkmcnt(4)
    v_mfma_f32_16x16x32_bf16 v[132:135], v[168:171], v[20:23], v[132:135]
    ds_read_b128 v[168:171], v10 offset:32768
    v_mfma_f32_16x16x32_bf16 v[136:139], v[172:175], v[16:19], v[136:139]
    s_waitcnt lgkmcnt(4)
    v_mfma_f32_16x16x32_bf16 v[140:143], v[172:175], v[20:23], v[140:143]
    v_swap_b32 v26, v28
    v_swap_b32 v27, v29
    ds_read_b128 v[172:175], v10 offset:33792
    v_mfma_f32_16x16x32_bf16 v[144:147], v[176:179], v[16:19], v[144:147]
    s_add_u32 s11, s21, 56320
    buffer_load_dwordx4 a[232:235], v10, s[40:43], s11 offen offset:1024 sc1
    s_waitcnt lgkmcnt(4)
    v_mfma_f32_16x16x32_bf16 v[148:151], v[176:179], v[20:23], v[148:151]
    ds_read_b128 v[176:179], v10 offset:34816
    v_mfma_f32_16x16x32_bf16 v[152:155], v[180:183], v[16:19], v[152:155]
    s_waitcnt lgkmcnt(4)
    v_mfma_f32_16x16x32_bf16 v[156:159], v[180:183], v[20:23], v[156:159]
    ds_read_b128 v[180:183], v10 offset:35840
    v_mfma_f32_16x16x32_bf16 v[112:115], v[160:163], v[24:27], v[112:115]
    s_add_u32 s10, s17, 190464
    buffer_load_dwordx4 v[88:91], v250, s[28:31], s10 offen offset:0 sc1
    s_waitcnt lgkmcnt(4)
    v_mfma_f32_16x16x32_bf16 v[116:119], v[160:163], v[28:31], v[116:119]
    ds_read_b128 v[160:163], v10 offset:36864
    v_mfma_f32_16x16x32_bf16 v[120:123], v[164:167], v[24:27], v[120:123]
    s_waitcnt lgkmcnt(4)
    v_mfma_f32_16x16x32_bf16 v[124:127], v[164:167], v[28:31], v[124:127]
    ds_read_b128 v[164:167], v10 offset:37888
    v_mfma_f32_16x16x32_bf16 v[128:131], v[168:171], v[24:27], v[128:131]
    buffer_load_dwordx4 v[92:95], v250, s[28:31], s10 offen offset:256 sc1
    s_waitcnt lgkmcnt(4)
    v_mfma_f32_16x16x32_bf16 v[132:135], v[168:171], v[28:31], v[132:135]
    ds_read_b128 v[168:171], v10 offset:38912
    v_mfma_f32_16x16x32_bf16 v[136:139], v[172:175], v[24:27], v[136:139]
    s_waitcnt lgkmcnt(4)
    v_mfma_f32_16x16x32_bf16 v[140:143], v[172:175], v[28:31], v[140:143]
    v_swap_b32 v34, v36
    v_swap_b32 v35, v37
    ds_read_b128 v[172:175], v10 offset:39936
    v_mfma_f32_16x16x32_bf16 v[144:147], v[176:179], v[24:27], v[144:147]
    s_add_u32 s11, s22, 56320
    buffer_load_dwordx4 a[236:239], v10, s[40:43], s11 offen offset:0 sc1
    s_waitcnt lgkmcnt(4)
    v_mfma_f32_16x16x32_bf16 v[148:151], v[176:179], v[28:31], v[148:151]
    ds_read_b128 v[176:179], v10 offset:40960
    v_mfma_f32_16x16x32_bf16 v[152:155], v[180:183], v[24:27], v[152:155]
    s_waitcnt lgkmcnt(4)
    v_mfma_f32_16x16x32_bf16 v[156:159], v[180:183], v[28:31], v[156:159]
    ds_read_b128 v[180:183], v10 offset:41984
    v_mfma_f32_16x16x32_bf16 v[112:115], v[160:163], v[32:35], v[112:115]
    s_waitcnt lgkmcnt(4)
    v_mfma_f32_16x16x32_bf16 v[116:119], v[160:163], v[36:39], v[116:119]
    s_add_u32 s10, s17, 192512
    ds_read_b128 v[160:163], v10 offset:43008
    v_mfma_f32_16x16x32_bf16 v[120:123], v[164:167], v[32:35], v[120:123]
    buffer_load_dwordx4 v[96:99], v250, s[28:31], s10 offen offset:0 sc1
    s_waitcnt lgkmcnt(4)
    v_mfma_f32_16x16x32_bf16 v[124:127], v[164:167], v[36:39], v[124:127]
    ds_read_b128 v[164:167], v10 offset:44032
    v_mfma_f32_16x16x32_bf16 v[128:131], v[168:171], v[32:35], v[128:131]
    s_waitcnt lgkmcnt(4)
    v_mfma_f32_16x16x32_bf16 v[132:135], v[168:171], v[36:39], v[132:135]
    ds_read_b128 v[168:171], v10 offset:45056
    v_mfma_f32_16x16x32_bf16 v[136:139], v[172:175], v[32:35], v[136:139]
    s_waitcnt lgkmcnt(4)
    v_mfma_f32_16x16x32_bf16 v[140:143], v[172:175], v[36:39], v[140:143]
    v_swap_b32 v42, v44
    v_swap_b32 v43, v45
    ds_read_b128 v[172:175], v10 offset:46080
    v_mfma_f32_16x16x32_bf16 v[144:147], v[176:179], v[32:35], v[144:147]
    buffer_load_dwordx4 v[100:103], v250, s[28:31], s10 offen offset:256 sc1
    s_waitcnt lgkmcnt(4)
    v_mfma_f32_16x16x32_bf16 v[148:151], v[176:179], v[36:39], v[148:151]
    ds_read_b128 v[176:179], v10 offset:47104
    v_mfma_f32_16x16x32_bf16 v[152:155], v[180:183], v[32:35], v[152:155]
    s_waitcnt lgkmcnt(4)
    v_mfma_f32_16x16x32_bf16 v[156:159], v[180:183], v[36:39], v[156:159]
    ds_read_b128 v[180:183], v10 offset:48128
    v_mfma_f32_16x16x32_bf16 v[112:115], v[160:163], v[40:43], v[112:115]
    s_add_u32 s10, s17, 194560
    buffer_load_dwordx4 v[104:107], v250, s[28:31], s10 offen offset:0 sc1
    s_waitcnt lgkmcnt(4)
    v_mfma_f32_16x16x32_bf16 v[116:119], v[160:163], v[44:47], v[116:119]
    ds_read_b128 v[160:163], v10 offset:49152
    v_mfma_f32_16x16x32_bf16 v[120:123], v[164:167], v[40:43], v[120:123]
    s_waitcnt lgkmcnt(4)
    v_mfma_f32_16x16x32_bf16 v[124:127], v[164:167], v[44:47], v[124:127]
    ds_read_b128 v[164:167], v10 offset:50176
    v_mfma_f32_16x16x32_bf16 v[128:131], v[168:171], v[40:43], v[128:131]
    buffer_load_dwordx4 v[108:111], v250, s[28:31], s10 offen offset:256 sc1
    s_waitcnt lgkmcnt(4)
    v_mfma_f32_16x16x32_bf16 v[132:135], v[168:171], v[44:47], v[132:135]
    ds_read_b128 v[168:171], v10 offset:51200
    v_mfma_f32_16x16x32_bf16 v[136:139], v[172:175], v[40:43], v[136:139]
    s_waitcnt lgkmcnt(4)
    v_mfma_f32_16x16x32_bf16 v[140:143], v[172:175], v[44:47], v[140:143]
    s_waitcnt vmcnt(21)
    v_swap_b32 v50, v52
    v_swap_b32 v51, v53
    ds_read_b128 v[172:175], v10 offset:52224
    v_mfma_f32_16x16x32_bf16 v[144:147], v[176:179], v[40:43], v[144:147]
    s_mov_b32 s13, 589824
    s_mov_b32 exec_lo, 0xff
    s_mov_b32 exec_hi, 0
    buffer_load_dwordx2 v[214:215], v253, s[44:47], s13 offen sc1
    s_mov_b64 exec, -1
    s_waitcnt lgkmcnt(4)
    v_mfma_f32_16x16x32_bf16 v[148:151], v[176:179], v[44:47], v[148:151]
    ds_read_b128 v[176:179], v10 offset:53248
    v_mfma_f32_16x16x32_bf16 v[152:155], v[180:183], v[40:43], v[152:155]
    s_waitcnt lgkmcnt(4)
    v_mfma_f32_16x16x32_bf16 v[156:159], v[180:183], v[44:47], v[156:159]
    ds_read_b128 v[180:183], v10 offset:54272
    v_mfma_f32_16x16x32_bf16 v[112:115], v[160:163], v[48:51], v[112:115]
    s_waitcnt lgkmcnt(4)
    v_mfma_f32_16x16x32_bf16 v[116:119], v[160:163], v[52:55], v[116:119]
    s_add_u32 s10, s17, 196608
    ds_read_b128 v[160:163], v10 offset:55296
    v_mfma_f32_16x16x32_bf16 v[120:123], v[164:167], v[48:51], v[120:123]
    buffer_load_dwordx4 v[16:19], v250, s[28:31], s10 offen offset:0 sc1
    s_waitcnt lgkmcnt(4)
    v_mfma_f32_16x16x32_bf16 v[124:127], v[164:167], v[52:55], v[124:127]
    ds_read_b128 v[164:167], v10 offset:56320
    v_mfma_f32_16x16x32_bf16 v[128:131], v[168:171], v[48:51], v[128:131]
    s_waitcnt lgkmcnt(4)
    v_mfma_f32_16x16x32_bf16 v[132:135], v[168:171], v[52:55], v[132:135]
    ds_read_b128 v[168:171], v10 offset:57344
    v_mfma_f32_16x16x32_bf16 v[136:139], v[172:175], v[48:51], v[136:139]
    s_waitcnt lgkmcnt(4)
    v_mfma_f32_16x16x32_bf16 v[140:143], v[172:175], v[52:55], v[140:143]
    s_waitcnt vmcnt(20)
    v_swap_b32 v58, v60
    v_swap_b32 v59, v61
    ds_read_b128 v[172:175], v10 offset:58368
    v_mfma_f32_16x16x32_bf16 v[144:147], v[176:179], v[48:51], v[144:147]
    buffer_load_dwordx4 v[20:23], v250, s[28:31], s10 offen offset:256 sc1
    s_waitcnt lgkmcnt(4)
    v_mfma_f32_16x16x32_bf16 v[148:151], v[176:179], v[52:55], v[148:151]
    ds_read_b128 v[176:179], v10 offset:59392
    v_mfma_f32_16x16x32_bf16 v[152:155], v[180:183], v[48:51], v[152:155]
    s_waitcnt lgkmcnt(4)
    v_mfma_f32_16x16x32_bf16 v[156:159], v[180:183], v[52:55], v[156:159]
    ds_read_b128 v[180:183], v10 offset:60416
    v_mfma_f32_16x16x32_bf16 v[112:115], v[160:163], v[56:59], v[112:115]
    s_waitcnt lgkmcnt(4)
    v_mfma_f32_16x16x32_bf16 v[116:119], v[160:163], v[60:63], v[116:119]
    s_add_u32 s10, s17, 198656
    ds_read_b128 v[160:163], v11 offset:0
    v_mfma_f32_16x16x32_bf16 v[120:123], v[164:167], v[56:59], v[120:123]
    buffer_load_dwordx4 v[24:27], v250, s[28:31], s10 offen offset:0 sc1
    s_waitcnt lgkmcnt(4)
    v_mfma_f32_16x16x32_bf16 v[124:127], v[164:167], v[60:63], v[124:127]
    ds_read_b128 v[164:167], v11 offset:1024
    v_mfma_f32_16x16x32_bf16 v[128:131], v[168:171], v[56:59], v[128:131]
    s_waitcnt lgkmcnt(4)
    v_mfma_f32_16x16x32_bf16 v[132:135], v[168:171], v[60:63], v[132:135]
    ds_read_b128 v[168:171], v11 offset:2048
    v_mfma_f32_16x16x32_bf16 v[136:139], v[172:175], v[56:59], v[136:139]
    s_waitcnt lgkmcnt(4)
    v_mfma_f32_16x16x32_bf16 v[140:143], v[172:175], v[60:63], v[140:143]
    s_waitcnt vmcnt(19)
    v_swap_b32 v66, v68
    v_swap_b32 v67, v69
    ds_read_b128 v[172:175], v11 offset:3072
    v_mfma_f32_16x16x32_bf16 v[144:147], v[176:179], v[56:59], v[144:147]
    buffer_load_dwordx4 v[28:31], v250, s[28:31], s10 offen offset:256 sc1
    s_waitcnt lgkmcnt(4)
    v_mfma_f32_16x16x32_bf16 v[148:151], v[176:179], v[60:63], v[148:151]
    ds_read_b128 v[176:179], v11 offset:4096
    v_mfma_f32_16x16x32_bf16 v[152:155], v[180:183], v[56:59], v[152:155]
    s_waitcnt lgkmcnt(4)
    v_mfma_f32_16x16x32_bf16 v[156:159], v[180:183], v[60:63], v[156:159]
    ds_read_b128 v[180:183], v11 offset:5120
    v_mfma_f32_16x16x32_bf16 v[112:115], v[160:163], v[64:67], v[112:115]
    s_waitcnt lgkmcnt(4)
    v_mfma_f32_16x16x32_bf16 v[116:119], v[160:163], v[68:71], v[116:119]
    s_add_u32 s10, s17, 200704
    ds_read_b128 v[160:163], v11 offset:6144
    v_mfma_f32_16x16x32_bf16 v[120:123], v[164:167], v[64:67], v[120:123]
    buffer_load_dwordx4 v[32:35], v250, s[28:31], s10 offen offset:0 sc1
    s_waitcnt lgkmcnt(4)
    v_mfma_f32_16x16x32_bf16 v[124:127], v[164:167], v[68:71], v[124:127]
    ds_read_b128 v[164:167], v11 offset:7168
    v_mfma_f32_16x16x32_bf16 v[128:131], v[168:171], v[64:67], v[128:131]
    s_waitcnt lgkmcnt(4)
    v_mfma_f32_16x16x32_bf16 v[132:135], v[168:171], v[68:71], v[132:135]
    ds_read_b128 v[168:171], v11 offset:8192
    v_mfma_f32_16x16x32_bf16 v[136:139], v[172:175], v[64:67], v[136:139]
    s_waitcnt lgkmcnt(4)
    v_mfma_f32_16x16x32_bf16 v[140:143], v[172:175], v[68:71], v[140:143]
    s_waitcnt vmcnt(18)
    v_swap_b32 v74, v76
    v_swap_b32 v75, v77
    ds_read_b128 v[172:175], v11 offset:9216
    v_mfma_f32_16x16x32_bf16 v[144:147], v[176:179], v[64:67], v[144:147]
    buffer_load_dwordx4 v[36:39], v250, s[28:31], s10 offen offset:256 sc1
    s_waitcnt lgkmcnt(4)
    v_mfma_f32_16x16x32_bf16 v[148:151], v[176:179], v[68:71], v[148:151]
    ds_read_b128 v[176:179], v11 offset:10240
    v_mfma_f32_16x16x32_bf16 v[152:155], v[180:183], v[64:67], v[152:155]
    s_waitcnt lgkmcnt(4)
    v_mfma_f32_16x16x32_bf16 v[156:159], v[180:183], v[68:71], v[156:159]
    ds_read_b128 v[180:183], v11 offset:11264
    v_mfma_f32_16x16x32_bf16 v[112:115], v[160:163], v[72:75], v[112:115]
    s_waitcnt lgkmcnt(4)
    v_mfma_f32_16x16x32_bf16 v[116:119], v[160:163], v[76:79], v[116:119]
    s_add_u32 s10, s17, 202752
    ds_read_b128 v[160:163], v11 offset:12288
    v_mfma_f32_16x16x32_bf16 v[120:123], v[164:167], v[72:75], v[120:123]
    buffer_load_dwordx4 v[40:43], v250, s[28:31], s10 offen offset:0 sc1
    s_waitcnt lgkmcnt(4)
    v_mfma_f32_16x16x32_bf16 v[124:127], v[164:167], v[76:79], v[124:127]
    ds_read_b128 v[164:167], v11 offset:13312
    v_mfma_f32_16x16x32_bf16 v[128:131], v[168:171], v[72:75], v[128:131]
    s_waitcnt lgkmcnt(4)
    v_mfma_f32_16x16x32_bf16 v[132:135], v[168:171], v[76:79], v[132:135]
    ds_read_b128 v[168:171], v11 offset:14336
    v_mfma_f32_16x16x32_bf16 v[136:139], v[172:175], v[72:75], v[136:139]
    s_waitcnt lgkmcnt(4)
    v_mfma_f32_16x16x32_bf16 v[140:143], v[172:175], v[76:79], v[140:143]
    s_waitcnt vmcnt(16)
    v_swap_b32 v82, v84
    v_swap_b32 v83, v85
    ds_read_b128 v[172:175], v11 offset:15360
    v_mfma_f32_16x16x32_bf16 v[144:147], v[176:179], v[72:75], v[144:147]
    buffer_load_dwordx4 v[44:47], v250, s[28:31], s10 offen offset:256 sc1
    s_waitcnt lgkmcnt(4)
    v_mfma_f32_16x16x32_bf16 v[148:151], v[176:179], v[76:79], v[148:151]
    ds_read_b128 v[176:179], v11 offset:16384
    v_mfma_f32_16x16x32_bf16 v[152:155], v[180:183], v[72:75], v[152:155]
    s_waitcnt lgkmcnt(4)
    v_mfma_f32_16x16x32_bf16 v[156:159], v[180:183], v[76:79], v[156:159]
    ds_read_b128 v[180:183], v11 offset:17408
    v_mfma_f32_16x16x32_bf16 v[112:115], v[160:163], v[80:83], v[112:115]
    s_lshl_b32 s13, s15, 9
    s_add_u32 s13, s13, 4096
    buffer_load_dwordx2 v[208:209], v0, s[44:47], s13 offen offset:0 sc1
    s_waitcnt lgkmcnt(4)
    v_mfma_f32_16x16x32_bf16 v[116:119], v[160:163], v[84:87], v[116:119]
    ds_read_b128 v[160:163], v11 offset:18432
    v_mfma_f32_16x16x32_bf16 v[120:123], v[164:167], v[80:83], v[120:123]
    buffer_load_dwordx2 v[210:211], v0, s[44:47], s13 offen offset:512 sc1
    s_add_u32 s13, s62, 0
    s_lshl_b32 s12, s14, 11
    s_add_u32 s12, s12, s13
    s_add_u32 s13, s13, 4096
    buffer_load_dwordx2 v[216:217], v250, s[28:31], s12 offen sc1
    s_waitcnt lgkmcnt(4)
    v_mfma_f32_16x16x32_bf16 v[124:127], v[164:167], v[84:87], v[124:127]
    ds_read_b128 v[164:167], v11 offset:19456
    v_mfma_f32_16x16x32_bf16 v[128:131], v[168:171], v[80:83], v[128:131]
    buffer_load_dwordx2 v[218:219], v250, s[28:31], s12 offen offset:256 sc1
    s_waitcnt lgkmcnt(4)
    v_mfma_f32_16x16x32_bf16 v[132:135], v[168:171], v[84:87], v[132:135]
    ds_read_b128 v[168:171], v11 offset:20480
    v_mfma_f32_16x16x32_bf16 v[136:139], v[172:175], v[80:83], v[136:139]
    buffer_load_dwordx2 v[220:221], v10, s[28:31], s13 offen sc1
    s_waitcnt lgkmcnt(4)
    v_mfma_f32_16x16x32_bf16 v[140:143], v[172:175], v[84:87], v[140:143]
    s_waitcnt vmcnt(19)
    v_swap_b32 v90, v92
    v_swap_b32 v91, v93
    ds_read_b128 v[172:175], v11 offset:21504
    v_mfma_f32_16x16x32_bf16 v[144:147], v[176:179], v[80:83], v[144:147]
    buffer_load_dwordx2 v[228:229], v250, s[52:55], s12 offen sc1
    buffer_load_dwordx2 v[230:231], v250, s[52:55], s12 offen offset:256 sc1
    s_waitcnt lgkmcnt(4)
    v_mfma_f32_16x16x32_bf16 v[148:151], v[176:179], v[84:87], v[148:151]
    ds_read_b128 v[176:179], v11 offset:22528
    v_mfma_f32_16x16x32_bf16 v[152:155], v[180:183], v[80:83], v[152:155]
    buffer_load_dwordx2 v[232:233], v10, s[52:55], s13 offen sc1
    s_waitcnt lgkmcnt(4)
    v_mfma_f32_16x16x32_bf16 v[156:159], v[180:183], v[84:87], v[156:159]
    ds_read_b128 v[180:183], v11 offset:23552
    v_mfma_f32_16x16x32_bf16 v[112:115], v[160:163], v[88:91], v[112:115]
    s_waitcnt lgkmcnt(4)
    v_mfma_f32_16x16x32_bf16 v[116:119], v[160:163], v[92:95], v[116:119]
    ds_read_b128 v[160:163], v11 offset:24576
    v_mfma_f32_16x16x32_bf16 v[120:123], v[164:167], v[88:91], v[120:123]
    s_waitcnt lgkmcnt(4)
    v_mfma_f32_16x16x32_bf16 v[124:127], v[164:167], v[92:95], v[124:127]
    ds_read_b128 v[164:167], v11 offset:25600
    v_mfma_f32_16x16x32_bf16 v[128:131], v[168:171], v[88:91], v[128:131]
    s_waitcnt lgkmcnt(4)
    v_mfma_f32_16x16x32_bf16 v[132:135], v[168:171], v[92:95], v[132:135]
    ds_read_b128 v[168:171], v11 offset:26624
    v_mfma_f32_16x16x32_bf16 v[136:139], v[172:175], v[88:91], v[136:139]
    s_waitcnt lgkmcnt(4)
    v_mfma_f32_16x16x32_bf16 v[140:143], v[172:175], v[92:95], v[140:143]
    s_waitcnt vmcnt(19)
    v_swap_b32 v98, v100
    v_swap_b32 v99, v101
    ds_read_b128 v[172:175], v11 offset:27648
    v_mfma_f32_16x16x32_bf16 v[144:147], v[176:179], v[88:91], v[144:147]
    s_waitcnt lgkmcnt(4)
    v_mfma_f32_16x16x32_bf16 v[148:151], v[176:179], v[92:95], v[148:151]
    ds_read_b128 v[176:179], v11 offset:28672
    v_mfma_f32_16x16x32_bf16 v[152:155], v[180:183], v[88:91], v[152:155]
    s_waitcnt lgkmcnt(4)
    v_mfma_f32_16x16x32_bf16 v[156:159], v[180:183], v[92:95], v[156:159]
    ds_read_b128 v[180:183], v11 offset:29696
    s_waitcnt vmcnt(16)
    v_mov_b32 v214, v214
    s_mov_b32 exec_lo, 0xff
    s_mov_b32 exec_hi, 0
    v_cmp_eq_u64 vcc, s[100:101], v[214:215]
    s_nop 0
    s_cmp_eq_u64 vcc, exec
    s_mov_b64 exec, -1
    s_cbranch_scc1 interleave_layers__ssm_conv_h3__swiglu_ffn__prompt_kernel_ok21
    s_mov_b32 s23, 0
interleave_layers__ssm_conv_h3__swiglu_ffn__prompt_kernel_spin22:
    s_sleep 1
    s_mov_b32 s13, 589824
    s_mov_b32 exec_lo, 0xff
    s_mov_b32 exec_hi, 0
    buffer_load_dwordx2 v[214:215], v253, s[44:47], s13 offen sc1
    s_mov_b64 exec, -1
    s_waitcnt vmcnt(0)
    s_add_u32 s23, s23, 1
    s_cmp_ge_u32 s23, 262144
    s_cbranch_scc1 interleave_layers__ssm_conv_h3__swiglu_ffn__prompt_kernel_ok21
    v_mov_b32 v214, v214
    s_mov_b32 exec_lo, 0xff
    s_mov_b32 exec_hi, 0
    v_cmp_eq_u64 vcc, s[100:101], v[214:215]
    s_nop 0
    s_cmp_eq_u64 vcc, exec
    s_mov_b64 exec, -1
    s_cbranch_scc0 interleave_layers__ssm_conv_h3__swiglu_ffn__prompt_kernel_spin22
    s_nop 0
interleave_layers__ssm_conv_h3__swiglu_ffn__prompt_kernel_ok21:
    v_mfma_f32_16x16x32_bf16 v[112:115], v[160:163], v[96:99], v[112:115]
    s_add_u32 s10, s57, 0
    buffer_load_dwordx4 v[48:51], v10, s[36:39], s10 offen sc1
    s_waitcnt lgkmcnt(4)
    v_mfma_f32_16x16x32_bf16 v[116:119], v[160:163], v[100:103], v[116:119]
    s_add_u32 s10, s58, 0
    ds_read_b128 v[160:163], v11 offset:30720
    v_mfma_f32_16x16x32_bf16 v[120:123], v[164:167], v[96:99], v[120:123]
    buffer_load_dwordx4 v[52:55], v10, s[36:39], s10 offen sc1
    s_waitcnt lgkmcnt(4)
    v_mfma_f32_16x16x32_bf16 v[124:127], v[164:167], v[100:103], v[124:127]
    s_add_u32 s10, s57, 1024
    ds_read_b128 v[164:167], v11 offset:31744
    v_mfma_f32_16x16x32_bf16 v[128:131], v[168:171], v[96:99], v[128:131]
    buffer_load_dwordx4 v[56:59], v10, s[36:39], s10 offen sc1
    s_waitcnt lgkmcnt(4)
    v_mfma_f32_16x16x32_bf16 v[132:135], v[168:171], v[100:103], v[132:135]
    s_add_u32 s10, s58, 1024
    ds_read_b128 v[168:171], v11 offset:32768
    v_mfma_f32_16x16x32_bf16 v[136:139], v[172:175], v[96:99], v[136:139]
    buffer_load_dwordx4 v[60:63], v10, s[36:39], s10 offen sc1
    s_waitcnt lgkmcnt(4)
    v_mfma_f32_16x16x32_bf16 v[140:143], v[172:175], v[100:103], v[140:143]
    s_add_u32 s10, s57, 2048
    v_swap_b32 v106, v108
    v_swap_b32 v107, v109
    ds_read_b128 v[172:175], v11 offset:33792
    v_mfma_f32_16x16x32_bf16 v[144:147], v[176:179], v[96:99], v[144:147]
    buffer_load_dwordx4 v[64:67], v10, s[36:39], s10 offen sc1
    s_waitcnt lgkmcnt(4)
    v_mfma_f32_16x16x32_bf16 v[148:151], v[176:179], v[100:103], v[148:151]
    s_add_u32 s10, s58, 2048
    ds_read_b128 v[176:179], v11 offset:34816
    v_mfma_f32_16x16x32_bf16 v[152:155], v[180:183], v[96:99], v[152:155]
    buffer_load_dwordx4 v[68:71], v10, s[36:39], s10 offen sc1
    s_waitcnt lgkmcnt(4)
    v_mfma_f32_16x16x32_bf16 v[156:159], v[180:183], v[100:103], v[156:159]
    ds_read_b128 v[180:183], v11 offset:35840
    v_mfma_f32_16x16x32_bf16 v[112:115], v[160:163], v[104:107], v[112:115]
    s_add_u32 s10, s57, 3072
    buffer_load_dwordx4 v[72:75], v10, s[36:39], s10 offen sc1
    s_waitcnt lgkmcnt(4)
    v_mfma_f32_16x16x32_bf16 v[116:119], v[160:163], v[108:111], v[116:119]
    s_add_u32 s10, s58, 3072
    ds_read_b128 v[160:163], v11 offset:36864
    v_mfma_f32_16x16x32_bf16 v[120:123], v[164:167], v[104:107], v[120:123]
    buffer_load_dwordx4 v[76:79], v10, s[36:39], s10 offen sc1
    s_waitcnt lgkmcnt(4)
    v_mfma_f32_16x16x32_bf16 v[124:127], v[164:167], v[108:111], v[124:127]
    s_add_u32 s10, s57, 4096
    ds_read_b128 v[164:167], v11 offset:37888
    v_mfma_f32_16x16x32_bf16 v[128:131], v[168:171], v[104:107], v[128:131]
    buffer_load_dwordx4 v[80:83], v10, s[36:39], s10 offen sc1
    s_waitcnt lgkmcnt(4)
    v_mfma_f32_16x16x32_bf16 v[132:135], v[168:171], v[108:111], v[132:135]
    s_add_u32 s10, s58, 4096
    ds_read_b128 v[168:171], v11 offset:38912
    v_mfma_f32_16x16x32_bf16 v[136:139], v[172:175], v[104:107], v[136:139]
    buffer_load_dwordx4 v[84:87], v10, s[36:39], s10 offen sc1
    s_waitcnt lgkmcnt(4)
    v_mfma_f32_16x16x32_bf16 v[140:143], v[172:175], v[108:111], v[140:143]
    s_add_u32 s10, s57, 5120
    s_waitcnt vmcnt(24)
    v_swap_b32 v18, v20
    v_swap_b32 v19, v21
    ds_read_b128 v[172:175], v11 offset:39936
    v_mfma_f32_16x16x32_bf16 v[144:147], v[176:179], v[104:107], v[144:147]
    buffer_load_dwordx4 v[88:91], v10, s[36:39], s10 offen sc1
    s_waitcnt lgkmcnt(4)
    v_mfma_f32_16x16x32_bf16 v[148:151], v[176:179], v[108:111], v[148:151]
    s_add_u32 s10, s58, 5120
    ds_read_b128 v[176:179], v11 offset:40960
    v_mfma_f32_16x16x32_bf16 v[152:155], v[180:183], v[104:107], v[152:155]
    buffer_load_dwordx4 v[92:95], v10, s[36:39], s10 offen sc1
    s_waitcnt lgkmcnt(4)
    v_mfma_f32_16x16x32_bf16 v[156:159], v[180:183], v[108:111], v[156:159]
    ds_read_b128 v[180:183], v11 offset:41984
    v_mfma_f32_16x16x32_bf16 v[112:115], v[160:163], v[16:19], v[112:115]
    s_add_u32 s10, s57, 6144
    buffer_load_dwordx4 v[96:99], v10, s[36:39], s10 offen sc1
    s_waitcnt lgkmcnt(4)
    v_mfma_f32_16x16x32_bf16 v[116:119], v[160:163], v[20:23], v[116:119]
    ds_read_b128 v[160:163], v11 offset:43008
    v_mfma_f32_16x16x32_bf16 v[120:123], v[164:167], v[16:19], v[120:123]
    s_waitcnt lgkmcnt(4)
    v_mfma_f32_16x16x32_bf16 v[124:127], v[164:167], v[20:23], v[124:127]
    s_add_u32 s10, s58, 6144
    ds_read_b128 v[164:167], v11 offset:44032
    v_mfma_f32_16x16x32_bf16 v[128:131], v[168:171], v[16:19], v[128:131]
    buffer_load_dwordx4 v[100:103], v10, s[36:39], s10 offen sc1
    s_waitcnt lgkmcnt(4)
    v_mfma_f32_16x16x32_bf16 v[132:135], v[168:171], v[20:23], v[132:135]
    s_add_u32 s10, s57, 7168
    ds_read_b128 v[168:171], v11 offset:45056
    v_mfma_f32_16x16x32_bf16 v[136:139], v[172:175], v[16:19], v[136:139]
    buffer_load_dwordx4 v[104:107], v10, s[36:39], s10 offen sc1
    s_waitcnt lgkmcnt(4)
    v_mfma_f32_16x16x32_bf16 v[140:143], v[172:175], v[20:23], v[140:143]
    s_waitcnt vmcnt(27)
    v_swap_b32 v26, v28
    v_swap_b32 v27, v29
    ds_read_b128 v[172:175], v11 offset:46080
    v_mfma_f32_16x16x32_bf16 v[144:147], v[176:179], v[16:19], v[144:147]
    s_waitcnt lgkmcnt(4)
    v_mfma_f32_16x16x32_bf16 v[148:151], v[176:179], v[20:23], v[148:151]
    s_add_u32 s10, s58, 7168
    ds_read_b128 v[176:179], v11 offset:47104
    v_mfma_f32_16x16x32_bf16 v[152:155], v[180:183], v[16:19], v[152:155]
    buffer_load_dwordx4 v[108:111], v10, s[36:39], s10 offen sc1
    s_waitcnt lgkmcnt(4)
    v_mfma_f32_16x16x32_bf16 v[156:159], v[180:183], v[20:23], v[156:159]
    ds_read_b128 v[180:183], v11 offset:48128
    v_mfma_f32_16x16x32_bf16 v[112:115], v[160:163], v[24:27], v[112:115]
    s_waitcnt lgkmcnt(4)
    v_mfma_f32_16x16x32_bf16 v[116:119], v[160:163], v[28:31], v[116:119]
    s_add_u32 s10, s57, 8192
    ds_read_b128 v[160:163], v11 offset:49152
    v_mfma_f32_16x16x32_bf16 v[120:123], v[164:167], v[24:27], v[120:123]
    buffer_load_dwordx4 v[16:19], v10, s[36:39], s10 offen sc1
    s_waitcnt lgkmcnt(4)
    v_mfma_f32_16x16x32_bf16 v[124:127], v[164:167], v[28:31], v[124:127]
    ds_read_b128 v[164:167], v11 offset:50176
    v_mfma_f32_16x16x32_bf16 v[128:131], v[168:171], v[24:27], v[128:131]
    s_waitcnt lgkmcnt(4)
    v_mfma_f32_16x16x32_bf16 v[132:135], v[168:171], v[28:31], v[132:135]
    ds_read_b128 v[168:171], v11 offset:51200
    v_mfma_f32_16x16x32_bf16 v[136:139], v[172:175], v[24:27], v[136:139]
    s_waitcnt lgkmcnt(4)
    v_mfma_f32_16x16x32_bf16 v[140:143], v[172:175], v[28:31], v[140:143]
    s_add_u32 s10, s58, 8192
    s_waitcnt vmcnt(27)
    v_swap_b32 v34, v36
    v_swap_b32 v35, v37
    ds_read_b128 v[172:175], v11 offset:52224
    v_mfma_f32_16x16x32_bf16 v[144:147], v[176:179], v[24:27], v[144:147]
    buffer_load_dwordx4 v[20:23], v10, s[36:39], s10 offen sc1
    s_waitcnt lgkmcnt(4)
    v_mfma_f32_16x16x32_bf16 v[148:151], v[176:179], v[28:31], v[148:151]
    ds_read_b128 v[176:179], v11 offset:53248
    v_mfma_f32_16x16x32_bf16 v[152:155], v[180:183], v[24:27], v[152:155]
    s_waitcnt lgkmcnt(4)
    v_mfma_f32_16x16x32_bf16 v[156:159], v[180:183], v[28:31], v[156:159]
    ds_read_b128 v[180:183], v11 offset:54272
    v_mfma_f32_16x16x32_bf16 v[112:115], v[160:163], v[32:35], v[112:115]
    s_waitcnt lgkmcnt(4)
    v_mfma_f32_16x16x32_bf16 v[116:119], v[160:163], v[36:39], v[116:119]
    s_add_u32 s10, s57, 9216
    ds_read_b128 v[160:163], v11 offset:55296
    v_mfma_f32_16x16x32_bf16 v[120:123], v[164:167], v[32:35], v[120:123]
    buffer_load_dwordx4 v[24:27], v10, s[36:39], s10 offen sc1
    s_waitcnt lgkmcnt(4)
    v_mfma_f32_16x16x32_bf16 v[124:127], v[164:167], v[36:39], v[124:127]
    ds_read_b128 v[164:167], v11 offset:56320
    v_mfma_f32_16x16x32_bf16 v[128:131], v[168:171], v[32:35], v[128:131]
    s_waitcnt lgkmcnt(4)
    v_mfma_f32_16x16x32_bf16 v[132:135], v[168:171], v[36:39], v[132:135]
    ds_read_b128 v[168:171], v11 offset:57344
    v_mfma_f32_16x16x32_bf16 v[136:139], v[172:175], v[32:35], v[136:139]
    s_waitcnt lgkmcnt(4)
    v_mfma_f32_16x16x32_bf16 v[140:143], v[172:175], v[36:39], v[140:143]
    s_add_u32 s10, s58, 9216
    s_waitcnt vmcnt(27)
    v_swap_b32 v42, v44
    v_swap_b32 v43, v45
    ds_read_b128 v[172:175], v11 offset:58368
    v_mfma_f32_16x16x32_bf16 v[144:147], v[176:179], v[32:35], v[144:147]
    buffer_load_dwordx4 v[28:31], v10, s[36:39], s10 offen sc1
    s_waitcnt lgkmcnt(4)
    v_mfma_f32_16x16x32_bf16 v[148:151], v[176:179], v[36:39], v[148:151]
    ds_read_b128 v[176:179], v11 offset:59392
    v_mfma_f32_16x16x32_bf16 v[152:155], v[180:183], v[32:35], v[152:155]
    s_waitcnt lgkmcnt(4)
    v_mfma_f32_16x16x32_bf16 v[156:159], v[180:183], v[36:39], v[156:159]
    ds_read_b128 v[180:183], v11 offset:60416
    v_mfma_f32_16x16x32_bf16 v[112:115], v[160:163], v[40:43], v[112:115]
    s_waitcnt lgkmcnt(4)
    v_mfma_f32_16x16x32_bf16 v[116:119], v[160:163], v[44:47], v[116:119]
    s_add_u32 s10, s57, 10240
    v_lshlrev_b32 v255, 4, v3
    v_add_u32 v255, 122880, v255
    ds_read_b128 v[160:163], v255 offset:0
    v_mfma_f32_16x16x32_bf16 v[120:123], v[164:167], v[40:43], v[120:123]
    buffer_load_dwordx4 v[32:35], v10, s[36:39], s10 offen sc1
    s_waitcnt lgkmcnt(4)
    v_mfma_f32_16x16x32_bf16 v[124:127], v[164:167], v[44:47], v[124:127]
    ds_read_b128 v[164:167], v255 offset:64
    v_mfma_f32_16x16x32_bf16 v[128:131], v[168:171], v[40:43], v[128:131]
    s_waitcnt lgkmcnt(4)
    v_mfma_f32_16x16x32_bf16 v[132:135], v[168:171], v[44:47], v[132:135]
    ds_read_b128 v[168:171], v255 offset:128
    v_mfma_f32_16x16x32_bf16 v[136:139], v[172:175], v[40:43], v[136:139]
    s_waitcnt lgkmcnt(4)
    v_mfma_f32_16x16x32_bf16 v[140:143], v[172:175], v[44:47], v[140:143]
    s_add_u32 s10, s58, 10240
    ds_read_b128 v[172:175], v255 offset:192
    v_mfma_f32_16x16x32_bf16 v[144:147], v[176:179], v[40:43], v[144:147]
    buffer_load_dwordx4 v[36:39], v10, s[36:39], s10 offen sc1
    s_waitcnt lgkmcnt(4)
    v_mfma_f32_16x16x32_bf16 v[148:151], v[176:179], v[44:47], v[148:151]
    ds_read_b128 v[176:179], v255 offset:256
    v_mfma_f32_16x16x32_bf16 v[152:155], v[180:183], v[40:43], v[152:155]
    v_mfma_f32_16x16x32_bf16 v[156:159], v[180:183], v[44:47], v[156:159]
    ds_read_b128 v[180:183], v255 offset:320
    s_add_u32 s10, s57, 11264
    buffer_load_dwordx4 v[40:43], v10, s[36:39], s10 offen sc1
    s_add_u32 s10, s58, 11264
    buffer_load_dwordx4 v[44:47], v10, s[36:39], s10 offen sc1
    s_waitcnt vmcnt(30)
    v_min_u32 v204, v209, v211
    v_cmp_ne_u32 vcc, 0, v204
    s_nop 0
    s_cmp_eq_u64 vcc, -1
    s_cbranch_scc1 interleave_layers__ssm_conv_h3__swiglu_ffn__prompt_kernel_ok23
    s_mov_b32 s23, 0
interleave_layers__ssm_conv_h3__swiglu_ffn__prompt_kernel_spin24:
    s_sleep 1
    s_lshl_b32 s13, s15, 9
    s_add_u32 s13, s13, 4096
    buffer_load_dwordx2 v[208:209], v0, s[44:47], s13 offen offset:0 sc1
    buffer_load_dwordx2 v[210:211], v0, s[44:47], s13 offen offset:512 sc1
    s_waitcnt vmcnt(0)
    s_add_u32 s23, s23, 1
    s_cmp_ge_u32 s23, 262144
    s_cbranch_scc1 interleave_layers__ssm_conv_h3__swiglu_ffn__prompt_kernel_ok23
    v_min_u32 v204, v209, v211
    v_cmp_ne_u32 vcc, 0, v204
    s_nop 0
    s_cmp_eq_u64 vcc, -1
    s_cbranch_scc0 interleave_layers__ssm_conv_h3__swiglu_ffn__prompt_kernel_spin24
    s_nop 1
interleave_layers__ssm_conv_h3__swiglu_ffn__prompt_kernel_ok23:
    v_mov_b32 v204, v208
    s_nop 1
    v_permlane16_swap_b32 v208, v204
    v_add_f32 v208, v208, v204
    v_mov_b32 v204, v208
    s_nop 1
    v_permlane32_swap_b32 v208, v204
    v_add_f32 v208, v208, v204
    v_mov_b32 v204, v209
    s_nop 1
    v_permlane16_swap_b32 v209, v204
    v_add_f32 v209, v209, v204
    v_mov_b32 v204, v209
    s_nop 1
    v_permlane32_swap_b32 v209, v204
    v_add_f32 v209, v209, v204
    v_mul_f32 v240, 0xbacccccd, v208
    v_mul_f32 v209, 0xbacccccd, v209
    v_fma_f32 v209, -v240, v240, v209
    v_max_f32 v209, 0, v209
    v_add_f32 v209, 0x3727c5ac, v209
    v_rsq_f32 v241, v209
    v_mov_b32 v204, v210
    s_nop 1
    v_permlane16_swap_b32 v210, v204
    v_add_f32 v210, v210, v204
    v_mov_b32 v204, v210
    s_nop 1
    v_permlane32_swap_b32 v210, v204
    v_add_f32 v210, v210, v204
    v_mov_b32 v204, v211
    s_nop 1
    v_permlane16_swap_b32 v211, v204
    v_add_f32 v211, v211, v204
    v_mov_b32 v204, v211
    s_nop 1
    v_permlane32_swap_b32 v211, v204
    v_add_f32 v211, v211, v204
    v_mul_f32 v242, 0xbacccccd, v210
    v_mul_f32 v211, 0xbacccccd, v211
    v_fma_f32 v211, -v242, v242, v211
    v_max_f32 v211, 0, v211
    v_add_f32 v211, 0x3727c5ac, v211
    v_rsq_f32 v243, v211
    s_add_u32 s12, s56, 393216
    v_mul_f32 v212, 0xbfb8aa3b, v241
    v_mul_f32 v213, v241, v241
    v_rcp_f32 v213, v213
    s_waitcnt lgkmcnt(5)
    v_pk_fma_f32 v[112:113], v[160:161], v[240:241], v[112:113] op_sel:[0,0,0] op_sel_hi:[1,0,1]
    v_pk_fma_f32 v[114:115], v[162:163], v[240:241], v[114:115] op_sel:[0,0,0] op_sel_hi:[1,0,1]
    s_waitcnt lgkmcnt(4)
    v_pk_fma_f32 v[120:121], v[164:165], v[240:241], v[120:121] op_sel:[0,0,0] op_sel_hi:[1,0,1]
    v_pk_fma_f32 v[122:123], v[166:167], v[240:241], v[122:123] op_sel:[0,0,0] op_sel_hi:[1,0,1]
    s_waitcnt lgkmcnt(3)
    v_pk_fma_f32 v[128:129], v[168:169], v[240:241], v[128:129] op_sel:[0,0,0] op_sel_hi:[1,0,1]
    v_pk_fma_f32 v[130:131], v[170:171], v[240:241], v[130:131] op_sel:[0,0,0] op_sel_hi:[1,0,1]
    s_waitcnt lgkmcnt(2)
    v_pk_fma_f32 v[136:137], v[172:173], v[240:241], v[136:137] op_sel:[0,0,0] op_sel_hi:[1,0,1]
    v_pk_fma_f32 v[138:139], v[174:175], v[240:241], v[138:139] op_sel:[0,0,0] op_sel_hi:[1,0,1]
    s_waitcnt lgkmcnt(1)
    v_pk_fma_f32 v[144:145], v[176:177], v[240:241], v[144:145] op_sel:[0,0,0] op_sel_hi:[1,0,1]
    v_pk_fma_f32 v[146:147], v[178:179], v[240:241], v[146:147] op_sel:[0,0,0] op_sel_hi:[1,0,1]
    s_waitcnt lgkmcnt(0)
    v_pk_fma_f32 v[152:153], v[180:181], v[240:241], v[152:153] op_sel:[0,0,0] op_sel_hi:[1,0,1]
    v_pk_fma_f32 v[154:155], v[182:183], v[240:241], v[154:155] op_sel:[0,0,0] op_sel_hi:[1,0,1]
    v_pk_mul_f32 v[184:185], v[112:113], v[212:213] op_sel:[0,0] op_sel_hi:[1,0]
    v_pk_mul_f32 v[186:187], v[114:115], v[212:213] op_sel:[0,0] op_sel_hi:[1,0]
    v_pk_mul_f32 v[188:189], v[120:121], v[212:213] op_sel:[0,0] op_sel_hi:[1,0]
    v_pk_mul_f32 v[190:191], v[122:123], v[212:213] op_sel:[0,0] op_sel_hi:[1,0]
    v_pk_mul_f32 v[192:193], v[128:129], v[212:213] op_sel:[0,0] op_sel_hi:[1,0]
    v_pk_mul_f32 v[194:195], v[130:131], v[212:213] op_sel:[0,0] op_sel_hi:[1,0]
    v_exp_f32 v184, v184
    v_exp_f32 v185, v185
    v_exp_f32 v186, v186
    v_exp_f32 v187, v187
    v_exp_f32 v188, v188
    v_exp_f32 v189, v189
    v_exp_f32 v190, v190
    v_exp_f32 v191, v191
    v_exp_f32 v192, v192
    v_exp_f32 v193, v193
    v_exp_f32 v194, v194
    v_exp_f32 v195, v195
    v_pk_mul_f32 v[112:113], v[112:113], v[136:137]
    v_pk_mul_f32 v[114:115], v[114:115], v[138:139]
    v_pk_mul_f32 v[120:121], v[120:121], v[144:145]
    v_pk_mul_f32 v[122:123], v[122:123], v[146:147]
    v_pk_mul_f32 v[128:129], v[128:129], v[152:153]
    v_pk_mul_f32 v[130:131], v[130:131], v[154:155]
    v_pk_fma_f32 v[184:185], v[184:185], v[212:213], v[212:213] op_sel:[0,1,1] op_sel_hi:[1,1,1]
    v_pk_fma_f32 v[186:187], v[186:187], v[212:213], v[212:213] op_sel:[0,1,1] op_sel_hi:[1,1,1]
    v_pk_fma_f32 v[188:189], v[188:189], v[212:213], v[212:213] op_sel:[0,1,1] op_sel_hi:[1,1,1]
    v_pk_fma_f32 v[190:191], v[190:191], v[212:213], v[212:213] op_sel:[0,1,1] op_sel_hi:[1,1,1]
    v_pk_fma_f32 v[192:193], v[192:193], v[212:213], v[212:213] op_sel:[0,1,1] op_sel_hi:[1,1,1]
    v_pk_fma_f32 v[194:195], v[194:195], v[212:213], v[212:213] op_sel:[0,1,1] op_sel_hi:[1,1,1]
    v_rcp_f32 v184, v184
    v_rcp_f32 v185, v185
    v_rcp_f32 v186, v186
    v_rcp_f32 v187, v187
    v_rcp_f32 v188, v188
    v_rcp_f32 v189, v189
    v_rcp_f32 v190, v190
    v_rcp_f32 v191, v191
    v_rcp_f32 v192, v192
    v_rcp_f32 v193, v193
    v_rcp_f32 v194, v194
    v_rcp_f32 v195, v195
    v_pk_mul_f32 v[184:185], v[184:185], v[112:113]
    v_pk_mul_f32 v[186:187], v[186:187], v[114:115]
    v_pk_mul_f32 v[188:189], v[188:189], v[120:121]
    v_pk_mul_f32 v[190:191], v[190:191], v[122:123]
    v_pk_mul_f32 v[192:193], v[192:193], v[128:129]
    v_pk_mul_f32 v[194:195], v[194:195], v[130:131]
    v_cvt_pk_bf16_f32 v196, v184, v185
    v_cvt_pk_bf16_f32 v197, v186, v187
    v_cvt_pk_bf16_f32 v198, v188, v189
    v_cvt_pk_bf16_f32 v199, v190, v191
    v_cvt_pk_bf16_f32 v204, v192, v193
    v_cvt_pk_bf16_f32 v205, v194, v195
    buffer_store_dwordx4 v[196:199], v10, s[36:39], s12 offen sc1
    v_mul_f32 v212, 0xbfb8aa3b, v243
    v_mul_f32 v213, v243, v243
    v_rcp_f32 v213, v213
    v_pk_fma_f32 v[116:117], v[160:161], v[242:243], v[116:117] op_sel:[0,0,0] op_sel_hi:[1,0,1]
    v_pk_fma_f32 v[118:119], v[162:163], v[242:243], v[118:119] op_sel:[0,0,0] op_sel_hi:[1,0,1]
    v_pk_fma_f32 v[124:125], v[164:165], v[242:243], v[124:125] op_sel:[0,0,0] op_sel_hi:[1,0,1]
    v_pk_fma_f32 v[126:127], v[166:167], v[242:243], v[126:127] op_sel:[0,0,0] op_sel_hi:[1,0,1]
    v_pk_fma_f32 v[132:133], v[168:169], v[242:243], v[132:133] op_sel:[0,0,0] op_sel_hi:[1,0,1]
    v_pk_fma_f32 v[134:135], v[170:171], v[242:243], v[134:135] op_sel:[0,0,0] op_sel_hi:[1,0,1]
    v_pk_fma_f32 v[140:141], v[172:173], v[242:243], v[140:141] op_sel:[0,0,0] op_sel_hi:[1,0,1]
    v_pk_fma_f32 v[142:143], v[174:175], v[242:243], v[142:143] op_sel:[0,0,0] op_sel_hi:[1,0,1]
    v_pk_fma_f32 v[148:149], v[176:177], v[242:243], v[148:149] op_sel:[0,0,0] op_sel_hi:[1,0,1]
    v_pk_fma_f32 v[150:151], v[178:179], v[242:243], v[150:151] op_sel:[0,0,0] op_sel_hi:[1,0,1]
    v_pk_fma_f32 v[156:157], v[180:181], v[242:243], v[156:157] op_sel:[0,0,0] op_sel_hi:[1,0,1]
    v_pk_fma_f32 v[158:159], v[182:183], v[242:243], v[158:159] op_sel:[0,0,0] op_sel_hi:[1,0,1]
    v_pk_mul_f32 v[184:185], v[116:117], v[212:213] op_sel:[0,0] op_sel_hi:[1,0]
    v_pk_mul_f32 v[186:187], v[118:119], v[212:213] op_sel:[0,0] op_sel_hi:[1,0]
    v_pk_mul_f32 v[188:189], v[124:125], v[212:213] op_sel:[0,0] op_sel_hi:[1,0]
    v_pk_mul_f32 v[190:191], v[126:127], v[212:213] op_sel:[0,0] op_sel_hi:[1,0]
    v_pk_mul_f32 v[192:193], v[132:133], v[212:213] op_sel:[0,0] op_sel_hi:[1,0]
    v_pk_mul_f32 v[194:195], v[134:135], v[212:213] op_sel:[0,0] op_sel_hi:[1,0]
    v_exp_f32 v184, v184
    v_exp_f32 v185, v185
    v_exp_f32 v186, v186
    v_exp_f32 v187, v187
    v_exp_f32 v188, v188
    v_exp_f32 v189, v189
    v_exp_f32 v190, v190
    v_exp_f32 v191, v191
    v_exp_f32 v192, v192
    v_exp_f32 v193, v193
    v_exp_f32 v194, v194
    v_exp_f32 v195, v195
    v_pk_mul_f32 v[116:117], v[116:117], v[140:141]
    v_pk_mul_f32 v[118:119], v[118:119], v[142:143]
    v_pk_mul_f32 v[124:125], v[124:125], v[148:149]
    v_pk_mul_f32 v[126:127], v[126:127], v[150:151]
    v_pk_mul_f32 v[132:133], v[132:133], v[156:157]
    v_pk_mul_f32 v[134:135], v[134:135], v[158:159]
    v_pk_fma_f32 v[184:185], v[184:185], v[212:213], v[212:213] op_sel:[0,1,1] op_sel_hi:[1,1,1]
    v_pk_fma_f32 v[186:187], v[186:187], v[212:213], v[212:213] op_sel:[0,1,1] op_sel_hi:[1,1,1]
    v_pk_fma_f32 v[188:189], v[188:189], v[212:213], v[212:213] op_sel:[0,1,1] op_sel_hi:[1,1,1]
    v_pk_fma_f32 v[190:191], v[190:191], v[212:213], v[212:213] op_sel:[0,1,1] op_sel_hi:[1,1,1]
    v_pk_fma_f32 v[192:193], v[192:193], v[212:213], v[212:213] op_sel:[0,1,1] op_sel_hi:[1,1,1]
    v_pk_fma_f32 v[194:195], v[194:195], v[212:213], v[212:213] op_sel:[0,1,1] op_sel_hi:[1,1,1]
    v_rcp_f32 v184, v184
    v_rcp_f32 v185, v185
    v_rcp_f32 v186, v186
    v_rcp_f32 v187, v187
    v_rcp_f32 v188, v188
    v_rcp_f32 v189, v189
    v_rcp_f32 v190, v190
    v_rcp_f32 v191, v191
    v_rcp_f32 v192, v192
    v_rcp_f32 v193, v193
    v_rcp_f32 v194, v194
    v_rcp_f32 v195, v195
    v_pk_mul_f32 v[184:185], v[184:185], v[116:117]
    v_pk_mul_f32 v[186:187], v[186:187], v[118:119]
    v_pk_mul_f32 v[188:189], v[188:189], v[124:125]
    v_pk_mul_f32 v[190:191], v[190:191], v[126:127]
    v_pk_mul_f32 v[192:193], v[192:193], v[132:133]
    v_pk_mul_f32 v[194:195], v[194:195], v[134:135]
    v_cvt_pk_bf16_f32 v200, v184, v185
    v_cvt_pk_bf16_f32 v201, v186, v187
    v_cvt_pk_bf16_f32 v202, v188, v189
    v_cvt_pk_bf16_f32 v203, v190, v191
    v_cvt_pk_bf16_f32 v206, v192, v193
    v_cvt_pk_bf16_f32 v207, v194, v195
    s_add_u32 s13, s12, 49152
    buffer_store_dwordx4 v[200:203], v10, s[36:39], s13 offen sc1
    v_permlane16_swap_b32 v204, v206
    v_permlane16_swap_b32 v205, v207
    buffer_store_dwordx4 v[204:207], v8, s[36:39], s12 offen offset:1024 sc1
    s_waitcnt vmcnt(26)
    v_mfma_f32_16x16x32_bf16 v[160:163], a[0:3], v[48:51], 0
    v_mfma_f32_16x16x32_bf16 v[164:167], a[4:7], v[48:51], 0
    v_mfma_f32_16x16x32_bf16 v[128:131], a[8:11], v[48:51], 0
    v_mfma_f32_16x16x32_bf16 v[136:139], a[12:15], v[48:51], 0
    v_mfma_f32_16x16x32_bf16 v[168:171], a[16:19], v[48:51], 0
    s_waitcnt vmcnt(25)
    v_mfma_f32_16x16x32_bf16 v[116:119], a[0:3], v[52:55], 0
    v_mfma_f32_16x16x32_bf16 v[124:127], a[4:7], v[52:55], 0
    v_mfma_f32_16x16x32_bf16 v[132:135], a[8:11], v[52:55], 0
    v_mfma_f32_16x16x32_bf16 v[140:143], a[12:15], v[52:55], 0
    v_mfma_f32_16x16x32_bf16 v[148:151], a[16:19], v[52:55], 0
    s_waitcnt vmcnt(24)
    v_mfma_f32_16x16x32_bf16 v[160:163], a[20:23], v[56:59], v[160:163]
    v_mfma_f32_16x16x32_bf16 v[164:167], a[24:27], v[56:59], v[164:167]
    v_mfma_f32_16x16x32_bf16 v[128:131], a[28:31], v[56:59], v[128:131]
    v_mfma_f32_16x16x32_bf16 v[136:139], a[32:35], v[56:59], v[136:139]
    v_mfma_f32_16x16x32_bf16 v[168:171], a[36:39], v[56:59], v[168:171]
    s_waitcnt vmcnt(23)
    v_mfma_f32_16x16x32_bf16 v[116:119], a[20:23], v[60:63], v[116:119]
    v_mfma_f32_16x16x32_bf16 v[124:127], a[24:27], v[60:63], v[124:127]
    v_mfma_f32_16x16x32_bf16 v[132:135], a[28:31], v[60:63], v[132:135]
    v_mfma_f32_16x16x32_bf16 v[140:143], a[32:35], v[60:63], v[140:143]
    v_mfma_f32_16x16x32_bf16 v[148:151], a[36:39], v[60:63], v[148:151]
    s_waitcnt vmcnt(22)
    v_mfma_f32_16x16x32_bf16 v[160:163], a[40:43], v[64:67], v[160:163]
    v_mfma_f32_16x16x32_bf16 v[164:167], a[44:47], v[64:67], v[164:167]
    v_mfma_f32_16x16x32_bf16 v[128:131], a[48:51], v[64:67], v[128:131]
    v_mfma_f32_16x16x32_bf16 v[136:139], a[52:55], v[64:67], v[136:139]
    v_mfma_f32_16x16x32_bf16 v[168:171], a[56:59], v[64:67], v[168:171]
    s_waitcnt vmcnt(21)
    v_mfma_f32_16x16x32_bf16 v[116:119], a[40:43], v[68:71], v[116:119]
    v_mfma_f32_16x16x32_bf16 v[124:127], a[44:47], v[68:71], v[124:127]
    v_mfma_f32_16x16x32_bf16 v[132:135], a[48:51], v[68:71], v[132:135]
    v_mfma_f32_16x16x32_bf16 v[140:143], a[52:55], v[68:71], v[140:143]
    v_mfma_f32_16x16x32_bf16 v[148:151], a[56:59], v[68:71], v[148:151]
    s_waitcnt vmcnt(20)
    v_mfma_f32_16x16x32_bf16 v[160:163], a[60:63], v[72:75], v[160:163]
    v_mfma_f32_16x16x32_bf16 v[164:167], a[64:67], v[72:75], v[164:167]
    v_mfma_f32_16x16x32_bf16 v[128:131], a[68:71], v[72:75], v[128:131]
    v_mfma_f32_16x16x32_bf16 v[136:139], a[72:75], v[72:75], v[136:139]
    v_mfma_f32_16x16x32_bf16 v[168:171], a[76:79], v[72:75], v[168:171]
    s_waitcnt vmcnt(19)
    v_mfma_f32_16x16x32_bf16 v[116:119], a[60:63], v[76:79], v[116:119]
    v_mfma_f32_16x16x32_bf16 v[124:127], a[64:67], v[76:79], v[124:127]
    v_mfma_f32_16x16x32_bf16 v[132:135], a[68:71], v[76:79], v[132:135]
    v_mfma_f32_16x16x32_bf16 v[140:143], a[72:75], v[76:79], v[140:143]
    v_mfma_f32_16x16x32_bf16 v[148:151], a[76:79], v[76:79], v[148:151]
    s_waitcnt vmcnt(18)
    v_mfma_f32_16x16x32_bf16 v[160:163], a[80:83], v[80:83], v[160:163]
    v_mfma_f32_16x16x32_bf16 v[164:167], a[84:87], v[80:83], v[164:167]
    v_mfma_f32_16x16x32_bf16 v[128:131], a[88:91], v[80:83], v[128:131]
    v_mfma_f32_16x16x32_bf16 v[136:139], a[92:95], v[80:83], v[136:139]
    v_mfma_f32_16x16x32_bf16 v[168:171], a[96:99], v[80:83], v[168:171]
    s_waitcnt vmcnt(17)
    v_mfma_f32_16x16x32_bf16 v[116:119], a[80:83], v[84:87], v[116:119]
    v_mfma_f32_16x16x32_bf16 v[124:127], a[84:87], v[84:87], v[124:127]
    v_mfma_f32_16x16x32_bf16 v[132:135], a[88:91], v[84:87], v[132:135]
    v_mfma_f32_16x16x32_bf16 v[140:143], a[92:95], v[84:87], v[140:143]
    v_mfma_f32_16x16x32_bf16 v[148:151], a[96:99], v[84:87], v[148:151]
    s_lshl_b32 s12, s4, 3
    s_add_u32 s12, s12, s3
    s_lshl_b32 s12, s12, 5
    s_add_u32 s12, s12, s5
    s_lshl_b32 s12, s12, 7
    s_add_u32 s12, s12, 606208
    v_mov_b32 v254, s100
    v_mov_b32 v255, s101
    s_waitcnt vmcnt(0)
    buffer_store_dwordx2 v[254:255], v252, s[44:47], s12 offen sc1
    s_barrier
    v_mfma_f32_16x16x32_bf16 v[160:163], a[100:103], v[88:91], v[160:163]
    v_mfma_f32_16x16x32_bf16 v[164:167], a[104:107], v[88:91], v[164:167]
    v_mfma_f32_16x16x32_bf16 v[128:131], a[108:111], v[88:91], v[128:131]
    v_mfma_f32_16x16x32_bf16 v[136:139], a[112:115], v[88:91], v[136:139]
    v_mfma_f32_16x16x32_bf16 v[168:171], a[116:119], v[88:91], v[168:171]
    v_mfma_f32_16x16x32_bf16 v[116:119], a[100:103], v[92:95], v[116:119]
    v_mfma_f32_16x16x32_bf16 v[124:127], a[104:107], v[92:95], v[124:127]
    v_mfma_f32_16x16x32_bf16 v[132:135], a[108:111], v[92:95], v[132:135]
    v_mfma_f32_16x16x32_bf16 v[140:143], a[112:115], v[92:95], v[140:143]
    v_mfma_f32_16x16x32_bf16 v[148:151], a[116:119], v[92:95], v[148:151]
    v_mfma_f32_16x16x32_bf16 v[160:163], a[120:123], v[96:99], v[160:163]
    v_mfma_f32_16x16x32_bf16 v[164:167], a[124:127], v[96:99], v[164:167]
    v_mfma_f32_16x16x32_bf16 v[128:131], a[128:131], v[96:99], v[128:131]
    v_mfma_f32_16x16x32_bf16 v[136:139], a[132:135], v[96:99], v[136:139]
    v_mfma_f32_16x16x32_bf16 v[168:171], a[136:139], v[96:99], v[168:171]
    v_mfma_f32_16x16x32_bf16 v[116:119], a[120:123], v[100:103], v[116:119]
    v_mfma_f32_16x16x32_bf16 v[124:127], a[124:127], v[100:103], v[124:127]
    v_mfma_f32_16x16x32_bf16 v[132:135], a[128:131], v[100:103], v[132:135]
    v_mfma_f32_16x16x32_bf16 v[140:143], a[132:135], v[100:103], v[140:143]
    v_mfma_f32_16x16x32_bf16 v[148:151], a[136:139], v[100:103], v[148:151]
    v_mfma_f32_16x16x32_bf16 v[160:163], a[140:143], v[104:107], v[160:163]
    v_mfma_f32_16x16x32_bf16 v[164:167], a[144:147], v[104:107], v[164:167]
    v_mfma_f32_16x16x32_bf16 v[128:131], a[148:151], v[104:107], v[128:131]
    v_mfma_f32_16x16x32_bf16 v[136:139], a[152:155], v[104:107], v[136:139]
    v_mfma_f32_16x16x32_bf16 v[168:171], a[156:159], v[104:107], v[168:171]
    v_mfma_f32_16x16x32_bf16 v[116:119], a[140:143], v[108:111], v[116:119]
    v_mfma_f32_16x16x32_bf16 v[124:127], a[144:147], v[108:111], v[124:127]
    v_mfma_f32_16x16x32_bf16 v[132:135], a[148:151], v[108:111], v[132:135]
    v_mfma_f32_16x16x32_bf16 v[140:143], a[152:155], v[108:111], v[140:143]
    v_mfma_f32_16x16x32_bf16 v[148:151], a[156:159], v[108:111], v[148:151]
    v_mfma_f32_16x16x32_bf16 v[160:163], a[160:163], v[16:19], v[160:163]
    v_mfma_f32_16x16x32_bf16 v[164:167], a[164:167], v[16:19], v[164:167]
    v_mfma_f32_16x16x32_bf16 v[128:131], a[168:171], v[16:19], v[128:131]
    v_mfma_f32_16x16x32_bf16 v[136:139], a[172:175], v[16:19], v[136:139]
    v_mfma_f32_16x16x32_bf16 v[168:171], a[176:179], v[16:19], v[168:171]
    v_mfma_f32_16x16x32_bf16 v[116:119], a[160:163], v[20:23], v[116:119]
    v_mfma_f32_16x16x32_bf16 v[124:127], a[164:167], v[20:23], v[124:127]
    v_mfma_f32_16x16x32_bf16 v[132:135], a[168:171], v[20:23], v[132:135]
    v_mfma_f32_16x16x32_bf16 v[140:143], a[172:175], v[20:23], v[140:143]
    v_mfma_f32_16x16x32_bf16 v[148:151], a[176:179], v[20:23], v[148:151]
    v_mfma_f32_16x16x32_bf16 v[116:119], a[180:183], v[28:31], v[116:119]
    v_mfma_f32_16x16x32_bf16 v[116:119], a[200:203], v[36:39], v[116:119]
    v_mfma_f32_16x16x32_bf16 v[116:119], a[220:223], v[44:47], v[116:119]
    s_mov_b32 s13, 606208
    s_mov_b32 exec_lo, 0xff
    s_mov_b32 exec_hi, 0
    buffer_load_dwordx2 v[214:215], v253, s[44:47], s13 offen sc1
    s_mov_b64 exec, -1
    v_mfma_f32_16x16x32_bf16 v[124:127], a[184:187], v[28:31], v[124:127]
    v_mfma_f32_16x16x32_bf16 v[124:127], a[204:207], v[36:39], v[124:127]
    v_mfma_f32_16x16x32_bf16 v[124:127], a[224:227], v[44:47], v[124:127]
    v_mfma_f32_16x16x32_bf16 v[128:131], a[188:191], v[24:27], v[128:131]
    v_mfma_f32_16x16x32_bf16 v[128:131], a[208:211], v[32:35], v[128:131]
    v_mfma_f32_16x16x32_bf16 v[128:131], a[228:231], v[40:43], v[128:131]
    ds_write_b128 v249, v[116:119] offset:0
    v_mfma_f32_16x16x32_bf16 v[136:139], a[192:195], v[24:27], v[136:139]
    v_mfma_f32_16x16x32_bf16 v[136:139], a[212:215], v[32:35], v[136:139]
    v_mfma_f32_16x16x32_bf16 v[136:139], a[232:235], v[40:43], v[136:139]
    s_nop 0
    ds_write_b128 v249, v[124:127] offset:1024
    v_mfma_f32_16x16x32_bf16 v[132:135], a[188:191], v[28:31], v[132:135]
    v_mfma_f32_16x16x32_bf16 v[132:135], a[208:211], v[36:39], v[132:135]
    v_mfma_f32_16x16x32_bf16 v[132:135], a[228:231], v[44:47], v[132:135]
    ds_write_b128 v249, v[128:131] offset:2048
    v_mfma_f32_16x16x32_bf16 v[140:143], a[192:195], v[28:31], v[140:143]
    v_lshlrev_b32 v184, 16, v216
    v_mfma_f32_16x16x32_bf16 v[140:143], a[212:215], v[36:39], v[140:143]
    v_and_b32 v185, 0xffff0000, v216
    v_mfma_f32_16x16x32_bf16 v[140:143], a[232:235], v[44:47], v[140:143]
    v_lshlrev_b32 v186, 16, v217
    ds_write_b128 v249, v[136:139] offset:3072
    v_mfma_f32_16x16x32_bf16 v[148:151], a[196:199], v[28:31], v[148:151]
    v_and_b32 v187, 0xffff0000, v217
    v_mfma_f32_16x16x32_bf16 v[148:151], a[216:219], v[36:39], v[148:151]
    v_lshlrev_b32 v188, 16, v218
    v_mfma_f32_16x16x32_bf16 v[148:151], a[236:239], v[44:47], v[148:151]
    v_and_b32 v189, 0xffff0000, v218
    ds_write_b128 v249, v[132:135] offset:4096
    v_mfma_f32_16x16x32_bf16 v[168:171], a[196:199], v[24:27], v[168:171]
    v_lshlrev_b32 v190, 16, v219
    v_mfma_f32_16x16x32_bf16 v[168:171], a[216:219], v[32:35], v[168:171]
    v_and_b32 v191, 0xffff0000, v219
    v_mfma_f32_16x16x32_bf16 v[168:171], a[236:239], v[40:43], v[168:171]
    v_lshlrev_b32 v192, 16, v220
    ds_write_b128 v249, v[140:143] offset:5120
    v_mfma_f32_16x16x32_bf16 v[160:163], a[180:183], v[24:27], v[160:163]
    v_and_b32 v193, 0xffff0000, v220
    v_mfma_f32_16x16x32_bf16 v[160:163], a[200:203], v[32:35], v[160:163]
    v_lshlrev_b32 v194, 16, v221
    v_mfma_f32_16x16x32_bf16 v[160:163], a[220:223], v[40:43], v[160:163]
    v_and_b32 v195, 0xffff0000, v221
    ds_write_b128 v249, v[148:151] offset:7168
    v_mfma_f32_16x16x32_bf16 v[164:167], a[184:187], v[24:27], v[164:167]
    v_xor_b32 v197, 8192, v249
    v_mfma_f32_16x16x32_bf16 v[164:167], a[204:207], v[32:35], v[164:167]
    v_xor_b32 v198, 16384, v249
    v_mfma_f32_16x16x32_bf16 v[164:167], a[224:227], v[40:43], v[164:167]
    v_xor_b32 v199, 24576, v249
    ds_write_b128 v249, v[168:171] offset:6144
    s_waitcnt vmcnt(0)
    v_mov_b32 v214, v214
    s_mov_b32 exec_lo, 0xff
    s_mov_b32 exec_hi, 0
    v_cmp_eq_u64 vcc, s[100:101], v[214:215]
    s_nop 0
    s_cmp_eq_u64 vcc, exec
    s_mov_b64 exec, -1
    s_cbranch_scc1 interleave_layers__ssm_conv_h3__swiglu_ffn__prompt_kernel_ok25
    s_mov_b32 s23, 0
interleave_layers__ssm_conv_h3__swiglu_ffn__prompt_kernel_spin26:
    s_sleep 1
    s_mov_b32 s13, 606208
    s_mov_b32 exec_lo, 0xff
    s_mov_b32 exec_hi, 0
    buffer_load_dwordx2 v[214:215], v253, s[44:47], s13 offen sc1
    s_mov_b64 exec, -1
    s_waitcnt vmcnt(0)
    s_add_u32 s23, s23, 1
    s_cmp_ge_u32 s23, 262144
    s_cbranch_scc1 interleave_layers__ssm_conv_h3__swiglu_ffn__prompt_kernel_ok25
    v_mov_b32 v214, v214
    s_mov_b32 exec_lo, 0xff
    s_mov_b32 exec_hi, 0
    v_cmp_eq_u64 vcc, s[100:101], v[214:215]
    s_nop 0
    s_cmp_eq_u64 vcc, exec
    s_mov_b64 exec, -1
    s_cbranch_scc0 interleave_layers__ssm_conv_h3__swiglu_ffn__prompt_kernel_spin26
    s_nop 0
interleave_layers__ssm_conv_h3__swiglu_ffn__prompt_kernel_ok25:
    s_add_u32 s10, s57, 393216
    buffer_load_dwordx4 v[16:19], v10, s[36:39], s10 offen sc1
    s_add_u32 s10, s58, 393216
    buffer_load_dwordx4 v[20:23], v10, s[36:39], s10 offen sc1
    s_add_u32 s10, s57, 394240
    buffer_load_dwordx4 v[24:27], v10, s[36:39], s10 offen sc1
    s_add_u32 s10, s58, 394240
    buffer_load_dwordx4 v[28:31], v10, s[36:39], s10 offen sc1
    s_add_u32 s10, s57, 395264
    buffer_load_dwordx4 v[32:35], v10, s[36:39], s10 offen sc1
    s_add_u32 s10, s58, 395264
    buffer_load_dwordx4 v[36:39], v10, s[36:39], s10 offen sc1
    s_add_u32 s10, s57, 396288
    buffer_load_dwordx4 v[40:43], v10, s[36:39], s10 offen sc1
    s_add_u32 s10, s58, 396288
    buffer_load_dwordx4 v[44:47], v10, s[36:39], s10 offen sc1
    s_add_u32 s10, s57, 397312
    buffer_load_dwordx4 v[48:51], v10, s[36:39], s10 offen sc1
    s_add_u32 s10, s58, 397312
    buffer_load_dwordx4 v[52:55], v10, s[36:39], s10 offen sc1
    s_waitcnt lgkmcnt(0)
    s_barrier
    ds_read_b128 v[112:115], v197 offset:0
    ds_read_b128 v[116:119], v197 offset:1024
    ds_read_b128 v[120:123], v197 offset:7168
    ds_read_b128 v[124:127], v198 offset:2048
    ds_read_b128 v[128:131], v198 offset:3072
    ds_read_b128 v[132:135], v198 offset:6144
    ds_read_b128 v[136:139], v199 offset:4096
    ds_read_b128 v[140:143], v199 offset:5120
    ds_read_b128 v[144:147], v199 offset:7168
    v_pk_add_f32 v[160:161], v[160:161], v[184:185]
    v_pk_add_f32 v[162:163], v[162:163], v[186:187]
    v_pk_add_f32 v[164:165], v[164:165], v[188:189]
    v_pk_add_f32 v[166:167], v[166:167], v[190:191]
    v_pk_add_f32 v[168:169], v[168:169], v[192:193]
    v_pk_add_f32 v[170:171], v[170:171], v[194:195]
    s_waitcnt lgkmcnt(8)
    v_pk_add_f32 v[160:161], v[160:161], v[112:113]
    v_pk_add_f32 v[162:163], v[162:163], v[114:115]
    s_waitcnt lgkmcnt(7)
    v_pk_add_f32 v[164:165], v[164:165], v[116:117]
    v_pk_add_f32 v[166:167], v[166:167], v[118:119]
    s_waitcnt lgkmcnt(6)
    v_pk_add_f32 v[168:169], v[168:169], v[120:121]
    v_pk_add_f32 v[170:171], v[170:171], v[122:123]
    s_waitcnt lgkmcnt(5)
    v_pk_add_f32 v[160:161], v[160:161], v[124:125]
    v_pk_add_f32 v[162:163], v[162:163], v[126:127]
    s_waitcnt lgkmcnt(4)
    v_pk_add_f32 v[164:165], v[164:165], v[128:129]
    v_pk_add_f32 v[166:167], v[166:167], v[130:131]
    s_waitcnt lgkmcnt(3)
    v_pk_add_f32 v[168:169], v[168:169], v[132:133]
    v_pk_add_f32 v[170:171], v[170:171], v[134:135]
    s_waitcnt lgkmcnt(2)
    v_pk_add_f32 v[160:161], v[160:161], v[136:137]
    v_pk_add_f32 v[162:163], v[162:163], v[138:139]
    s_waitcnt lgkmcnt(1)
    v_pk_add_f32 v[164:165], v[164:165], v[140:141]
    v_pk_add_f32 v[166:167], v[166:167], v[142:143]
    s_waitcnt lgkmcnt(0)
    v_pk_add_f32 v[168:169], v[168:169], v[144:145]
    v_pk_add_f32 v[170:171], v[170:171], v[146:147]
    v_pk_add_f32 v[202:203], v[168:169], v[170:171]
    v_pk_mul_f32 v[204:205], v[168:169], v[168:169]
    v_pk_fma_f32 v[204:205], v[170:171], v[170:171], v[204:205]
    v_pk_add_f32 v[188:189], v[160:161], v[162:163]
    v_pk_mul_f32 v[202:203], v[202:203], s[26:27]
    v_pk_mul_f32 v[204:205], v[204:205], s[26:27]
    v_pk_add_f32 v[190:191], v[164:165], v[166:167]
    v_pk_fma_f32 v[204:205], v[160:161], v[160:161], v[204:205]
    v_pk_fma_f32 v[204:205], v[162:163], v[162:163], v[204:205]
    v_pk_fma_f32 v[204:205], v[164:165], v[164:165], v[204:205]
    v_pk_fma_f32 v[204:205], v[166:167], v[166:167], v[204:205]
    v_pk_add_f32 v[188:189], v[188:189], v[190:191]
    v_pk_add_f32 v[202:203], v[202:203], v[188:189]
    v_add_f32 v201, v204, v205
    v_add_f32 v200, v202, v203
    s_nop 1
    v_permlane16_swap_b32 v200, v201
    v_add_f32 v200, v200, v201
    v_mov_b32 v201, v200
    s_nop 1
    v_permlane32_swap_b32 v200, v201
    v_add_f32 v200, v200, v201
    v_mov_b32 v201, v200
    s_nop 1
    v_permlane16_swap_b32 v200, v201
    v_or_b32 v201, 0x80000000, v201
    s_add_u32 s12, s60, 65536
    buffer_store_dwordx2 v[200:201], v14, s[44:47], s12 offen sc1
    s_waitcnt vmcnt(10)
    v_mfma_f32_16x16x32_bf16 v[172:175], a[0:3], v[16:19], 0
    v_mfma_f32_16x16x32_bf16 v[176:179], a[4:7], v[16:19], 0
    v_mfma_f32_16x16x32_bf16 v[128:131], a[8:11], v[16:19], 0
    s_add_u32 s10, s57, 398336
    buffer_load_dwordx4 v[56:59], v10, s[36:39], s10 offen sc1
    v_mfma_f32_16x16x32_bf16 v[136:139], a[12:15], v[16:19], 0
    v_mfma_f32_16x16x32_bf16 v[180:183], a[16:19], v[16:19], 0
    s_waitcnt vmcnt(10)
    v_mfma_f32_16x16x32_bf16 v[116:119], a[0:3], v[20:23], 0
    v_mfma_f32_16x16x32_bf16 v[124:127], a[4:7], v[20:23], 0
    v_mfma_f32_16x16x32_bf16 v[132:135], a[8:11], v[20:23], 0
    s_add_u32 s10, s58, 398336
    buffer_load_dwordx4 v[60:63], v10, s[36:39], s10 offen sc1
    v_mfma_f32_16x16x32_bf16 v[140:143], a[12:15], v[20:23], 0
    v_mfma_f32_16x16x32_bf16 v[148:151], a[16:19], v[20:23], 0
    s_waitcnt vmcnt(10)
    v_mfma_f32_16x16x32_bf16 v[172:175], a[20:23], v[24:27], v[172:175]
    v_mfma_f32_16x16x32_bf16 v[176:179], a[24:27], v[24:27], v[176:179]
    v_mfma_f32_16x16x32_bf16 v[128:131], a[28:31], v[24:27], v[128:131]
    s_add_u32 s10, s57, 399360
    buffer_load_dwordx4 v[64:67], v10, s[36:39], s10 offen sc1
    v_mfma_f32_16x16x32_bf16 v[136:139], a[32:35], v[24:27], v[136:139]
    v_mfma_f32_16x16x32_bf16 v[180:183], a[36:39], v[24:27], v[180:183]
    s_waitcnt vmcnt(10)
    v_mfma_f32_16x16x32_bf16 v[116:119], a[20:23], v[28:31], v[116:119]
    v_mfma_f32_16x16x32_bf16 v[124:127], a[24:27], v[28:31], v[124:127]
    v_mfma_f32_16x16x32_bf16 v[132:135], a[28:31], v[28:31], v[132:135]
    s_add_u32 s10, s58, 399360
    buffer_load_dwordx4 v[68:71], v10, s[36:39], s10 offen sc1
    v_mfma_f32_16x16x32_bf16 v[140:143], a[32:35], v[28:31], v[140:143]
    v_mfma_f32_16x16x32_bf16 v[148:151], a[36:39], v[28:31], v[148:151]
    s_waitcnt vmcnt(10)
    v_mfma_f32_16x16x32_bf16 v[172:175], a[40:43], v[32:35], v[172:175]
    s_add_u32 s10, s57, 400384
    buffer_load_dwordx4 v[72:75], v10, s[36:39], s10 offen sc1
    v_mfma_f32_16x16x32_bf16 v[176:179], a[44:47], v[32:35], v[176:179]
    s_add_u32 s10, s58, 400384
    buffer_load_dwordx4 v[76:79], v10, s[36:39], s10 offen sc1
    v_mfma_f32_16x16x32_bf16 v[128:131], a[48:51], v[32:35], v[128:131]
    v_mfma_f32_16x16x32_bf16 v[136:139], a[52:55], v[32:35], v[136:139]
    s_add_u32 s13, s62, 163840
    s_lshl_b32 s12, s14, 11
    s_add_u32 s12, s12, s13
    s_add_u32 s13, s13, 4096
    buffer_load_dwordx2 v[222:223], v250, s[28:31], s12 offen sc1
    v_mfma_f32_16x16x32_bf16 v[180:183], a[56:59], v[32:35], v[180:183]
    buffer_load_dwordx2 v[224:225], v250, s[28:31], s12 offen offset:256 sc1
    s_waitcnt vmcnt(13)
    v_mfma_f32_16x16x32_bf16 v[116:119], a[40:43], v[36:39], v[116:119]
    buffer_load_dwordx2 v[226:227], v10, s[28:31], s13 offen sc1
    v_mfma_f32_16x16x32_bf16 v[124:127], a[44:47], v[36:39], v[124:127]
    buffer_load_dwordx2 v[234:235], v250, s[52:55], s12 offen sc1
    v_mfma_f32_16x16x32_bf16 v[132:135], a[48:51], v[36:39], v[132:135]
    v_mfma_f32_16x16x32_bf16 v[140:143], a[52:55], v[36:39], v[140:143]
    buffer_load_dwordx2 v[236:237], v250, s[52:55], s12 offen offset:256 sc1
    v_mfma_f32_16x16x32_bf16 v[148:151], a[56:59], v[36:39], v[148:151]
    buffer_load_dwordx2 v[238:239], v10, s[52:55], s13 offen sc1
    s_waitcnt vmcnt(16)
    v_mfma_f32_16x16x32_bf16 v[172:175], a[60:63], v[40:43], v[172:175]
    v_mfma_f32_16x16x32_bf16 v[176:179], a[64:67], v[40:43], v[176:179]
    v_mfma_f32_16x16x32_bf16 v[128:131], a[68:71], v[40:43], v[128:131]
    s_add_u32 s10, s57, 401408
    buffer_load_dwordx4 v[80:83], v10, s[36:39], s10 offen sc1
    v_mfma_f32_16x16x32_bf16 v[136:139], a[72:75], v[40:43], v[136:139]
    v_mfma_f32_16x16x32_bf16 v[180:183], a[76:79], v[40:43], v[180:183]
    s_waitcnt vmcnt(16)
    v_mfma_f32_16x16x32_bf16 v[116:119], a[60:63], v[44:47], v[116:119]
    v_mfma_f32_16x16x32_bf16 v[124:127], a[64:67], v[44:47], v[124:127]
    v_mfma_f32_16x16x32_bf16 v[132:135], a[68:71], v[44:47], v[132:135]
    s_add_u32 s10, s58, 401408
    buffer_load_dwordx4 v[84:87], v10, s[36:39], s10 offen sc1
    v_mfma_f32_16x16x32_bf16 v[140:143], a[72:75], v[44:47], v[140:143]
    v_mfma_f32_16x16x32_bf16 v[148:151], a[76:79], v[44:47], v[148:151]
    s_waitcnt vmcnt(16)
    v_mfma_f32_16x16x32_bf16 v[172:175], a[80:83], v[48:51], v[172:175]
    s_add_u32 s10, s57, 402432
    buffer_load_dwordx4 v[88:91], v10, s[36:39], s10 offen sc1
    v_mfma_f32_16x16x32_bf16 v[176:179], a[84:87], v[48:51], v[176:179]
    v_mfma_f32_16x16x32_bf16 v[128:131], a[88:91], v[48:51], v[128:131]
    s_add_u32 s10, s58, 402432
    buffer_load_dwordx4 v[92:95], v10, s[36:39], s10 offen sc1
    v_mfma_f32_16x16x32_bf16 v[136:139], a[92:95], v[48:51], v[136:139]
    v_mfma_f32_16x16x32_bf16 v[180:183], a[96:99], v[48:51], v[180:183]
    s_lshl_b32 s13, s16, 11
    s_add_u32 s13, s13, 65536
    buffer_load_dwordx2 v[192:193], v15, s[44:47], s13 offen offset:0 sc1
    s_waitcnt vmcnt(18)
    v_mfma_f32_16x16x32_bf16 v[116:119], a[80:83], v[52:55], v[116:119]
    buffer_load_dwordx2 v[194:195], v15, s[44:47], s13 offen offset:128 sc1
    v_mfma_f32_16x16x32_bf16 v[124:127], a[84:87], v[52:55], v[124:127]
    v_mfma_f32_16x16x32_bf16 v[132:135], a[88:91], v[52:55], v[132:135]
    buffer_load_dwordx2 v[196:197], v15, s[44:47], s13 offen offset:256 sc1
    v_mfma_f32_16x16x32_bf16 v[140:143], a[92:95], v[52:55], v[140:143]
    v_mfma_f32_16x16x32_bf16 v[148:151], a[96:99], v[52:55], v[148:151]
    buffer_load_dwordx2 v[198:199], v15, s[44:47], s13 offen offset:384 sc1
    s_barrier
    s_waitcnt vmcnt(19)
    v_mfma_f32_16x16x32_bf16 v[172:175], a[100:103], v[56:59], v[172:175]
    v_mfma_f32_16x16x32_bf16 v[176:179], a[104:107], v[56:59], v[176:179]
    v_mfma_f32_16x16x32_bf16 v[128:131], a[108:111], v[56:59], v[128:131]
    s_add_u32 s10, s57, 403456
    buffer_load_dwordx4 v[96:99], v10, s[36:39], s10 offen sc1
    v_mfma_f32_16x16x32_bf16 v[136:139], a[112:115], v[56:59], v[136:139]
    v_mfma_f32_16x16x32_bf16 v[180:183], a[116:119], v[56:59], v[180:183]
    s_waitcnt vmcnt(19)
    v_mfma_f32_16x16x32_bf16 v[116:119], a[100:103], v[60:63], v[116:119]
    v_mfma_f32_16x16x32_bf16 v[124:127], a[104:107], v[60:63], v[124:127]
    v_mfma_f32_16x16x32_bf16 v[132:135], a[108:111], v[60:63], v[132:135]
    s_add_u32 s10, s58, 403456
    buffer_load_dwordx4 v[100:103], v10, s[36:39], s10 offen sc1
    v_mfma_f32_16x16x32_bf16 v[140:143], a[112:115], v[60:63], v[140:143]
    v_mfma_f32_16x16x32_bf16 v[148:151], a[116:119], v[60:63], v[148:151]
    s_waitcnt vmcnt(19)
    v_mfma_f32_16x16x32_bf16 v[172:175], a[120:123], v[64:67], v[172:175]
    v_mfma_f32_16x16x32_bf16 v[176:179], a[124:127], v[64:67], v[176:179]
    v_mfma_f32_16x16x32_bf16 v[128:131], a[128:131], v[64:67], v[128:131]
    s_add_u32 s10, s57, 404480
    buffer_load_dwordx4 v[104:107], v10, s[36:39], s10 offen sc1
    v_mfma_f32_16x16x32_bf16 v[136:139], a[132:135], v[64:67], v[136:139]
    v_mfma_f32_16x16x32_bf16 v[180:183], a[136:139], v[64:67], v[180:183]
    s_waitcnt vmcnt(19)
    v_mfma_f32_16x16x32_bf16 v[116:119], a[120:123], v[68:71], v[116:119]
    v_mfma_f32_16x16x32_bf16 v[124:127], a[124:127], v[68:71], v[124:127]
    v_mfma_f32_16x16x32_bf16 v[132:135], a[128:131], v[68:71], v[132:135]
    s_add_u32 s10, s58, 404480
    buffer_load_dwordx4 v[108:111], v10, s[36:39], s10 offen sc1
    v_mfma_f32_16x16x32_bf16 v[140:143], a[132:135], v[68:71], v[140:143]
    v_mfma_f32_16x16x32_bf16 v[148:151], a[136:139], v[68:71], v[148:151]
    s_waitcnt vmcnt(19)
    v_mfma_f32_16x16x32_bf16 v[172:175], a[140:143], v[72:75], v[172:175]
    v_mfma_f32_16x16x32_bf16 v[176:179], a[144:147], v[72:75], v[176:179]
    v_mfma_f32_16x16x32_bf16 v[128:131], a[148:151], v[72:75], v[128:131]
    v_mfma_f32_16x16x32_bf16 v[136:139], a[152:155], v[72:75], v[136:139]
    v_mfma_f32_16x16x32_bf16 v[180:183], a[156:159], v[72:75], v[180:183]
    s_waitcnt vmcnt(18)
    v_mfma_f32_16x16x32_bf16 v[116:119], a[140:143], v[76:79], v[116:119]
    v_mfma_f32_16x16x32_bf16 v[124:127], a[144:147], v[76:79], v[124:127]
    v_mfma_f32_16x16x32_bf16 v[132:135], a[148:151], v[76:79], v[132:135]
    v_mfma_f32_16x16x32_bf16 v[140:143], a[152:155], v[76:79], v[140:143]
    v_mfma_f32_16x16x32_bf16 v[148:151], a[156:159], v[76:79], v[148:151]
    s_waitcnt vmcnt(6)
    v_min_u32 v204, v193, v195
    s_waitcnt vmcnt(5)
    v_min_u32 v204, v204, v197
    s_waitcnt vmcnt(4)
    v_min_u32 v204, v204, v199
    v_cmp_ne_u32 vcc, 0, v204
    s_nop 0
    s_cmp_eq_u64 vcc, -1
    s_cbranch_scc1 interleave_layers__ssm_conv_h3__swiglu_ffn__prompt_kernel_ok27
    s_mov_b32 s23, 0
interleave_layers__ssm_conv_h3__swiglu_ffn__prompt_kernel_spin28:
    s_sleep 1
    s_lshl_b32 s13, s16, 11
    s_add_u32 s13, s13, 65536
    buffer_load_dwordx2 v[192:193], v15, s[44:47], s13 offen offset:0 sc1
    buffer_load_dwordx2 v[194:195], v15, s[44:47], s13 offen offset:128 sc1
    buffer_load_dwordx2 v[196:197], v15, s[44:47], s13 offen offset:256 sc1
    buffer_load_dwordx2 v[198:199], v15, s[44:47], s13 offen offset:384 sc1
    s_waitcnt vmcnt(0)
    s_add_u32 s23, s23, 1
    s_cmp_ge_u32 s23, 262144
    s_cbranch_scc1 interleave_layers__ssm_conv_h3__swiglu_ffn__prompt_kernel_ok27
    v_min_u32 v204, v193, v195
    v_min_u32 v204, v204, v197
    v_min_u32 v204, v204, v199
    v_cmp_ne_u32 vcc, 0, v204
    s_nop 0
    s_cmp_eq_u64 vcc, -1
    s_cbranch_scc0 interleave_layers__ssm_conv_h3__swiglu_ffn__prompt_kernel_spin28
    s_nop 1
interleave_layers__ssm_conv_h3__swiglu_ffn__prompt_kernel_ok27:
    v_pk_add_f32 v[192:193], v[192:193], v[194:195]
    v_pk_add_f32 v[192:193], v[192:193], v[196:197]
    v_pk_add_f32 v[192:193], v[192:193], v[198:199]
    v_mov_b32 v204, v192
    s_nop 1
    v_permlane16_swap_b32 v192, v204
    v_add_f32 v192, v192, v204
    v_mov_b32 v204, v192
    s_nop 1
    v_permlane32_swap_b32 v192, v204
    v_add_f32 v192, v192, v204
    v_mov_b32 v204, v193
    s_nop 1
    v_permlane16_swap_b32 v193, v204
    v_add_f32 v193, v193, v204
    v_mov_b32 v204, v193
    s_nop 1
    v_permlane32_swap_b32 v193, v204
    v_add_f32 v193, v193, v204
    v_mul_f32 v206, 0xbacccccd, v192
    v_mul_f32 v193, 0xbacccccd, v193
    v_fma_f32 v193, -v206, v206, v193
    v_max_f32 v193, 0, v193
    v_add_f32 v193, 0x3727c5ac, v193
    v_rsq_f32 v207, v193
    s_nop 0
    v_mul_f32 v206, v206, v207
    v_lshlrev_b32 v184, 16, v228
    v_and_b32 v185, 0xffff0000, v228
    v_pk_fma_f32 v[186:187], v[160:161], v[206:207], v[206:207] op_sel:[0,1,0] op_sel_hi:[1,1,0]
    v_pk_fma_f32 v[160:161], v[186:187], v[184:185], v[160:161]
    v_cvt_pk_bf16_f32 v216, v160, v161
    v_lshlrev_b32 v184, 16, v229
    v_and_b32 v185, 0xffff0000, v229
    v_pk_fma_f32 v[186:187], v[162:163], v[206:207], v[206:207] op_sel:[0,1,0] op_sel_hi:[1,1,0]
    v_pk_fma_f32 v[162:163], v[186:187], v[184:185], v[162:163]
    v_cvt_pk_bf16_f32 v217, v162, v163
    v_lshlrev_b32 v184, 16, v230
    v_and_b32 v185, 0xffff0000, v230
    v_pk_fma_f32 v[186:187], v[164:165], v[206:207], v[206:207] op_sel:[0,1,0] op_sel_hi:[1,1,0]
    v_pk_fma_f32 v[164:165], v[186:187], v[184:185], v[164:165]
    v_cvt_pk_bf16_f32 v218, v164, v165
    v_lshlrev_b32 v184, 16, v231
    v_and_b32 v185, 0xffff0000, v231
    v_pk_fma_f32 v[186:187], v[166:167], v[206:207], v[206:207] op_sel:[0,1,0] op_sel_hi:[1,1,0]
    v_pk_fma_f32 v[166:167], v[186:187], v[184:185], v[166:167]
    v_cvt_pk_bf16_f32 v219, v166, v167
    v_lshlrev_b32 v184, 16, v232
    v_and_b32 v185, 0xffff0000, v232
    v_pk_fma_f32 v[186:187], v[168:169], v[206:207], v[206:207] op_sel:[0,1,0] op_sel_hi:[1,1,0]
    v_pk_fma_f32 v[168:169], v[186:187], v[184:185], v[168:169]
    v_cvt_pk_bf16_f32 v220, v168, v169
    v_lshlrev_b32 v184, 16, v233
    v_and_b32 v185, 0xffff0000, v233
    v_pk_fma_f32 v[186:187], v[170:171], v[206:207], v[206:207] op_sel:[0,1,0] op_sel_hi:[1,1,0]
    v_pk_fma_f32 v[170:171], v[186:187], v[184:185], v[170:171]
    v_cvt_pk_bf16_f32 v221, v170, v171
    s_add_u32 s13, s59, 14680064
    s_lshl_b32 s12, s14, 10
    s_add_u32 s12, s12, s13
    buffer_store_dwordx4 v[216:219], v10, s[28:31], s12 offen sc1
    buffer_store_dwordx2 v[220:221], v12, s[28:31], s13 offen offset:2048 sc1
    v_lshlrev_b32 v160, 16, v216
    v_and_b32 v161, 0xffff0000, v216
    v_lshlrev_b32 v162, 16, v217
    v_and_b32 v163, 0xffff0000, v217
    v_lshlrev_b32 v164, 16, v218
    v_and_b32 v165, 0xffff0000, v218
    v_lshlrev_b32 v166, 16, v219
    v_and_b32 v167, 0xffff0000, v219
    v_lshlrev_b32 v168, 16, v220
    v_and_b32 v169, 0xffff0000, v220
    v_lshlrev_b32 v170, 16, v221
    v_and_b32 v171, 0xffff0000, v221
    v_pk_add_f32 v[202:203], v[168:169], v[170:171]
    v_pk_mul_f32 v[204:205], v[168:169], v[168:169]
    v_pk_fma_f32 v[204:205], v[170:171], v[170:171], v[204:205]
    v_pk_add_f32 v[188:189], v[160:161], v[162:163]
    v_pk_mul_f32 v[202:203], v[202:203], s[26:27]
    v_pk_mul_f32 v[204:205], v[204:205], s[26:27]
    v_pk_add_f32 v[190:191], v[164:165], v[166:167]
    v_pk_fma_f32 v[204:205], v[160:161], v[160:161], v[204:205]
    v_pk_fma_f32 v[204:205], v[162:163], v[162:163], v[204:205]
    v_pk_fma_f32 v[204:205], v[164:165], v[164:165], v[204:205]
    v_pk_fma_f32 v[204:205], v[166:167], v[166:167], v[204:205]
    v_pk_add_f32 v[188:189], v[188:189], v[190:191]
    v_pk_add_f32 v[202:203], v[202:203], v[188:189]
    v_add_f32 v245, v204, v205
    v_add_f32 v244, v202, v203
    s_nop 1
    v_permlane16_swap_b32 v244, v245
    v_add_f32 v244, v244, v245
    v_mov_b32 v245, v244
    s_nop 1
    v_permlane32_swap_b32 v244, v245
    v_add_f32 v244, v244, v245
    v_mov_b32 v245, v244
    s_nop 1
    v_permlane16_swap_b32 v244, v245
    v_or_b32 v245, 0x80000000, v245
    v_mfma_f32_16x16x32_bf16 v[172:175], a[160:163], v[80:83], v[172:175]
    v_mfma_f32_16x16x32_bf16 v[176:179], a[164:167], v[80:83], v[176:179]
    v_mfma_f32_16x16x32_bf16 v[128:131], a[168:171], v[80:83], v[128:131]
    v_mfma_f32_16x16x32_bf16 v[136:139], a[172:175], v[80:83], v[136:139]
    v_mfma_f32_16x16x32_bf16 v[180:183], a[176:179], v[80:83], v[180:183]
    v_mfma_f32_16x16x32_bf16 v[116:119], a[160:163], v[84:87], v[116:119]
    v_mfma_f32_16x16x32_bf16 v[124:127], a[164:167], v[84:87], v[124:127]
    v_mfma_f32_16x16x32_bf16 v[132:135], a[168:171], v[84:87], v[132:135]
    v_mfma_f32_16x16x32_bf16 v[140:143], a[172:175], v[84:87], v[140:143]
    v_mfma_f32_16x16x32_bf16 v[148:151], a[176:179], v[84:87], v[148:151]
    v_mfma_f32_16x16x32_bf16 v[116:119], a[180:183], v[92:95], v[116:119]
    s_waitcnt vmcnt(4)
    v_mfma_f32_16x16x32_bf16 v[116:119], a[200:203], v[100:103], v[116:119]
    s_waitcnt vmcnt(2)
    v_mfma_f32_16x16x32_bf16 v[116:119], a[220:223], v[108:111], v[116:119]
    v_mfma_f32_16x16x32_bf16 v[124:127], a[184:187], v[92:95], v[124:127]
    v_mfma_f32_16x16x32_bf16 v[124:127], a[204:207], v[100:103], v[124:127]
    v_mfma_f32_16x16x32_bf16 v[124:127], a[224:227], v[108:111], v[124:127]
    v_mfma_f32_16x16x32_bf16 v[128:131], a[188:191], v[88:91], v[128:131]
    v_mfma_f32_16x16x32_bf16 v[128:131], a[208:211], v[96:99], v[128:131]
    v_mfma_f32_16x16x32_bf16 v[128:131], a[228:231], v[104:107], v[128:131]
    s_nop 1
    ds_write_b128 v249, v[116:119] offset:0
    v_mfma_f32_16x16x32_bf16 v[136:139], a[192:195], v[88:91], v[136:139]
    v_mfma_f32_16x16x32_bf16 v[136:139], a[212:215], v[96:99], v[136:139]
    v_mfma_f32_16x16x32_bf16 v[136:139], a[232:235], v[104:107], v[136:139]
    ds_write_b128 v249, v[124:127] offset:1024
    v_mfma_f32_16x16x32_bf16 v[132:135], a[188:191], v[92:95], v[132:135]
    v_mfma_f32_16x16x32_bf16 v[132:135], a[208:211], v[100:103], v[132:135]
    v_mfma_f32_16x16x32_bf16 v[132:135], a[228:231], v[108:111], v[132:135]
    ds_write_b128 v249, v[128:131] offset:2048
    v_mfma_f32_16x16x32_bf16 v[140:143], a[192:195], v[92:95], v[140:143]
    v_lshlrev_b32 v184, 16, v222
    v_mfma_f32_16x16x32_bf16 v[140:143], a[212:215], v[100:103], v[140:143]
    v_and_b32 v185, 0xffff0000, v222
    v_mfma_f32_16x16x32_bf16 v[140:143], a[232:235], v[108:111], v[140:143]
    v_lshlrev_b32 v186, 16, v223
    ds_write_b128 v249, v[136:139] offset:3072
    v_mfma_f32_16x16x32_bf16 v[148:151], a[196:199], v[92:95], v[148:151]
    v_and_b32 v187, 0xffff0000, v223
    v_mfma_f32_16x16x32_bf16 v[148:151], a[216:219], v[100:103], v[148:151]
    v_lshlrev_b32 v188, 16, v224
    v_mfma_f32_16x16x32_bf16 v[148:151], a[236:239], v[108:111], v[148:151]
    v_and_b32 v189, 0xffff0000, v224
    ds_write_b128 v249, v[132:135] offset:4096
    v_mfma_f32_16x16x32_bf16 v[180:183], a[196:199], v[88:91], v[180:183]
    v_lshlrev_b32 v190, 16, v225
    v_mfma_f32_16x16x32_bf16 v[180:183], a[216:219], v[96:99], v[180:183]
    v_and_b32 v191, 0xffff0000, v225
    v_mfma_f32_16x16x32_bf16 v[180:183], a[236:239], v[104:107], v[180:183]
    v_lshlrev_b32 v192, 16, v226
    ds_write_b128 v249, v[140:143] offset:5120
    v_mfma_f32_16x16x32_bf16 v[172:175], a[180:183], v[88:91], v[172:175]
    v_and_b32 v193, 0xffff0000, v226
    v_mfma_f32_16x16x32_bf16 v[172:175], a[200:203], v[96:99], v[172:175]
    v_lshlrev_b32 v194, 16, v227
    v_mfma_f32_16x16x32_bf16 v[172:175], a[220:223], v[104:107], v[172:175]
    v_and_b32 v195, 0xffff0000, v227
    ds_write_b128 v249, v[148:151] offset:7168
    v_mfma_f32_16x16x32_bf16 v[176:179], a[184:187], v[88:91], v[176:179]
    v_xor_b32 v197, 8192, v249
    v_mfma_f32_16x16x32_bf16 v[176:179], a[204:207], v[96:99], v[176:179]
    v_xor_b32 v198, 16384, v249
    v_mfma_f32_16x16x32_bf16 v[176:179], a[224:227], v[104:107], v[176:179]
    v_xor_b32 v199, 24576, v249
    ds_write_b128 v249, v[180:183] offset:6144
    s_add_u32 s12, s60, 327680
    s_waitcnt vmcnt(0)
    buffer_store_dwordx2 v[244:245], v14, s[44:47], s12 offen sc1
    s_waitcnt lgkmcnt(0)
    s_barrier
    ds_read_b128 v[112:115], v197 offset:0
    ds_read_b128 v[116:119], v197 offset:1024
    ds_read_b128 v[120:123], v197 offset:7168
    ds_read_b128 v[124:127], v198 offset:2048
    ds_read_b128 v[128:131], v198 offset:3072
    ds_read_b128 v[132:135], v198 offset:6144
    ds_read_b128 v[136:139], v199 offset:4096
    ds_read_b128 v[140:143], v199 offset:5120
    ds_read_b128 v[144:147], v199 offset:7168
    v_pk_add_f32 v[172:173], v[172:173], v[184:185]
    v_pk_add_f32 v[174:175], v[174:175], v[186:187]
    v_pk_add_f32 v[176:177], v[176:177], v[188:189]
    v_pk_add_f32 v[178:179], v[178:179], v[190:191]
    v_pk_add_f32 v[180:181], v[180:181], v[192:193]
    v_pk_add_f32 v[182:183], v[182:183], v[194:195]
    s_waitcnt lgkmcnt(8)
    v_pk_add_f32 v[172:173], v[172:173], v[112:113]
    v_pk_add_f32 v[174:175], v[174:175], v[114:115]
    s_waitcnt lgkmcnt(7)
    v_pk_add_f32 v[176:177], v[176:177], v[116:117]
    v_pk_add_f32 v[178:179], v[178:179], v[118:119]
    s_waitcnt lgkmcnt(6)
    v_pk_add_f32 v[180:181], v[180:181], v[120:121]
    v_pk_add_f32 v[182:183], v[182:183], v[122:123]
    s_waitcnt lgkmcnt(5)
    v_pk_add_f32 v[172:173], v[172:173], v[124:125]
    v_pk_add_f32 v[174:175], v[174:175], v[126:127]
    s_waitcnt lgkmcnt(4)
    v_pk_add_f32 v[176:177], v[176:177], v[128:129]
    v_pk_add_f32 v[178:179], v[178:179], v[130:131]
    s_waitcnt lgkmcnt(3)
    v_pk_add_f32 v[180:181], v[180:181], v[132:133]
    v_pk_add_f32 v[182:183], v[182:183], v[134:135]
    s_waitcnt lgkmcnt(2)
    v_pk_add_f32 v[172:173], v[172:173], v[136:137]
    v_pk_add_f32 v[174:175], v[174:175], v[138:139]
    s_waitcnt lgkmcnt(1)
    v_pk_add_f32 v[176:177], v[176:177], v[140:141]
    v_pk_add_f32 v[178:179], v[178:179], v[142:143]
    s_waitcnt lgkmcnt(0)
    v_pk_add_f32 v[180:181], v[180:181], v[144:145]
    v_pk_add_f32 v[182:183], v[182:183], v[146:147]
    v_pk_add_f32 v[202:203], v[180:181], v[182:183]
    v_pk_mul_f32 v[204:205], v[180:181], v[180:181]
    v_pk_fma_f32 v[204:205], v[182:183], v[182:183], v[204:205]
    v_pk_add_f32 v[188:189], v[172:173], v[174:175]
    v_pk_mul_f32 v[202:203], v[202:203], s[26:27]
    v_pk_mul_f32 v[204:205], v[204:205], s[26:27]
    v_pk_add_f32 v[190:191], v[176:177], v[178:179]
    v_pk_fma_f32 v[204:205], v[172:173], v[172:173], v[204:205]
    v_pk_fma_f32 v[204:205], v[174:175], v[174:175], v[204:205]
    v_pk_fma_f32 v[204:205], v[176:177], v[176:177], v[204:205]
    v_pk_fma_f32 v[204:205], v[178:179], v[178:179], v[204:205]
    v_pk_add_f32 v[188:189], v[188:189], v[190:191]
    v_pk_add_f32 v[202:203], v[202:203], v[188:189]
    v_add_f32 v201, v204, v205
    v_add_f32 v200, v202, v203
    s_nop 1
    v_permlane16_swap_b32 v200, v201
    v_add_f32 v200, v200, v201
    v_mov_b32 v201, v200
    s_nop 1
    v_permlane32_swap_b32 v200, v201
    v_add_f32 v200, v200, v201
    v_mov_b32 v201, v200
    s_nop 1
    v_permlane16_swap_b32 v200, v201
    v_or_b32 v201, 0x80000000, v201
    s_add_u32 s12, s60, 81920
    buffer_store_dwordx2 v[200:201], v14, s[44:47], s12 offen sc1
    s_lshl_b32 s13, s15, 11
    s_add_u32 s13, s13, 327680
    buffer_load_dwordx2 v[184:185], v15, s[44:47], s13 offen offset:0 sc1
    buffer_load_dwordx2 v[186:187], v15, s[44:47], s13 offen offset:128 sc1
    buffer_load_dwordx2 v[188:189], v15, s[44:47], s13 offen offset:256 sc1
    buffer_load_dwordx2 v[190:191], v15, s[44:47], s13 offen offset:384 sc1
    buffer_load_dwordx2 v[192:193], v15, s[44:47], s13 offen offset:2048 sc1
    buffer_load_dwordx2 v[194:195], v15, s[44:47], s13 offen offset:2176 sc1
    buffer_load_dwordx2 v[196:197], v15, s[44:47], s13 offen offset:2304 sc1
    buffer_load_dwordx2 v[198:199], v15, s[44:47], s13 offen offset:2432 sc1
    s_waitcnt vmcnt(6)
    v_min_u32 v204, v185, v187
    s_waitcnt vmcnt(5)
    v_min_u32 v204, v204, v189
    s_waitcnt vmcnt(4)
    v_min_u32 v204, v204, v191
    s_waitcnt vmcnt(3)
    v_min_u32 v204, v204, v193
    s_waitcnt vmcnt(2)
    v_min_u32 v204, v204, v195
    s_waitcnt vmcnt(1)
    v_min_u32 v204, v204, v197
    s_waitcnt vmcnt(0)
    v_min_u32 v204, v204, v199
    v_cmp_ne_u32 vcc, 0, v204
    s_nop 0
    s_cmp_eq_u64 vcc, -1
    s_cbranch_scc1 interleave_layers__ssm_conv_h3__swiglu_ffn__prompt_kernel_ok29
    s_mov_b32 s23, 0
interleave_layers__ssm_conv_h3__swiglu_ffn__prompt_kernel_spin30:
    s_sleep 1
    s_lshl_b32 s13, s15, 11
    s_add_u32 s13, s13, 327680
    buffer_load_dwordx2 v[184:185], v15, s[44:47], s13 offen offset:0 sc1
    buffer_load_dwordx2 v[186:187], v15, s[44:47], s13 offen offset:128 sc1
    buffer_load_dwordx2 v[188:189], v15, s[44:47], s13 offen offset:256 sc1
    buffer_load_dwordx2 v[190:191], v15, s[44:47], s13 offen offset:384 sc1
    buffer_load_dwordx2 v[192:193], v15, s[44:47], s13 offen offset:2048 sc1
    buffer_load_dwordx2 v[194:195], v15, s[44:47], s13 offen offset:2176 sc1
    buffer_load_dwordx2 v[196:197], v15, s[44:47], s13 offen offset:2304 sc1
    buffer_load_dwordx2 v[198:199], v15, s[44:47], s13 offen offset:2432 sc1
    s_waitcnt vmcnt(0)
    s_add_u32 s23, s23, 1
    s_cmp_ge_u32 s23, 262144
    s_cbranch_scc1 interleave_layers__ssm_conv_h3__swiglu_ffn__prompt_kernel_ok29
    v_min_u32 v204, v185, v187
    v_min_u32 v204, v204, v189
    v_min_u32 v204, v204, v191
    v_min_u32 v204, v204, v193
    v_min_u32 v204, v204, v195
    v_min_u32 v204, v204, v197
    v_min_u32 v204, v204, v199
    v_cmp_ne_u32 vcc, 0, v204
    s_nop 0
    s_cmp_eq_u64 vcc, -1
    s_cbranch_scc0 interleave_layers__ssm_conv_h3__swiglu_ffn__prompt_kernel_spin30
    s_nop 1
interleave_layers__ssm_conv_h3__swiglu_ffn__prompt_kernel_ok29:
    v_pk_add_f32 v[184:185], v[184:185], v[186:187]
    v_pk_add_f32 v[184:185], v[184:185], v[188:189]
    v_pk_add_f32 v[184:185], v[184:185], v[190:191]
    v_mov_b32 v204, v184
    s_nop 1
    v_permlane16_swap_b32 v184, v204
    v_add_f32 v184, v184, v204
    v_mov_b32 v204, v184
    s_nop 1
    v_permlane32_swap_b32 v184, v204
    v_add_f32 v184, v184, v204
    v_mov_b32 v204, v185
    s_nop 1
    v_permlane16_swap_b32 v185, v204
    v_add_f32 v185, v185, v204
    v_mov_b32 v204, v185
    s_nop 1
    v_permlane32_swap_b32 v185, v204
    v_add_f32 v185, v185, v204
    v_mul_f32 v4, 0xbacccccd, v184
    v_mul_f32 v185, 0xbacccccd, v185
    v_fma_f32 v185, -v4, v4, v185
    v_max_f32 v185, 0, v185
    v_add_f32 v185, 0x3727c5ac, v185
    v_rsq_f32 v5, v185
    v_pk_add_f32 v[192:193], v[192:193], v[194:195]
    v_pk_add_f32 v[192:193], v[192:193], v[196:197]
    v_pk_add_f32 v[192:193], v[192:193], v[198:199]
    v_mov_b32 v204, v192
    s_nop 1
    v_permlane16_swap_b32 v192, v204
    v_add_f32 v192, v192, v204
    v_mov_b32 v204, v192
    s_nop 1
    v_permlane32_swap_b32 v192, v204
    v_add_f32 v192, v192, v204
    v_mov_b32 v204, v193
    s_nop 1
    v_permlane16_swap_b32 v193, v204
    v_add_f32 v193, v193, v204
    v_mov_b32 v204, v193
    s_nop 1
    v_permlane32_swap_b32 v193, v204
    v_add_f32 v193, v193, v204
    v_mul_f32 v6, 0xbacccccd, v192
    v_mul_f32 v193, 0xbacccccd, v193
    v_fma_f32 v193, -v6, v6, v193
    v_max_f32 v193, 0, v193
    v_add_f32 v193, 0x3727c5ac, v193
    v_rsq_f32 v7, v193
    s_add_u32 s10, s17, 14680064
    buffer_load_dwordx4 v[16:19], v10, s[28:31], s10 offen sc1
    s_add_u32 s10, s17, 14700544
    buffer_load_dwordx4 v[20:23], v10, s[28:31], s10 offen sc1
    s_add_u32 s10, s17, 14681088
    buffer_load_dwordx4 v[24:27], v10, s[28:31], s10 offen sc1
    s_add_u32 s10, s17, 14701568
    buffer_load_dwordx4 v[28:31], v10, s[28:31], s10 offen sc1
    s_add_u32 s10, s17, 14682112
    buffer_load_dwordx4 v[32:35], v10, s[28:31], s10 offen sc1
    s_add_u32 s10, s17, 14702592
    buffer_load_dwordx4 v[36:39], v10, s[28:31], s10 offen sc1
    s_add_u32 s10, s17, 14683136
    buffer_load_dwordx4 v[40:43], v10, s[28:31], s10 offen sc1
    s_add_u32 s10, s17, 14703616
    buffer_load_dwordx4 v[44:47], v10, s[28:31], s10 offen sc1
    s_lshl_b32 s13, s16, 11
    s_add_u32 s13, s13, 81920
    buffer_load_dwordx2 v[192:193], v15, s[44:47], s13 offen offset:0 sc1
    buffer_load_dwordx2 v[194:195], v15, s[44:47], s13 offen offset:128 sc1
    buffer_load_dwordx2 v[196:197], v15, s[44:47], s13 offen offset:256 sc1
    buffer_load_dwordx2 v[198:199], v15, s[44:47], s13 offen offset:384 sc1
    s_add_u32 s10, s17, 14684160
    buffer_load_dwordx4 v[48:51], v10, s[28:31], s10 offen sc1
    s_add_u32 s10, s17, 14704640
    buffer_load_dwordx4 v[52:55], v10, s[28:31], s10 offen sc1
    s_add_u32 s10, s17, 14685184
    buffer_load_dwordx4 v[56:59], v10, s[28:31], s10 offen sc1
    s_add_u32 s10, s17, 14705664
    buffer_load_dwordx4 v[60:63], v10, s[28:31], s10 offen sc1
    s_add_u32 s10, s17, 14686208
    buffer_load_dwordx4 v[64:67], v10, s[28:31], s10 offen sc1
    s_add_u32 s10, s17, 14706688
    buffer_load_dwordx4 v[68:71], v10, s[28:31], s10 offen sc1
    s_add_u32 s10, s17, 14687232
    buffer_load_dwordx4 v[72:75], v10, s[28:31], s10 offen sc1
    s_add_u32 s10, s17, 14707712
    buffer_load_dwordx4 v[76:79], v10, s[28:31], s10 offen sc1
    s_waitcnt vmcnt(10)
    v_min_u32 v204, v193, v195
    s_waitcnt vmcnt(9)
    v_min_u32 v204, v204, v197
    s_waitcnt vmcnt(8)
    v_min_u32 v204, v204, v199
    v_cmp_ne_u32 vcc, 0, v204
    s_nop 0
    s_cmp_eq_u64 vcc, -1
    s_cbranch_scc1 interleave_layers__ssm_conv_h3__swiglu_ffn__prompt_kernel_ok31
    s_mov_b32 s23, 0
interleave_layers__ssm_conv_h3__swiglu_ffn__prompt_kernel_spin32:
    s_sleep 1
    s_lshl_b32 s13, s16, 11
    s_add_u32 s13, s13, 81920
    buffer_load_dwordx2 v[192:193], v15, s[44:47], s13 offen offset:0 sc1
    buffer_load_dwordx2 v[194:195], v15, s[44:47], s13 offen offset:128 sc1
    buffer_load_dwordx2 v[196:197], v15, s[44:47], s13 offen offset:256 sc1
    buffer_load_dwordx2 v[198:199], v15, s[44:47], s13 offen offset:384 sc1
    s_waitcnt vmcnt(0)
    s_add_u32 s23, s23, 1
    s_cmp_ge_u32 s23, 262144
    s_cbranch_scc1 interleave_layers__ssm_conv_h3__swiglu_ffn__prompt_kernel_ok31
    v_min_u32 v204, v193, v195
    v_min_u32 v204, v204, v197
    v_min_u32 v204, v204, v199
    v_cmp_ne_u32 vcc, 0, v204
    s_nop 0
    s_cmp_eq_u64 vcc, -1
    s_cbranch_scc0 interleave_layers__ssm_conv_h3__swiglu_ffn__prompt_kernel_spin32
    s_nop 1
interleave_layers__ssm_conv_h3__swiglu_ffn__prompt_kernel_ok31:
    v_pk_add_f32 v[192:193], v[192:193], v[194:195]
    v_pk_add_f32 v[192:193], v[192:193], v[196:197]
    v_pk_add_f32 v[192:193], v[192:193], v[198:199]
    v_mov_b32 v204, v192
    s_nop 1
    v_permlane16_swap_b32 v192, v204
    v_add_f32 v192, v192, v204
    v_mov_b32 v204, v192
    s_nop 1
    v_permlane32_swap_b32 v192, v204
    v_add_f32 v192, v192, v204
    v_mov_b32 v204, v193
    s_nop 1
    v_permlane16_swap_b32 v193, v204
    v_add_f32 v193, v193, v204
    v_mov_b32 v204, v193
    s_nop 1
    v_permlane32_swap_b32 v193, v204
    v_add_f32 v193, v193, v204
    v_mul_f32 v206, 0xbacccccd, v192
    v_mul_f32 v193, 0xbacccccd, v193
    v_fma_f32 v193, -v206, v206, v193
    v_max_f32 v193, 0, v193
    v_add_f32 v193, 0x3727c5ac, v193
    v_rsq_f32 v207, v193
    s_nop 0
    v_mul_f32 v206, v206, v207
    v_lshlrev_b32 v184, 16, v234
    v_and_b32 v185, 0xffff0000, v234
    v_pk_fma_f32 v[186:187], v[172:173], v[206:207], v[206:207] op_sel:[0,1,0] op_sel_hi:[1,1,0]
    v_pk_fma_f32 v[172:173], v[186:187], v[184:185], v[172:173]
    v_cvt_pk_bf16_f32 v222, v172, v173
    v_lshlrev_b32 v184, 16, v235
    v_and_b32 v185, 0xffff0000, v235
    v_pk_fma_f32 v[186:187], v[174:175], v[206:207], v[206:207] op_sel:[0,1,0] op_sel_hi:[1,1,0]
    v_pk_fma_f32 v[174:175], v[186:187], v[184:185], v[174:175]
    v_cvt_pk_bf16_f32 v223, v174, v175
    v_lshlrev_b32 v184, 16, v236
    v_and_b32 v185, 0xffff0000, v236
    v_pk_fma_f32 v[186:187], v[176:177], v[206:207], v[206:207] op_sel:[0,1,0] op_sel_hi:[1,1,0]
    v_pk_fma_f32 v[176:177], v[186:187], v[184:185], v[176:177]
    v_cvt_pk_bf16_f32 v224, v176, v177
    v_lshlrev_b32 v184, 16, v237
    v_and_b32 v185, 0xffff0000, v237
    v_pk_fma_f32 v[186:187], v[178:179], v[206:207], v[206:207] op_sel:[0,1,0] op_sel_hi:[1,1,0]
    v_pk_fma_f32 v[178:179], v[186:187], v[184:185], v[178:179]
    v_cvt_pk_bf16_f32 v225, v178, v179
    v_lshlrev_b32 v184, 16, v238
    v_and_b32 v185, 0xffff0000, v238
    v_pk_fma_f32 v[186:187], v[180:181], v[206:207], v[206:207] op_sel:[0,1,0] op_sel_hi:[1,1,0]
    v_pk_fma_f32 v[180:181], v[186:187], v[184:185], v[180:181]
    v_cvt_pk_bf16_f32 v226, v180, v181
    v_lshlrev_b32 v184, 16, v239
    v_and_b32 v185, 0xffff0000, v239
    v_pk_fma_f32 v[186:187], v[182:183], v[206:207], v[206:207] op_sel:[0,1,0] op_sel_hi:[1,1,0]
    v_pk_fma_f32 v[182:183], v[186:187], v[184:185], v[182:183]
    v_cvt_pk_bf16_f32 v227, v182, v183
    s_add_u32 s13, s59, 14843904
    s_lshl_b32 s12, s14, 10
    s_add_u32 s12, s12, s13
    buffer_store_dwordx4 v[222:225], v10, s[28:31], s12 offen sc1
    buffer_store_dwordx2 v[226:227], v12, s[28:31], s13 offen offset:2048 sc1
    v_lshlrev_b32 v172, 16, v222
    v_and_b32 v173, 0xffff0000, v222
    v_lshlrev_b32 v174, 16, v223
    v_and_b32 v175, 0xffff0000, v223
    v_lshlrev_b32 v176, 16, v224
    v_and_b32 v177, 0xffff0000, v224
    v_lshlrev_b32 v178, 16, v225
    v_and_b32 v179, 0xffff0000, v225
    v_lshlrev_b32 v180, 16, v226
    v_and_b32 v181, 0xffff0000, v226
    v_lshlrev_b32 v182, 16, v227
    v_and_b32 v183, 0xffff0000, v227
    v_pk_add_f32 v[202:203], v[180:181], v[182:183]
    v_pk_mul_f32 v[204:205], v[180:181], v[180:181]
    v_pk_fma_f32 v[204:205], v[182:183], v[182:183], v[204:205]
    v_pk_add_f32 v[188:189], v[172:173], v[174:175]
    v_pk_mul_f32 v[202:203], v[202:203], s[26:27]
    v_pk_mul_f32 v[204:205], v[204:205], s[26:27]
    v_pk_add_f32 v[190:191], v[176:177], v[178:179]
    v_pk_fma_f32 v[204:205], v[172:173], v[172:173], v[204:205]
    v_pk_fma_f32 v[204:205], v[174:175], v[174:175], v[204:205]
    v_pk_fma_f32 v[204:205], v[176:177], v[176:177], v[204:205]
    v_pk_fma_f32 v[204:205], v[178:179], v[178:179], v[204:205]
    v_pk_add_f32 v[188:189], v[188:189], v[190:191]
    v_pk_add_f32 v[202:203], v[202:203], v[188:189]
    v_add_f32 v247, v204, v205
    v_add_f32 v246, v202, v203
    s_nop 1
    v_permlane16_swap_b32 v246, v247
    v_add_f32 v246, v246, v247
    v_mov_b32 v247, v246
    s_nop 1
    v_permlane32_swap_b32 v246, v247
    v_add_f32 v246, v246, v247
    v_mov_b32 v247, v246
    s_nop 1
    v_permlane16_swap_b32 v246, v247
    v_or_b32 v247, 0x80000000, v247
    ds_read_b128 v[160:163], v10 offset:0
    ds_read_b128 v[164:167], v10 offset:1024
    ds_read_b128 v[168:171], v10 offset:2048
    ds_read_b128 v[172:175], v10 offset:3072
    ds_read_b128 v[176:179], v10 offset:4096
    ds_read_b128 v[180:183], v10 offset:5120
    s_waitcnt lgkmcnt(5)
    v_mfma_f32_16x16x32_bf16 v[112:115], v[160:163], v[16:19], 0
    s_waitcnt lgkmcnt(4)
    v_mfma_f32_16x16x32_bf16 v[116:119], v[160:163], v[20:23], 0
    s_add_u32 s10, s17, 14688256
    ds_read_b128 v[160:163], v10 offset:6144
    v_mfma_f32_16x16x32_bf16 v[120:123], v[164:167], v[16:19], 0
    buffer_load_dwordx4 v[80:83], v10, s[28:31], s10 offen sc1
    s_waitcnt lgkmcnt(4)
    v_mfma_f32_16x16x32_bf16 v[124:127], v[164:167], v[20:23], 0
    ds_read_b128 v[164:167], v10 offset:7168
    v_mfma_f32_16x16x32_bf16 v[128:131], v[168:171], v[16:19], 0
    s_waitcnt lgkmcnt(4)
    v_mfma_f32_16x16x32_bf16 v[132:135], v[168:171], v[20:23], 0
    ds_read_b128 v[168:171], v10 offset:8192
    v_mfma_f32_16x16x32_bf16 v[136:139], v[172:175], v[16:19], 0
    s_waitcnt lgkmcnt(4)
    v_mfma_f32_16x16x32_bf16 v[140:143], v[172:175], v[20:23], 0
    s_add_u32 s10, s17, 14708736
    ds_read_b128 v[172:175], v10 offset:9216
    v_mfma_f32_16x16x32_bf16 v[144:147], v[176:179], v[16:19], 0
    buffer_load_dwordx4 v[84:87], v10, s[28:31], s10 offen sc1
    s_waitcnt lgkmcnt(4)
    v_mfma_f32_16x16x32_bf16 v[148:151], v[176:179], v[20:23], 0
    ds_read_b128 v[176:179], v10 offset:10240
    v_mfma_f32_16x16x32_bf16 v[152:155], v[180:183], v[16:19], 0
    s_waitcnt lgkmcnt(4)
    v_mfma_f32_16x16x32_bf16 v[156:159], v[180:183], v[20:23], 0
    ds_read_b128 v[180:183], v10 offset:11264
    v_mfma_f32_16x16x32_bf16 v[112:115], v[160:163], v[24:27], v[112:115]
    s_waitcnt lgkmcnt(4)
    v_mfma_f32_16x16x32_bf16 v[116:119], v[160:163], v[28:31], v[116:119]
    s_add_u32 s10, s17, 14689280
    ds_read_b128 v[160:163], v10 offset:12288
    v_mfma_f32_16x16x32_bf16 v[120:123], v[164:167], v[24:27], v[120:123]
    buffer_load_dwordx4 v[88:91], v10, s[28:31], s10 offen sc1
    s_waitcnt lgkmcnt(4)
    v_mfma_f32_16x16x32_bf16 v[124:127], v[164:167], v[28:31], v[124:127]
    ds_read_b128 v[164:167], v10 offset:13312
    v_mfma_f32_16x16x32_bf16 v[128:131], v[168:171], v[24:27], v[128:131]
    s_waitcnt lgkmcnt(4)
    v_mfma_f32_16x16x32_bf16 v[132:135], v[168:171], v[28:31], v[132:135]
    ds_read_b128 v[168:171], v10 offset:14336
    v_mfma_f32_16x16x32_bf16 v[136:139], v[172:175], v[24:27], v[136:139]
    s_waitcnt lgkmcnt(4)
    v_mfma_f32_16x16x32_bf16 v[140:143], v[172:175], v[28:31], v[140:143]
    s_add_u32 s10, s17, 14709760
    ds_read_b128 v[172:175], v10 offset:15360
    v_mfma_f32_16x16x32_bf16 v[144:147], v[176:179], v[24:27], v[144:147]
    buffer_load_dwordx4 v[92:95], v10, s[28:31], s10 offen sc1
    s_waitcnt lgkmcnt(4)
    v_mfma_f32_16x16x32_bf16 v[148:151], v[176:179], v[28:31], v[148:151]
    ds_read_b128 v[176:179], v10 offset:16384
    v_mfma_f32_16x16x32_bf16 v[152:155], v[180:183], v[24:27], v[152:155]
    s_waitcnt lgkmcnt(4)
    v_mfma_f32_16x16x32_bf16 v[156:159], v[180:183], v[28:31], v[156:159]
    ds_read_b128 v[180:183], v10 offset:17408
    v_mfma_f32_16x16x32_bf16 v[112:115], v[160:163], v[32:35], v[112:115]
    s_waitcnt lgkmcnt(4)
    v_mfma_f32_16x16x32_bf16 v[116:119], v[160:163], v[36:39], v[116:119]
    s_add_u32 s10, s17, 14690304
    ds_read_b128 v[160:163], v10 offset:18432
    v_mfma_f32_16x16x32_bf16 v[120:123], v[164:167], v[32:35], v[120:123]
    buffer_load_dwordx4 v[96:99], v10, s[28:31], s10 offen sc1
    s_waitcnt lgkmcnt(4)
    v_mfma_f32_16x16x32_bf16 v[124:127], v[164:167], v[36:39], v[124:127]
    ds_read_b128 v[164:167], v10 offset:19456
    v_mfma_f32_16x16x32_bf16 v[128:131], v[168:171], v[32:35], v[128:131]
    s_waitcnt lgkmcnt(4)
    v_mfma_f32_16x16x32_bf16 v[132:135], v[168:171], v[36:39], v[132:135]
    ds_read_b128 v[168:171], v10 offset:20480
    v_mfma_f32_16x16x32_bf16 v[136:139], v[172:175], v[32:35], v[136:139]
    s_waitcnt lgkmcnt(4)
    v_mfma_f32_16x16x32_bf16 v[140:143], v[172:175], v[36:39], v[140:143]
    s_add_u32 s10, s17, 14710784
    ds_read_b128 v[172:175], v10 offset:21504
    v_mfma_f32_16x16x32_bf16 v[144:147], v[176:179], v[32:35], v[144:147]
    buffer_load_dwordx4 v[100:103], v10, s[28:31], s10 offen sc1
    s_waitcnt lgkmcnt(4)
    v_mfma_f32_16x16x32_bf16 v[148:151], v[176:179], v[36:39], v[148:151]
    ds_read_b128 v[176:179], v10 offset:22528
    v_mfma_f32_16x16x32_bf16 v[152:155], v[180:183], v[32:35], v[152:155]
    s_waitcnt lgkmcnt(4)
    v_mfma_f32_16x16x32_bf16 v[156:159], v[180:183], v[36:39], v[156:159]
    ds_read_b128 v[180:183], v10 offset:23552
    v_mfma_f32_16x16x32_bf16 v[112:115], v[160:163], v[40:43], v[112:115]
    s_waitcnt lgkmcnt(4)
    v_mfma_f32_16x16x32_bf16 v[116:119], v[160:163], v[44:47], v[116:119]
    s_add_u32 s10, s17, 14691328
    ds_read_b128 v[160:163], v10 offset:24576
    v_mfma_f32_16x16x32_bf16 v[120:123], v[164:167], v[40:43], v[120:123]
    buffer_load_dwordx4 v[104:107], v10, s[28:31], s10 offen sc1
    s_waitcnt lgkmcnt(4)
    v_mfma_f32_16x16x32_bf16 v[124:127], v[164:167], v[44:47], v[124:127]
    ds_read_b128 v[164:167], v10 offset:25600
    v_mfma_f32_16x16x32_bf16 v[128:131], v[168:171], v[40:43], v[128:131]
    s_waitcnt lgkmcnt(4)
    v_mfma_f32_16x16x32_bf16 v[132:135], v[168:171], v[44:47], v[132:135]
    ds_read_b128 v[168:171], v10 offset:26624
    v_mfma_f32_16x16x32_bf16 v[136:139], v[172:175], v[40:43], v[136:139]
    s_waitcnt lgkmcnt(4)
    v_mfma_f32_16x16x32_bf16 v[140:143], v[172:175], v[44:47], v[140:143]
    s_add_u32 s10, s17, 14711808
    ds_read_b128 v[172:175], v10 offset:27648
    v_mfma_f32_16x16x32_bf16 v[144:147], v[176:179], v[40:43], v[144:147]
    buffer_load_dwordx4 v[108:111], v10, s[28:31], s10 offen sc1
    s_waitcnt lgkmcnt(4)
    v_mfma_f32_16x16x32_bf16 v[148:151], v[176:179], v[44:47], v[148:151]
    ds_read_b128 v[176:179], v10 offset:28672
    v_mfma_f32_16x16x32_bf16 v[152:155], v[180:183], v[40:43], v[152:155]
    s_waitcnt vmcnt(16) lgkmcnt(4)
    v_mfma_f32_16x16x32_bf16 v[156:159], v[180:183], v[44:47], v[156:159]
    ds_read_b128 v[180:183], v10 offset:29696
    s_add_u32 s12, s60, 344064
    s_waitcnt vmcnt(8)
    buffer_store_dwordx2 v[246:247], v14, s[44:47], s12 offen sc1
    v_mfma_f32_16x16x32_bf16 v[112:115], v[160:163], v[48:51], v[112:115]
    s_waitcnt lgkmcnt(4)
    v_mfma_f32_16x16x32_bf16 v[116:119], v[160:163], v[52:55], v[116:119]
    s_add_u32 s10, s17, 14692352
    ds_read_b128 v[160:163], v10 offset:30720
    v_mfma_f32_16x16x32_bf16 v[120:123], v[164:167], v[48:51], v[120:123]
    buffer_load_dwordx4 v[16:19], v10, s[28:31], s10 offen sc1
    s_waitcnt lgkmcnt(4)
    v_mfma_f32_16x16x32_bf16 v[124:127], v[164:167], v[52:55], v[124:127]
    ds_read_b128 v[164:167], v10 offset:31744
    v_mfma_f32_16x16x32_bf16 v[128:131], v[168:171], v[48:51], v[128:131]
    s_waitcnt lgkmcnt(4)
    v_mfma_f32_16x16x32_bf16 v[132:135], v[168:171], v[52:55], v[132:135]
    ds_read_b128 v[168:171], v10 offset:32768
    v_mfma_f32_16x16x32_bf16 v[136:139], v[172:175], v[48:51], v[136:139]
    s_waitcnt lgkmcnt(4)
    v_mfma_f32_16x16x32_bf16 v[140:143], v[172:175], v[52:55], v[140:143]
    s_add_u32 s10, s17, 14712832
    ds_read_b128 v[172:175], v10 offset:33792
    v_mfma_f32_16x16x32_bf16 v[144:147], v[176:179], v[48:51], v[144:147]
    buffer_load_dwordx4 v[20:23], v10, s[28:31], s10 offen sc1
    s_waitcnt lgkmcnt(4)
    v_mfma_f32_16x16x32_bf16 v[148:151], v[176:179], v[52:55], v[148:151]
    ds_read_b128 v[176:179], v10 offset:34816
    v_mfma_f32_16x16x32_bf16 v[152:155], v[180:183], v[48:51], v[152:155]
    s_waitcnt lgkmcnt(4)
    v_mfma_f32_16x16x32_bf16 v[156:159], v[180:183], v[52:55], v[156:159]
    ds_read_b128 v[180:183], v10 offset:35840
    v_mfma_f32_16x16x32_bf16 v[112:115], v[160:163], v[56:59], v[112:115]
    s_waitcnt lgkmcnt(4)
    v_mfma_f32_16x16x32_bf16 v[116:119], v[160:163], v[60:63], v[116:119]
    s_add_u32 s10, s17, 14693376
    ds_read_b128 v[160:163], v10 offset:36864
    v_mfma_f32_16x16x32_bf16 v[120:123], v[164:167], v[56:59], v[120:123]
    buffer_load_dwordx4 v[24:27], v10, s[28:31], s10 offen sc1
    s_waitcnt lgkmcnt(4)
    v_mfma_f32_16x16x32_bf16 v[124:127], v[164:167], v[60:63], v[124:127]
    ds_read_b128 v[164:167], v10 offset:37888
    v_mfma_f32_16x16x32_bf16 v[128:131], v[168:171], v[56:59], v[128:131]
    s_waitcnt lgkmcnt(4)
    v_mfma_f32_16x16x32_bf16 v[132:135], v[168:171], v[60:63], v[132:135]
    ds_read_b128 v[168:171], v10 offset:38912
    v_mfma_f32_16x16x32_bf16 v[136:139], v[172:175], v[56:59], v[136:139]
    s_waitcnt lgkmcnt(4)
    v_mfma_f32_16x16x32_bf16 v[140:143], v[172:175], v[60:63], v[140:143]
    s_add_u32 s10, s17, 14713856
    ds_read_b128 v[172:175], v10 offset:39936
    v_mfma_f32_16x16x32_bf16 v[144:147], v[176:179], v[56:59], v[144:147]
    buffer_load_dwordx4 v[28:31], v10, s[28:31], s10 offen sc1
    s_waitcnt lgkmcnt(4)
    v_mfma_f32_16x16x32_bf16 v[148:151], v[176:179], v[60:63], v[148:151]
    ds_read_b128 v[176:179], v10 offset:40960
    v_mfma_f32_16x16x32_bf16 v[152:155], v[180:183], v[56:59], v[152:155]
    s_waitcnt lgkmcnt(4)
    v_mfma_f32_16x16x32_bf16 v[156:159], v[180:183], v[60:63], v[156:159]
    ds_read_b128 v[180:183], v10 offset:41984
    v_mfma_f32_16x16x32_bf16 v[112:115], v[160:163], v[64:67], v[112:115]
    s_waitcnt lgkmcnt(4)
    v_mfma_f32_16x16x32_bf16 v[116:119], v[160:163], v[68:71], v[116:119]
    s_add_u32 s10, s17, 14694400
    ds_read_b128 v[160:163], v10 offset:43008
    v_mfma_f32_16x16x32_bf16 v[120:123], v[164:167], v[64:67], v[120:123]
    buffer_load_dwordx4 v[32:35], v10, s[28:31], s10 offen sc1
    s_waitcnt lgkmcnt(4)
    v_mfma_f32_16x16x32_bf16 v[124:127], v[164:167], v[68:71], v[124:127]
    ds_read_b128 v[164:167], v10 offset:44032
    v_mfma_f32_16x16x32_bf16 v[128:131], v[168:171], v[64:67], v[128:131]
    s_waitcnt lgkmcnt(4)
    v_mfma_f32_16x16x32_bf16 v[132:135], v[168:171], v[68:71], v[132:135]
    ds_read_b128 v[168:171], v10 offset:45056
    v_mfma_f32_16x16x32_bf16 v[136:139], v[172:175], v[64:67], v[136:139]
    s_waitcnt lgkmcnt(4)
    v_mfma_f32_16x16x32_bf16 v[140:143], v[172:175], v[68:71], v[140:143]
    s_add_u32 s10, s17, 14714880
    ds_read_b128 v[172:175], v10 offset:46080
    v_mfma_f32_16x16x32_bf16 v[144:147], v[176:179], v[64:67], v[144:147]
    buffer_load_dwordx4 v[36:39], v10, s[28:31], s10 offen sc1
    s_waitcnt lgkmcnt(4)
    v_mfma_f32_16x16x32_bf16 v[148:151], v[176:179], v[68:71], v[148:151]
    ds_read_b128 v[176:179], v10 offset:47104
    v_mfma_f32_16x16x32_bf16 v[152:155], v[180:183], v[64:67], v[152:155]
    s_waitcnt lgkmcnt(4)
    v_mfma_f32_16x16x32_bf16 v[156:159], v[180:183], v[68:71], v[156:159]
    ds_read_b128 v[180:183], v10 offset:48128
    v_mfma_f32_16x16x32_bf16 v[112:115], v[160:163], v[72:75], v[112:115]
    s_waitcnt lgkmcnt(4)
    v_mfma_f32_16x16x32_bf16 v[116:119], v[160:163], v[76:79], v[116:119]
    s_add_u32 s10, s17, 14695424
    ds_read_b128 v[160:163], v10 offset:49152
    v_mfma_f32_16x16x32_bf16 v[120:123], v[164:167], v[72:75], v[120:123]
    buffer_load_dwordx4 v[40:43], v10, s[28:31], s10 offen sc1
    s_waitcnt lgkmcnt(4)
    v_mfma_f32_16x16x32_bf16 v[124:127], v[164:167], v[76:79], v[124:127]
    ds_read_b128 v[164:167], v10 offset:50176
    v_mfma_f32_16x16x32_bf16 v[128:131], v[168:171], v[72:75], v[128:131]
    s_waitcnt lgkmcnt(4)
    v_mfma_f32_16x16x32_bf16 v[132:135], v[168:171], v[76:79], v[132:135]
    ds_read_b128 v[168:171], v10 offset:51200
    v_mfma_f32_16x16x32_bf16 v[136:139], v[172:175], v[72:75], v[136:139]
    s_waitcnt lgkmcnt(4)
    v_mfma_f32_16x16x32_bf16 v[140:143], v[172:175], v[76:79], v[140:143]
    s_add_u32 s10, s17, 14715904
    ds_read_b128 v[172:175], v10 offset:52224
    v_mfma_f32_16x16x32_bf16 v[144:147], v[176:179], v[72:75], v[144:147]
    buffer_load_dwordx4 v[44:47], v10, s[28:31], s10 offen sc1
    s_waitcnt lgkmcnt(4)
    v_mfma_f32_16x16x32_bf16 v[148:151], v[176:179], v[76:79], v[148:151]
    ds_read_b128 v[176:179], v10 offset:53248
    v_mfma_f32_16x16x32_bf16 v[152:155], v[180:183], v[72:75], v[152:155]
    s_waitcnt vmcnt(15) lgkmcnt(4)
    v_mfma_f32_16x16x32_bf16 v[156:159], v[180:183], v[76:79], v[156:159]
    ds_read_b128 v[180:183], v10 offset:54272
    v_mfma_f32_16x16x32_bf16 v[112:115], v[160:163], v[80:83], v[112:115]
    s_waitcnt lgkmcnt(4)
    v_mfma_f32_16x16x32_bf16 v[116:119], v[160:163], v[84:87], v[116:119]
    s_add_u32 s10, s17, 14696448
    ds_read_b128 v[160:163], v10 offset:55296
    v_mfma_f32_16x16x32_bf16 v[120:123], v[164:167], v[80:83], v[120:123]
    buffer_load_dwordx4 v[48:51], v10, s[28:31], s10 offen sc1
    s_waitcnt lgkmcnt(4)
    v_mfma_f32_16x16x32_bf16 v[124:127], v[164:167], v[84:87], v[124:127]
    ds_read_b128 v[164:167], v10 offset:56320
    v_mfma_f32_16x16x32_bf16 v[128:131], v[168:171], v[80:83], v[128:131]
    s_waitcnt lgkmcnt(4)
    v_mfma_f32_16x16x32_bf16 v[132:135], v[168:171], v[84:87], v[132:135]
    ds_read_b128 v[168:171], v10 offset:57344
    v_mfma_f32_16x16x32_bf16 v[136:139], v[172:175], v[80:83], v[136:139]
    s_waitcnt lgkmcnt(4)
    v_mfma_f32_16x16x32_bf16 v[140:143], v[172:175], v[84:87], v[140:143]
    s_add_u32 s10, s17, 14716928
    ds_read_b128 v[172:175], v10 offset:58368
    v_mfma_f32_16x16x32_bf16 v[144:147], v[176:179], v[80:83], v[144:147]
    buffer_load_dwordx4 v[52:55], v10, s[28:31], s10 offen sc1
    s_waitcnt lgkmcnt(4)
    v_mfma_f32_16x16x32_bf16 v[148:151], v[176:179], v[84:87], v[148:151]
    ds_read_b128 v[176:179], v10 offset:59392
    v_mfma_f32_16x16x32_bf16 v[152:155], v[180:183], v[80:83], v[152:155]
    s_waitcnt vmcnt(15) lgkmcnt(4)
    v_mfma_f32_16x16x32_bf16 v[156:159], v[180:183], v[84:87], v[156:159]
    ds_read_b128 v[180:183], v10 offset:60416
    v_mfma_f32_16x16x32_bf16 v[112:115], v[160:163], v[88:91], v[112:115]
    s_waitcnt lgkmcnt(4)
    v_mfma_f32_16x16x32_bf16 v[116:119], v[160:163], v[92:95], v[116:119]
    s_add_u32 s10, s17, 14697472
    ds_read_b128 v[160:163], v11 offset:0
    v_mfma_f32_16x16x32_bf16 v[120:123], v[164:167], v[88:91], v[120:123]
    buffer_load_dwordx4 v[56:59], v10, s[28:31], s10 offen sc1
    s_waitcnt lgkmcnt(4)
    v_mfma_f32_16x16x32_bf16 v[124:127], v[164:167], v[92:95], v[124:127]
    ds_read_b128 v[164:167], v11 offset:1024
    v_mfma_f32_16x16x32_bf16 v[128:131], v[168:171], v[88:91], v[128:131]
    s_waitcnt lgkmcnt(4)
    v_mfma_f32_16x16x32_bf16 v[132:135], v[168:171], v[92:95], v[132:135]
    ds_read_b128 v[168:171], v11 offset:2048
    v_mfma_f32_16x16x32_bf16 v[136:139], v[172:175], v[88:91], v[136:139]
    s_waitcnt lgkmcnt(4)
    v_mfma_f32_16x16x32_bf16 v[140:143], v[172:175], v[92:95], v[140:143]
    s_add_u32 s10, s17, 14717952
    ds_read_b128 v[172:175], v11 offset:3072
    v_mfma_f32_16x16x32_bf16 v[144:147], v[176:179], v[88:91], v[144:147]
    buffer_load_dwordx4 v[60:63], v10, s[28:31], s10 offen sc1
    s_waitcnt lgkmcnt(4)
    v_mfma_f32_16x16x32_bf16 v[148:151], v[176:179], v[92:95], v[148:151]
    ds_read_b128 v[176:179], v11 offset:4096
    v_mfma_f32_16x16x32_bf16 v[152:155], v[180:183], v[88:91], v[152:155]
    s_waitcnt vmcnt(15) lgkmcnt(4)
    v_mfma_f32_16x16x32_bf16 v[156:159], v[180:183], v[92:95], v[156:159]
    ds_read_b128 v[180:183], v11 offset:5120
    v_mfma_f32_16x16x32_bf16 v[112:115], v[160:163], v[96:99], v[112:115]
    s_waitcnt lgkmcnt(4)
    v_mfma_f32_16x16x32_bf16 v[116:119], v[160:163], v[100:103], v[116:119]
    s_add_u32 s10, s17, 14698496
    ds_read_b128 v[160:163], v11 offset:6144
    v_mfma_f32_16x16x32_bf16 v[120:123], v[164:167], v[96:99], v[120:123]
    buffer_load_dwordx4 v[64:67], v10, s[28:31], s10 offen sc1
    s_waitcnt lgkmcnt(4)
    v_mfma_f32_16x16x32_bf16 v[124:127], v[164:167], v[100:103], v[124:127]
    ds_read_b128 v[164:167], v11 offset:7168
    v_mfma_f32_16x16x32_bf16 v[128:131], v[168:171], v[96:99], v[128:131]
    s_waitcnt lgkmcnt(4)
    v_mfma_f32_16x16x32_bf16 v[132:135], v[168:171], v[100:103], v[132:135]
    ds_read_b128 v[168:171], v11 offset:8192
    v_mfma_f32_16x16x32_bf16 v[136:139], v[172:175], v[96:99], v[136:139]
    s_waitcnt lgkmcnt(4)
    v_mfma_f32_16x16x32_bf16 v[140:143], v[172:175], v[100:103], v[140:143]
    s_add_u32 s10, s17, 14718976
    ds_read_b128 v[172:175], v11 offset:9216
    v_mfma_f32_16x16x32_bf16 v[144:147], v[176:179], v[96:99], v[144:147]
    buffer_load_dwordx4 v[68:71], v10, s[28:31], s10 offen sc1
    s_waitcnt lgkmcnt(4)
    v_mfma_f32_16x16x32_bf16 v[148:151], v[176:179], v[100:103], v[148:151]
    ds_read_b128 v[176:179], v11 offset:10240
    v_mfma_f32_16x16x32_bf16 v[152:155], v[180:183], v[96:99], v[152:155]
    s_waitcnt vmcnt(15) lgkmcnt(4)
    v_mfma_f32_16x16x32_bf16 v[156:159], v[180:183], v[100:103], v[156:159]
    ds_read_b128 v[180:183], v11 offset:11264
    v_mfma_f32_16x16x32_bf16 v[112:115], v[160:163], v[104:107], v[112:115]
    s_add_u32 s10, s17, 14699520
    buffer_load_dwordx4 v[72:75], v10, s[28:31], s10 offen sc1
    s_add_u32 s10, s17, 14720000
    buffer_load_dwordx4 v[76:79], v10, s[28:31], s10 offen sc1
    s_waitcnt lgkmcnt(4)
    v_mfma_f32_16x16x32_bf16 v[116:119], v[160:163], v[108:111], v[116:119]
    ds_read_b128 v[160:163], v11 offset:12288
    v_mfma_f32_16x16x32_bf16 v[120:123], v[164:167], v[104:107], v[120:123]
    s_lshl_b32 s13, s15, 11
    s_add_u32 s13, s13, 344064
    buffer_load_dwordx2 v[184:185], v15, s[44:47], s13 offen offset:0 sc1
    s_waitcnt lgkmcnt(4)
    v_mfma_f32_16x16x32_bf16 v[124:127], v[164:167], v[108:111], v[124:127]
    ds_read_b128 v[164:167], v11 offset:13312
    v_mfma_f32_16x16x32_bf16 v[128:131], v[168:171], v[104:107], v[128:131]
    buffer_load_dwordx2 v[186:187], v15, s[44:47], s13 offen offset:128 sc1
    buffer_load_dwordx2 v[188:189], v15, s[44:47], s13 offen offset:256 sc1
    s_waitcnt lgkmcnt(4)
    v_mfma_f32_16x16x32_bf16 v[132:135], v[168:171], v[108:111], v[132:135]
    ds_read_b128 v[168:171], v11 offset:14336
    v_mfma_f32_16x16x32_bf16 v[136:139], v[172:175], v[104:107], v[136:139]
    buffer_load_dwordx2 v[190:191], v15, s[44:47], s13 offen offset:384 sc1
    buffer_load_dwordx2 v[192:193], v15, s[44:47], s13 offen offset:2048 sc1
    s_waitcnt lgkmcnt(4)
    v_mfma_f32_16x16x32_bf16 v[140:143], v[172:175], v[108:111], v[140:143]
    ds_read_b128 v[172:175], v11 offset:15360
    v_mfma_f32_16x16x32_bf16 v[144:147], v[176:179], v[104:107], v[144:147]
    buffer_load_dwordx2 v[194:195], v15, s[44:47], s13 offen offset:2176 sc1
    s_waitcnt lgkmcnt(4)
    v_mfma_f32_16x16x32_bf16 v[148:151], v[176:179], v[108:111], v[148:151]
    ds_read_b128 v[176:179], v11 offset:16384
    v_mfma_f32_16x16x32_bf16 v[152:155], v[180:183], v[104:107], v[152:155]
    buffer_load_dwordx2 v[196:197], v15, s[44:47], s13 offen offset:2304 sc1
    buffer_load_dwordx2 v[198:199], v15, s[44:47], s13 offen offset:2432 sc1
    s_waitcnt vmcnt(22) lgkmcnt(4)
    v_mfma_f32_16x16x32_bf16 v[156:159], v[180:183], v[108:111], v[156:159]
    ds_read_b128 v[180:183], v11 offset:17408
    v_mfma_f32_16x16x32_bf16 v[112:115], v[160:163], v[16:19], v[112:115]
    s_waitcnt lgkmcnt(4)
    v_mfma_f32_16x16x32_bf16 v[116:119], v[160:163], v[20:23], v[116:119]
    ds_read_b128 v[160:163], v11 offset:18432
    v_mfma_f32_16x16x32_bf16 v[120:123], v[164:167], v[16:19], v[120:123]
    s_waitcnt lgkmcnt(4)
    v_mfma_f32_16x16x32_bf16 v[124:127], v[164:167], v[20:23], v[124:127]
    ds_read_b128 v[164:167], v11 offset:19456
    v_mfma_f32_16x16x32_bf16 v[128:131], v[168:171], v[16:19], v[128:131]
    s_waitcnt lgkmcnt(4)
    v_mfma_f32_16x16x32_bf16 v[132:135], v[168:171], v[20:23], v[132:135]
    ds_read_b128 v[168:171], v11 offset:20480
    v_mfma_f32_16x16x32_bf16 v[136:139], v[172:175], v[16:19], v[136:139]
    s_waitcnt lgkmcnt(4)
    v_mfma_f32_16x16x32_bf16 v[140:143], v[172:175], v[20:23], v[140:143]
    ds_read_b128 v[172:175], v11 offset:21504
    v_mfma_f32_16x16x32_bf16 v[144:147], v[176:179], v[16:19], v[144:147]
    s_waitcnt lgkmcnt(4)
    v_mfma_f32_16x16x32_bf16 v[148:151], v[176:179], v[20:23], v[148:151]
    ds_read_b128 v[176:179], v11 offset:22528
    v_mfma_f32_16x16x32_bf16 v[152:155], v[180:183], v[16:19], v[152:155]
    s_waitcnt vmcnt(20) lgkmcnt(4)
    v_mfma_f32_16x16x32_bf16 v[156:159], v[180:183], v[20:23], v[156:159]
    ds_read_b128 v[180:183], v11 offset:23552
    v_mfma_f32_16x16x32_bf16 v[112:115], v[160:163], v[24:27], v[112:115]
    s_waitcnt lgkmcnt(4)
    v_mfma_f32_16x16x32_bf16 v[116:119], v[160:163], v[28:31], v[116:119]
    ds_read_b128 v[160:163], v11 offset:24576
    v_mfma_f32_16x16x32_bf16 v[120:123], v[164:167], v[24:27], v[120:123]
    s_waitcnt lgkmcnt(4)
    v_mfma_f32_16x16x32_bf16 v[124:127], v[164:167], v[28:31], v[124:127]
    ds_read_b128 v[164:167], v11 offset:25600
    v_mfma_f32_16x16x32_bf16 v[128:131], v[168:171], v[24:27], v[128:131]
    s_waitcnt lgkmcnt(4)
    v_mfma_f32_16x16x32_bf16 v[132:135], v[168:171], v[28:31], v[132:135]
    ds_read_b128 v[168:171], v11 offset:26624
    v_mfma_f32_16x16x32_bf16 v[136:139], v[172:175], v[24:27], v[136:139]
    s_waitcnt lgkmcnt(4)
    v_mfma_f32_16x16x32_bf16 v[140:143], v[172:175], v[28:31], v[140:143]
    ds_read_b128 v[172:175], v11 offset:27648
    v_mfma_f32_16x16x32_bf16 v[144:147], v[176:179], v[24:27], v[144:147]
    s_waitcnt lgkmcnt(4)
    v_mfma_f32_16x16x32_bf16 v[148:151], v[176:179], v[28:31], v[148:151]
    ds_read_b128 v[176:179], v11 offset:28672
    v_mfma_f32_16x16x32_bf16 v[152:155], v[180:183], v[24:27], v[152:155]
    s_waitcnt vmcnt(18) lgkmcnt(4)
    v_mfma_f32_16x16x32_bf16 v[156:159], v[180:183], v[28:31], v[156:159]
    ds_read_b128 v[180:183], v11 offset:29696
    v_mfma_f32_16x16x32_bf16 v[112:115], v[160:163], v[32:35], v[112:115]
    s_waitcnt lgkmcnt(4)
    v_mfma_f32_16x16x32_bf16 v[116:119], v[160:163], v[36:39], v[116:119]
    ds_read_b128 v[160:163], v11 offset:30720
    v_mfma_f32_16x16x32_bf16 v[120:123], v[164:167], v[32:35], v[120:123]
    s_waitcnt lgkmcnt(4)
    v_mfma_f32_16x16x32_bf16 v[124:127], v[164:167], v[36:39], v[124:127]
    ds_read_b128 v[164:167], v11 offset:31744
    v_mfma_f32_16x16x32_bf16 v[128:131], v[168:171], v[32:35], v[128:131]
    s_waitcnt lgkmcnt(4)
    v_mfma_f32_16x16x32_bf16 v[132:135], v[168:171], v[36:39], v[132:135]
    ds_read_b128 v[168:171], v11 offset:32768
    v_mfma_f32_16x16x32_bf16 v[136:139], v[172:175], v[32:35], v[136:139]
    s_waitcnt lgkmcnt(4)
    v_mfma_f32_16x16x32_bf16 v[140:143], v[172:175], v[36:39], v[140:143]
    ds_read_b128 v[172:175], v11 offset:33792
    v_mfma_f32_16x16x32_bf16 v[144:147], v[176:179], v[32:35], v[144:147]
    s_waitcnt lgkmcnt(4)
    v_mfma_f32_16x16x32_bf16 v[148:151], v[176:179], v[36:39], v[148:151]
    ds_read_b128 v[176:179], v11 offset:34816
    v_mfma_f32_16x16x32_bf16 v[152:155], v[180:183], v[32:35], v[152:155]
    s_waitcnt vmcnt(16) lgkmcnt(4)
    v_mfma_f32_16x16x32_bf16 v[156:159], v[180:183], v[36:39], v[156:159]
    ds_read_b128 v[180:183], v11 offset:35840
    v_mfma_f32_16x16x32_bf16 v[112:115], v[160:163], v[40:43], v[112:115]
    s_waitcnt vmcnt(6)
    v_min_u32 v204, v185, v187
    s_waitcnt vmcnt(5)
    v_min_u32 v204, v204, v189
    s_waitcnt vmcnt(4)
    v_min_u32 v204, v204, v191
    s_waitcnt vmcnt(3)
    v_min_u32 v204, v204, v193
    s_waitcnt vmcnt(2)
    v_min_u32 v204, v204, v195
    s_waitcnt vmcnt(1)
    v_min_u32 v204, v204, v197
    s_waitcnt vmcnt(0)
    v_min_u32 v204, v204, v199
    v_cmp_ne_u32 vcc, 0, v204
    s_nop 0
    s_cmp_eq_u64 vcc, -1
    s_cbranch_scc1 interleave_layers__ssm_conv_h3__swiglu_ffn__prompt_kernel_ok33
    s_mov_b32 s23, 0
interleave_layers__ssm_conv_h3__swiglu_ffn__prompt_kernel_spin34:
    s_sleep 1
    s_lshl_b32 s13, s15, 11
    s_add_u32 s13, s13, 344064
    buffer_load_dwordx2 v[184:185], v15, s[44:47], s13 offen offset:0 sc1
    buffer_load_dwordx2 v[186:187], v15, s[44:47], s13 offen offset:128 sc1
    buffer_load_dwordx2 v[188:189], v15, s[44:47], s13 offen offset:256 sc1
    buffer_load_dwordx2 v[190:191], v15, s[44:47], s13 offen offset:384 sc1
    buffer_load_dwordx2 v[192:193], v15, s[44:47], s13 offen offset:2048 sc1
    buffer_load_dwordx2 v[194:195], v15, s[44:47], s13 offen offset:2176 sc1
    buffer_load_dwordx2 v[196:197], v15, s[44:47], s13 offen offset:2304 sc1
    buffer_load_dwordx2 v[198:199], v15, s[44:47], s13 offen offset:2432 sc1
    s_waitcnt vmcnt(0)
    s_add_u32 s23, s23, 1
    s_cmp_ge_u32 s23, 262144
    s_cbranch_scc1 interleave_layers__ssm_conv_h3__swiglu_ffn__prompt_kernel_ok33
    v_min_u32 v204, v185, v187
    v_min_u32 v204, v204, v189
    v_min_u32 v204, v204, v191
    v_min_u32 v204, v204, v193
    v_min_u32 v204, v204, v195
    v_min_u32 v204, v204, v197
    v_min_u32 v204, v204, v199
    v_cmp_ne_u32 vcc, 0, v204
    s_nop 0
    s_cmp_eq_u64 vcc, -1
    s_cbranch_scc0 interleave_layers__ssm_conv_h3__swiglu_ffn__prompt_kernel_spin34
    s_nop 1
interleave_layers__ssm_conv_h3__swiglu_ffn__prompt_kernel_ok33:
    v_pk_add_f32 v[184:185], v[184:185], v[186:187]
    v_pk_add_f32 v[184:185], v[184:185], v[188:189]
    v_pk_add_f32 v[184:185], v[184:185], v[190:191]
    v_mov_b32 v204, v184
    s_nop 1
    v_permlane16_swap_b32 v184, v204
    v_add_f32 v184, v184, v204
    v_mov_b32 v204, v184
    s_nop 1
    v_permlane32_swap_b32 v184, v204
    v_add_f32 v184, v184, v204
    v_mov_b32 v204, v185
    s_nop 1
    v_permlane16_swap_b32 v185, v204
    v_add_f32 v185, v185, v204
    v_mov_b32 v204, v185
    s_nop 1
    v_permlane32_swap_b32 v185, v204
    v_add_f32 v185, v185, v204
    v_mul_f32 v240, 0xbacccccd, v184
    v_mul_f32 v185, 0xbacccccd, v185
    v_fma_f32 v185, -v240, v240, v185
    v_max_f32 v185, 0, v185
    v_add_f32 v185, 0x3727c5ac, v185
    v_rsq_f32 v241, v185
    v_pk_add_f32 v[192:193], v[192:193], v[194:195]
    v_pk_add_f32 v[192:193], v[192:193], v[196:197]
    v_pk_add_f32 v[192:193], v[192:193], v[198:199]
    v_mov_b32 v204, v192
    s_nop 1
    v_permlane16_swap_b32 v192, v204
    v_add_f32 v192, v192, v204
    v_mov_b32 v204, v192
    s_nop 1
    v_permlane32_swap_b32 v192, v204
    v_add_f32 v192, v192, v204
    v_mov_b32 v204, v193
    s_nop 1
    v_permlane16_swap_b32 v193, v204
    v_add_f32 v193, v193, v204
    v_mov_b32 v204, v193
    s_nop 1
    v_permlane32_swap_b32 v193, v204
    v_add_f32 v193, v193, v204
    v_mul_f32 v242, 0xbacccccd, v192
    v_mul_f32 v193, 0xbacccccd, v193
    v_fma_f32 v193, -v242, v242, v193
    v_max_f32 v193, 0, v193
    v_add_f32 v193, 0x3727c5ac, v193
    v_rsq_f32 v243, v193
    s_add_u32 s10, s17, 14843904
    buffer_load_dwordx4 v[80:83], v10, s[28:31], s10 offen sc1
    s_waitcnt lgkmcnt(4)
    v_mfma_f32_16x16x32_bf16 v[116:119], v[160:163], v[44:47], v[116:119]
    ds_read_b128 v[160:163], v11 offset:36864
    v_mfma_f32_16x16x32_bf16 v[120:123], v[164:167], v[40:43], v[120:123]
    s_waitcnt lgkmcnt(4)
    v_mfma_f32_16x16x32_bf16 v[124:127], v[164:167], v[44:47], v[124:127]
    s_add_u32 s10, s17, 14864384
    ds_read_b128 v[164:167], v11 offset:37888
    v_mfma_f32_16x16x32_bf16 v[128:131], v[168:171], v[40:43], v[128:131]
    buffer_load_dwordx4 v[84:87], v10, s[28:31], s10 offen sc1
    s_waitcnt lgkmcnt(4)
    v_mfma_f32_16x16x32_bf16 v[132:135], v[168:171], v[44:47], v[132:135]
    s_add_u32 s10, s17, 14844928
    ds_read_b128 v[168:171], v11 offset:38912
    v_mfma_f32_16x16x32_bf16 v[136:139], v[172:175], v[40:43], v[136:139]
    buffer_load_dwordx4 v[88:91], v10, s[28:31], s10 offen sc1
    s_waitcnt lgkmcnt(4)
    v_mfma_f32_16x16x32_bf16 v[140:143], v[172:175], v[44:47], v[140:143]
    ds_read_b128 v[172:175], v11 offset:39936
    v_mfma_f32_16x16x32_bf16 v[144:147], v[176:179], v[40:43], v[144:147]
    s_waitcnt lgkmcnt(4)
    v_mfma_f32_16x16x32_bf16 v[148:151], v[176:179], v[44:47], v[148:151]
    s_add_u32 s10, s17, 14865408
    ds_read_b128 v[176:179], v11 offset:40960
    v_mfma_f32_16x16x32_bf16 v[152:155], v[180:183], v[40:43], v[152:155]
    buffer_load_dwordx4 v[92:95], v10, s[28:31], s10 offen sc1
    s_waitcnt lgkmcnt(4)
    v_mfma_f32_16x16x32_bf16 v[156:159], v[180:183], v[44:47], v[156:159]
    ds_read_b128 v[180:183], v11 offset:41984
    v_mfma_f32_16x16x32_bf16 v[112:115], v[160:163], v[48:51], v[112:115]
    s_add_u32 s10, s17, 14845952
    buffer_load_dwordx4 v[96:99], v10, s[28:31], s10 offen sc1
    s_waitcnt lgkmcnt(4)
    v_mfma_f32_16x16x32_bf16 v[116:119], v[160:163], v[52:55], v[116:119]
    ds_read_b128 v[160:163], v11 offset:43008
    v_mfma_f32_16x16x32_bf16 v[120:123], v[164:167], v[48:51], v[120:123]
    s_waitcnt lgkmcnt(4)
    v_mfma_f32_16x16x32_bf16 v[124:127], v[164:167], v[52:55], v[124:127]
    s_add_u32 s10, s17, 14866432
    ds_read_b128 v[164:167], v11 offset:44032
    v_mfma_f32_16x16x32_bf16 v[128:131], v[168:171], v[48:51], v[128:131]
    buffer_load_dwordx4 v[100:103], v10, s[28:31], s10 offen sc1
    s_waitcnt lgkmcnt(4)
    v_mfma_f32_16x16x32_bf16 v[132:135], v[168:171], v[52:55], v[132:135]
    s_add_u32 s10, s17, 14846976
    ds_read_b128 v[168:171], v11 offset:45056
    v_mfma_f32_16x16x32_bf16 v[136:139], v[172:175], v[48:51], v[136:139]
    buffer_load_dwordx4 v[104:107], v10, s[28:31], s10 offen sc1
    s_waitcnt lgkmcnt(4)
    v_mfma_f32_16x16x32_bf16 v[140:143], v[172:175], v[52:55], v[140:143]
    ds_read_b128 v[172:175], v11 offset:46080
    v_mfma_f32_16x16x32_bf16 v[144:147], v[176:179], v[48:51], v[144:147]
    s_waitcnt lgkmcnt(4)
    v_mfma_f32_16x16x32_bf16 v[148:151], v[176:179], v[52:55], v[148:151]
    s_add_u32 s10, s17, 14867456
    ds_read_b128 v[176:179], v11 offset:47104
    v_mfma_f32_16x16x32_bf16 v[152:155], v[180:183], v[48:51], v[152:155]
    buffer_load_dwordx4 v[108:111], v10, s[28:31], s10 offen sc1
    s_waitcnt lgkmcnt(4)
    v_mfma_f32_16x16x32_bf16 v[156:159], v[180:183], v[52:55], v[156:159]
    ds_read_b128 v[180:183], v11 offset:48128
    v_mfma_f32_16x16x32_bf16 v[112:115], v[160:163], v[56:59], v[112:115]
    s_add_u32 s10, s17, 14848000
    buffer_load_dwordx4 v[16:19], v10, s[28:31], s10 offen sc1
    s_waitcnt lgkmcnt(4)
    v_mfma_f32_16x16x32_bf16 v[116:119], v[160:163], v[60:63], v[116:119]
    ds_read_b128 v[160:163], v11 offset:49152
    v_mfma_f32_16x16x32_bf16 v[120:123], v[164:167], v[56:59], v[120:123]
    s_waitcnt lgkmcnt(4)
    v_mfma_f32_16x16x32_bf16 v[124:127], v[164:167], v[60:63], v[124:127]
    s_add_u32 s10, s17, 14868480
    ds_read_b128 v[164:167], v11 offset:50176
    v_mfma_f32_16x16x32_bf16 v[128:131], v[168:171], v[56:59], v[128:131]
    buffer_load_dwordx4 v[20:23], v10, s[28:31], s10 offen sc1
    s_waitcnt lgkmcnt(4)
    v_mfma_f32_16x16x32_bf16 v[132:135], v[168:171], v[60:63], v[132:135]
    s_add_u32 s10, s17, 14849024
    ds_read_b128 v[168:171], v11 offset:51200
    v_mfma_f32_16x16x32_bf16 v[136:139], v[172:175], v[56:59], v[136:139]
    buffer_load_dwordx4 v[24:27], v10, s[28:31], s10 offen sc1
    s_waitcnt lgkmcnt(4)
    v_mfma_f32_16x16x32_bf16 v[140:143], v[172:175], v[60:63], v[140:143]
    ds_read_b128 v[172:175], v11 offset:52224
    v_mfma_f32_16x16x32_bf16 v[144:147], v[176:179], v[56:59], v[144:147]
    s_waitcnt lgkmcnt(4)
    v_mfma_f32_16x16x32_bf16 v[148:151], v[176:179], v[60:63], v[148:151]
    s_add_u32 s10, s17, 14869504
    ds_read_b128 v[176:179], v11 offset:53248
    v_mfma_f32_16x16x32_bf16 v[152:155], v[180:183], v[56:59], v[152:155]
    buffer_load_dwordx4 v[28:31], v10, s[28:31], s10 offen sc1
    s_waitcnt lgkmcnt(4)
    v_mfma_f32_16x16x32_bf16 v[156:159], v[180:183], v[60:63], v[156:159]
    ds_read_b128 v[180:183], v11 offset:54272
    v_mfma_f32_16x16x32_bf16 v[112:115], v[160:163], v[64:67], v[112:115]
    s_add_u32 s10, s17, 14850048
    buffer_load_dwordx4 v[32:35], v10, s[28:31], s10 offen sc1
    s_waitcnt lgkmcnt(4)
    v_mfma_f32_16x16x32_bf16 v[116:119], v[160:163], v[68:71], v[116:119]
    ds_read_b128 v[160:163], v11 offset:55296
    v_mfma_f32_16x16x32_bf16 v[120:123], v[164:167], v[64:67], v[120:123]
    s_waitcnt lgkmcnt(4)
    v_mfma_f32_16x16x32_bf16 v[124:127], v[164:167], v[68:71], v[124:127]
    s_add_u32 s10, s17, 14870528
    ds_read_b128 v[164:167], v11 offset:56320
    v_mfma_f32_16x16x32_bf16 v[128:131], v[168:171], v[64:67], v[128:131]
    buffer_load_dwordx4 v[36:39], v10, s[28:31], s10 offen sc1
    s_waitcnt lgkmcnt(4)
    v_mfma_f32_16x16x32_bf16 v[132:135], v[168:171], v[68:71], v[132:135]
    s_add_u32 s10, s17, 14851072
    ds_read_b128 v[168:171], v11 offset:57344
    v_mfma_f32_16x16x32_bf16 v[136:139], v[172:175], v[64:67], v[136:139]
    buffer_load_dwordx4 v[40:43], v10, s[28:31], s10 offen sc1
    s_waitcnt lgkmcnt(4)
    v_mfma_f32_16x16x32_bf16 v[140:143], v[172:175], v[68:71], v[140:143]
    ds_read_b128 v[172:175], v11 offset:58368
    v_mfma_f32_16x16x32_bf16 v[144:147], v[176:179], v[64:67], v[144:147]
    s_waitcnt lgkmcnt(4)
    v_mfma_f32_16x16x32_bf16 v[148:151], v[176:179], v[68:71], v[148:151]
    s_add_u32 s10, s17, 14871552
    ds_read_b128 v[176:179], v11 offset:59392
    v_mfma_f32_16x16x32_bf16 v[152:155], v[180:183], v[64:67], v[152:155]
    buffer_load_dwordx4 v[44:47], v10, s[28:31], s10 offen sc1
    s_waitcnt lgkmcnt(4)
    v_mfma_f32_16x16x32_bf16 v[156:159], v[180:183], v[68:71], v[156:159]
    ds_read_b128 v[180:183], v11 offset:60416
    v_mfma_f32_16x16x32_bf16 v[112:115], v[160:163], v[72:75], v[112:115]
    s_waitcnt lgkmcnt(4)
    v_mfma_f32_16x16x32_bf16 v[116:119], v[160:163], v[76:79], v[116:119]
    v_lshlrev_b32 v255, 4, v3
    v_add_u32 v255, 122880, v255
    ds_read_b128 v[160:163], v255 offset:0
    v_mfma_f32_16x16x32_bf16 v[120:123], v[164:167], v[72:75], v[120:123]
    s_waitcnt lgkmcnt(4)
    v_mfma_f32_16x16x32_bf16 v[124:127], v[164:167], v[76:79], v[124:127]
    ds_read_b128 v[164:167], v255 offset:64
    v_mfma_f32_16x16x32_bf16 v[128:131], v[168:171], v[72:75], v[128:131]
    s_waitcnt lgkmcnt(4)
    v_mfma_f32_16x16x32_bf16 v[132:135], v[168:171], v[76:79], v[132:135]
    ds_read_b128 v[168:171], v255 offset:128
    v_mfma_f32_16x16x32_bf16 v[136:139], v[172:175], v[72:75], v[136:139]
    s_waitcnt lgkmcnt(4)
    v_mfma_f32_16x16x32_bf16 v[140:143], v[172:175], v[76:79], v[140:143]
    ds_read_b128 v[172:175], v255 offset:192
    v_mfma_f32_16x16x32_bf16 v[144:147], v[176:179], v[72:75], v[144:147]
    s_waitcnt lgkmcnt(4)
    v_mfma_f32_16x16x32_bf16 v[148:151], v[176:179], v[76:79], v[148:151]
    ds_read_b128 v[176:179], v255 offset:256
    v_mfma_f32_16x16x32_bf16 v[152:155], v[180:183], v[72:75], v[152:155]
    v_mfma_f32_16x16x32_bf16 v[156:159], v[180:183], v[76:79], v[156:159]
    ds_read_b128 v[180:183], v255 offset:320
    s_add_u32 s12, s56, 14680064
    v_mul_f32 v212, 0xbfb8aa3b, v5
    v_mul_f32 v213, v5, v5
    v_rcp_f32 v213, v213
    s_waitcnt lgkmcnt(5)
    v_pk_fma_f32 v[112:113], v[160:161], v[4:5], v[112:113] op_sel:[0,0,0] op_sel_hi:[1,0,1]
    v_pk_fma_f32 v[114:115], v[162:163], v[4:5], v[114:115] op_sel:[0,0,0] op_sel_hi:[1,0,1]
    s_waitcnt lgkmcnt(4)
    v_pk_fma_f32 v[120:121], v[164:165], v[4:5], v[120:121] op_sel:[0,0,0] op_sel_hi:[1,0,1]
    v_pk_fma_f32 v[122:123], v[166:167], v[4:5], v[122:123] op_sel:[0,0,0] op_sel_hi:[1,0,1]
    s_waitcnt lgkmcnt(3)
    v_pk_fma_f32 v[128:129], v[168:169], v[4:5], v[128:129] op_sel:[0,0,0] op_sel_hi:[1,0,1]
    v_pk_fma_f32 v[130:131], v[170:171], v[4:5], v[130:131] op_sel:[0,0,0] op_sel_hi:[1,0,1]
    s_waitcnt lgkmcnt(2)
    v_pk_fma_f32 v[136:137], v[172:173], v[4:5], v[136:137] op_sel:[0,0,0] op_sel_hi:[1,0,1]
    v_pk_fma_f32 v[138:139], v[174:175], v[4:5], v[138:139] op_sel:[0,0,0] op_sel_hi:[1,0,1]
    s_waitcnt lgkmcnt(1)
    v_pk_fma_f32 v[144:145], v[176:177], v[4:5], v[144:145] op_sel:[0,0,0] op_sel_hi:[1,0,1]
    v_pk_fma_f32 v[146:147], v[178:179], v[4:5], v[146:147] op_sel:[0,0,0] op_sel_hi:[1,0,1]
    s_waitcnt lgkmcnt(0)
    v_pk_fma_f32 v[152:153], v[180:181], v[4:5], v[152:153] op_sel:[0,0,0] op_sel_hi:[1,0,1]
    v_pk_fma_f32 v[154:155], v[182:183], v[4:5], v[154:155] op_sel:[0,0,0] op_sel_hi:[1,0,1]
    v_pk_mul_f32 v[184:185], v[112:113], v[212:213] op_sel:[0,0] op_sel_hi:[1,0]
    v_pk_mul_f32 v[186:187], v[114:115], v[212:213] op_sel:[0,0] op_sel_hi:[1,0]
    v_pk_mul_f32 v[188:189], v[120:121], v[212:213] op_sel:[0,0] op_sel_hi:[1,0]
    v_pk_mul_f32 v[190:191], v[122:123], v[212:213] op_sel:[0,0] op_sel_hi:[1,0]
    v_pk_mul_f32 v[192:193], v[128:129], v[212:213] op_sel:[0,0] op_sel_hi:[1,0]
    v_pk_mul_f32 v[194:195], v[130:131], v[212:213] op_sel:[0,0] op_sel_hi:[1,0]
    v_exp_f32 v184, v184
    v_exp_f32 v185, v185
    v_exp_f32 v186, v186
    v_exp_f32 v187, v187
    v_exp_f32 v188, v188
    v_exp_f32 v189, v189
    v_exp_f32 v190, v190
    v_exp_f32 v191, v191
    v_exp_f32 v192, v192
    v_exp_f32 v193, v193
    v_exp_f32 v194, v194
    v_exp_f32 v195, v195
    v_pk_mul_f32 v[112:113], v[112:113], v[136:137]
    v_pk_mul_f32 v[114:115], v[114:115], v[138:139]
    v_pk_mul_f32 v[120:121], v[120:121], v[144:145]
    v_pk_mul_f32 v[122:123], v[122:123], v[146:147]
    v_pk_mul_f32 v[128:129], v[128:129], v[152:153]
    v_pk_mul_f32 v[130:131], v[130:131], v[154:155]
    v_pk_fma_f32 v[184:185], v[184:185], v[212:213], v[212:213] op_sel:[0,1,1] op_sel_hi:[1,1,1]
    v_pk_fma_f32 v[186:187], v[186:187], v[212:213], v[212:213] op_sel:[0,1,1] op_sel_hi:[1,1,1]
    v_pk_fma_f32 v[188:189], v[188:189], v[212:213], v[212:213] op_sel:[0,1,1] op_sel_hi:[1,1,1]
    v_pk_fma_f32 v[190:191], v[190:191], v[212:213], v[212:213] op_sel:[0,1,1] op_sel_hi:[1,1,1]
    v_pk_fma_f32 v[192:193], v[192:193], v[212:213], v[212:213] op_sel:[0,1,1] op_sel_hi:[1,1,1]
    v_pk_fma_f32 v[194:195], v[194:195], v[212:213], v[212:213] op_sel:[0,1,1] op_sel_hi:[1,1,1]
    v_rcp_f32 v184, v184
    v_rcp_f32 v185, v185
    v_rcp_f32 v186, v186
    v_rcp_f32 v187, v187
    v_rcp_f32 v188, v188
    v_rcp_f32 v189, v189
    v_rcp_f32 v190, v190
    v_rcp_f32 v191, v191
    v_rcp_f32 v192, v192
    v_rcp_f32 v193, v193
    v_rcp_f32 v194, v194
    v_rcp_f32 v195, v195
    v_pk_mul_f32 v[184:185], v[184:185], v[112:113]
    v_pk_mul_f32 v[186:187], v[186:187], v[114:115]
    v_pk_mul_f32 v[188:189], v[188:189], v[120:121]
    v_pk_mul_f32 v[190:191], v[190:191], v[122:123]
    v_pk_mul_f32 v[192:193], v[192:193], v[128:129]
    v_pk_mul_f32 v[194:195], v[194:195], v[130:131]
    v_cvt_pk_bf16_f32 v196, v184, v185
    v_cvt_pk_bf16_f32 v197, v186, v187
    v_cvt_pk_bf16_f32 v198, v188, v189
    v_cvt_pk_bf16_f32 v199, v190, v191
    v_cvt_pk_bf16_f32 v204, v192, v193
    v_cvt_pk_bf16_f32 v205, v194, v195
    buffer_store_dwordx4 v[196:199], v10, s[36:39], s12 offen sc1
    v_mul_f32 v212, 0xbfb8aa3b, v7
    v_mul_f32 v213, v7, v7
    v_rcp_f32 v213, v213
    v_pk_fma_f32 v[116:117], v[160:161], v[6:7], v[116:117] op_sel:[0,0,0] op_sel_hi:[1,0,1]
    v_pk_fma_f32 v[118:119], v[162:163], v[6:7], v[118:119] op_sel:[0,0,0] op_sel_hi:[1,0,1]
    v_pk_fma_f32 v[124:125], v[164:165], v[6:7], v[124:125] op_sel:[0,0,0] op_sel_hi:[1,0,1]
    v_pk_fma_f32 v[126:127], v[166:167], v[6:7], v[126:127] op_sel:[0,0,0] op_sel_hi:[1,0,1]
    v_pk_fma_f32 v[132:133], v[168:169], v[6:7], v[132:133] op_sel:[0,0,0] op_sel_hi:[1,0,1]
    v_pk_fma_f32 v[134:135], v[170:171], v[6:7], v[134:135] op_sel:[0,0,0] op_sel_hi:[1,0,1]
    v_pk_fma_f32 v[140:141], v[172:173], v[6:7], v[140:141] op_sel:[0,0,0] op_sel_hi:[1,0,1]
    v_pk_fma_f32 v[142:143], v[174:175], v[6:7], v[142:143] op_sel:[0,0,0] op_sel_hi:[1,0,1]
    v_pk_fma_f32 v[148:149], v[176:177], v[6:7], v[148:149] op_sel:[0,0,0] op_sel_hi:[1,0,1]
    v_pk_fma_f32 v[150:151], v[178:179], v[6:7], v[150:151] op_sel:[0,0,0] op_sel_hi:[1,0,1]
    v_pk_fma_f32 v[156:157], v[180:181], v[6:7], v[156:157] op_sel:[0,0,0] op_sel_hi:[1,0,1]
    v_pk_fma_f32 v[158:159], v[182:183], v[6:7], v[158:159] op_sel:[0,0,0] op_sel_hi:[1,0,1]
    v_pk_mul_f32 v[184:185], v[116:117], v[212:213] op_sel:[0,0] op_sel_hi:[1,0]
    v_pk_mul_f32 v[186:187], v[118:119], v[212:213] op_sel:[0,0] op_sel_hi:[1,0]
    v_pk_mul_f32 v[188:189], v[124:125], v[212:213] op_sel:[0,0] op_sel_hi:[1,0]
    v_pk_mul_f32 v[190:191], v[126:127], v[212:213] op_sel:[0,0] op_sel_hi:[1,0]
    v_pk_mul_f32 v[192:193], v[132:133], v[212:213] op_sel:[0,0] op_sel_hi:[1,0]
    v_pk_mul_f32 v[194:195], v[134:135], v[212:213] op_sel:[0,0] op_sel_hi:[1,0]
    v_exp_f32 v184, v184
    v_exp_f32 v185, v185
    v_exp_f32 v186, v186
    v_exp_f32 v187, v187
    v_exp_f32 v188, v188
    v_exp_f32 v189, v189
    v_exp_f32 v190, v190
    v_exp_f32 v191, v191
    v_exp_f32 v192, v192
    v_exp_f32 v193, v193
    v_exp_f32 v194, v194
    v_exp_f32 v195, v195
    v_pk_mul_f32 v[116:117], v[116:117], v[140:141]
    v_pk_mul_f32 v[118:119], v[118:119], v[142:143]
    v_pk_mul_f32 v[124:125], v[124:125], v[148:149]
    v_pk_mul_f32 v[126:127], v[126:127], v[150:151]
    v_pk_mul_f32 v[132:133], v[132:133], v[156:157]
    v_pk_mul_f32 v[134:135], v[134:135], v[158:159]
    v_pk_fma_f32 v[184:185], v[184:185], v[212:213], v[212:213] op_sel:[0,1,1] op_sel_hi:[1,1,1]
    v_pk_fma_f32 v[186:187], v[186:187], v[212:213], v[212:213] op_sel:[0,1,1] op_sel_hi:[1,1,1]
    v_pk_fma_f32 v[188:189], v[188:189], v[212:213], v[212:213] op_sel:[0,1,1] op_sel_hi:[1,1,1]
    v_pk_fma_f32 v[190:191], v[190:191], v[212:213], v[212:213] op_sel:[0,1,1] op_sel_hi:[1,1,1]
    v_pk_fma_f32 v[192:193], v[192:193], v[212:213], v[212:213] op_sel:[0,1,1] op_sel_hi:[1,1,1]
    v_pk_fma_f32 v[194:195], v[194:195], v[212:213], v[212:213] op_sel:[0,1,1] op_sel_hi:[1,1,1]
    v_rcp_f32 v184, v184
    v_rcp_f32 v185, v185
    v_rcp_f32 v186, v186
    v_rcp_f32 v187, v187
    v_rcp_f32 v188, v188
    v_rcp_f32 v189, v189
    v_rcp_f32 v190, v190
    v_rcp_f32 v191, v191
    v_rcp_f32 v192, v192
    v_rcp_f32 v193, v193
    v_rcp_f32 v194, v194
    v_rcp_f32 v195, v195
    v_pk_mul_f32 v[184:185], v[184:185], v[116:117]
    v_pk_mul_f32 v[186:187], v[186:187], v[118:119]
    v_pk_mul_f32 v[188:189], v[188:189], v[124:125]
    v_pk_mul_f32 v[190:191], v[190:191], v[126:127]
    v_pk_mul_f32 v[192:193], v[192:193], v[132:133]
    v_pk_mul_f32 v[194:195], v[194:195], v[134:135]
    v_cvt_pk_bf16_f32 v200, v184, v185
    v_cvt_pk_bf16_f32 v201, v186, v187
    v_cvt_pk_bf16_f32 v202, v188, v189
    v_cvt_pk_bf16_f32 v203, v190, v191
    v_cvt_pk_bf16_f32 v206, v192, v193
    v_cvt_pk_bf16_f32 v207, v194, v195
    s_add_u32 s13, s12, 49152
    buffer_store_dwordx4 v[200:203], v10, s[36:39], s13 offen sc1
    v_permlane16_swap_b32 v204, v206
    v_permlane16_swap_b32 v205, v207
    buffer_store_dwordx4 v[204:207], v8, s[36:39], s12 offen offset:1024 sc1
    ds_read_b128 v[160:163], v10 offset:0
    ds_read_b128 v[164:167], v10 offset:1024
    ds_read_b128 v[168:171], v10 offset:2048
    ds_read_b128 v[172:175], v10 offset:3072
    ds_read_b128 v[176:179], v10 offset:4096
    ds_read_b128 v[180:183], v10 offset:5120
    s_waitcnt vmcnt(18) lgkmcnt(5)
    v_mfma_f32_16x16x32_bf16 v[112:115], v[160:163], v[80:83], 0
    s_waitcnt lgkmcnt(4)
    s_waitcnt vmcnt(17)
    v_mfma_f32_16x16x32_bf16 v[116:119], v[160:163], v[84:87], 0
    s_add_u32 s10, s17, 14852096
    ds_read_b128 v[160:163], v10 offset:6144
    v_mfma_f32_16x16x32_bf16 v[120:123], v[164:167], v[80:83], 0
    buffer_load_dwordx4 v[48:51], v10, s[28:31], s10 offen sc1
    s_waitcnt lgkmcnt(4)
    v_mfma_f32_16x16x32_bf16 v[124:127], v[164:167], v[84:87], 0
    ds_read_b128 v[164:167], v10 offset:7168
    v_mfma_f32_16x16x32_bf16 v[128:131], v[168:171], v[80:83], 0
    s_waitcnt lgkmcnt(4)
    v_mfma_f32_16x16x32_bf16 v[132:135], v[168:171], v[84:87], 0
    ds_read_b128 v[168:171], v10 offset:8192
    v_mfma_f32_16x16x32_bf16 v[136:139], v[172:175], v[80:83], 0
    s_waitcnt lgkmcnt(4)
    v_mfma_f32_16x16x32_bf16 v[140:143], v[172:175], v[84:87], 0
    s_add_u32 s10, s17, 14872576
    ds_read_b128 v[172:175], v10 offset:9216
    v_mfma_f32_16x16x32_bf16 v[144:147], v[176:179], v[80:83], 0
    buffer_load_dwordx4 v[52:55], v10, s[28:31], s10 offen sc1
    s_waitcnt lgkmcnt(4)
    v_mfma_f32_16x16x32_bf16 v[148:151], v[176:179], v[84:87], 0
    ds_read_b128 v[176:179], v10 offset:10240
    v_mfma_f32_16x16x32_bf16 v[152:155], v[180:183], v[80:83], 0
    s_waitcnt vmcnt(17) lgkmcnt(4)
    v_mfma_f32_16x16x32_bf16 v[156:159], v[180:183], v[84:87], 0
    ds_read_b128 v[180:183], v10 offset:11264
    v_mfma_f32_16x16x32_bf16 v[112:115], v[160:163], v[88:91], v[112:115]
    s_waitcnt lgkmcnt(4)
    v_mfma_f32_16x16x32_bf16 v[116:119], v[160:163], v[92:95], v[116:119]
    s_add_u32 s10, s17, 14853120
    ds_read_b128 v[160:163], v10 offset:12288
    v_mfma_f32_16x16x32_bf16 v[120:123], v[164:167], v[88:91], v[120:123]
    buffer_load_dwordx4 v[56:59], v10, s[28:31], s10 offen sc1
    s_waitcnt lgkmcnt(4)
    v_mfma_f32_16x16x32_bf16 v[124:127], v[164:167], v[92:95], v[124:127]
    ds_read_b128 v[164:167], v10 offset:13312
    v_mfma_f32_16x16x32_bf16 v[128:131], v[168:171], v[88:91], v[128:131]
    s_waitcnt lgkmcnt(4)
    v_mfma_f32_16x16x32_bf16 v[132:135], v[168:171], v[92:95], v[132:135]
    ds_read_b128 v[168:171], v10 offset:14336
    v_mfma_f32_16x16x32_bf16 v[136:139], v[172:175], v[88:91], v[136:139]
    s_waitcnt lgkmcnt(4)
    v_mfma_f32_16x16x32_bf16 v[140:143], v[172:175], v[92:95], v[140:143]
    s_add_u32 s10, s17, 14873600
    ds_read_b128 v[172:175], v10 offset:15360
    v_mfma_f32_16x16x32_bf16 v[144:147], v[176:179], v[88:91], v[144:147]
    buffer_load_dwordx4 v[60:63], v10, s[28:31], s10 offen sc1
    s_waitcnt lgkmcnt(4)
    v_mfma_f32_16x16x32_bf16 v[148:151], v[176:179], v[92:95], v[148:151]
    ds_read_b128 v[176:179], v10 offset:16384
    v_mfma_f32_16x16x32_bf16 v[152:155], v[180:183], v[88:91], v[152:155]
    s_waitcnt vmcnt(17) lgkmcnt(4)
    v_mfma_f32_16x16x32_bf16 v[156:159], v[180:183], v[92:95], v[156:159]
    ds_read_b128 v[180:183], v10 offset:17408
    v_mfma_f32_16x16x32_bf16 v[112:115], v[160:163], v[96:99], v[112:115]
    s_waitcnt lgkmcnt(4)
    v_mfma_f32_16x16x32_bf16 v[116:119], v[160:163], v[100:103], v[116:119]
    s_add_u32 s10, s17, 14854144
    ds_read_b128 v[160:163], v10 offset:18432
    v_mfma_f32_16x16x32_bf16 v[120:123], v[164:167], v[96:99], v[120:123]
    buffer_load_dwordx4 v[64:67], v10, s[28:31], s10 offen sc1
    s_waitcnt lgkmcnt(4)
    v_mfma_f32_16x16x32_bf16 v[124:127], v[164:167], v[100:103], v[124:127]
    ds_read_b128 v[164:167], v10 offset:19456
    v_mfma_f32_16x16x32_bf16 v[128:131], v[168:171], v[96:99], v[128:131]
    s_waitcnt lgkmcnt(4)
    v_mfma_f32_16x16x32_bf16 v[132:135], v[168:171], v[100:103], v[132:135]
    ds_read_b128 v[168:171], v10 offset:20480
    v_mfma_f32_16x16x32_bf16 v[136:139], v[172:175], v[96:99], v[136:139]
    s_waitcnt lgkmcnt(4)
    v_mfma_f32_16x16x32_bf16 v[140:143], v[172:175], v[100:103], v[140:143]
    s_add_u32 s10, s17, 14874624
    ds_read_b128 v[172:175], v10 offset:21504
    v_mfma_f32_16x16x32_bf16 v[144:147], v[176:179], v[96:99], v[144:147]
    buffer_load_dwordx4 v[68:71], v10, s[28:31], s10 offen sc1
    s_waitcnt lgkmcnt(4)
    v_mfma_f32_16x16x32_bf16 v[148:151], v[176:179], v[100:103], v[148:151]
    ds_read_b128 v[176:179], v10 offset:22528
    v_mfma_f32_16x16x32_bf16 v[152:155], v[180:183], v[96:99], v[152:155]
    s_waitcnt vmcnt(17) lgkmcnt(4)
    v_mfma_f32_16x16x32_bf16 v[156:159], v[180:183], v[100:103], v[156:159]
    ds_read_b128 v[180:183], v10 offset:23552
    v_mfma_f32_16x16x32_bf16 v[112:115], v[160:163], v[104:107], v[112:115]
    s_waitcnt lgkmcnt(4)
    v_mfma_f32_16x16x32_bf16 v[116:119], v[160:163], v[108:111], v[116:119]
    s_add_u32 s10, s17, 14855168
    ds_read_b128 v[160:163], v10 offset:24576
    v_mfma_f32_16x16x32_bf16 v[120:123], v[164:167], v[104:107], v[120:123]
    buffer_load_dwordx4 v[72:75], v10, s[28:31], s10 offen sc1
    s_waitcnt lgkmcnt(4)
    v_mfma_f32_16x16x32_bf16 v[124:127], v[164:167], v[108:111], v[124:127]
    ds_read_b128 v[164:167], v10 offset:25600
    v_mfma_f32_16x16x32_bf16 v[128:131], v[168:171], v[104:107], v[128:131]
    s_waitcnt lgkmcnt(4)
    v_mfma_f32_16x16x32_bf16 v[132:135], v[168:171], v[108:111], v[132:135]
    ds_read_b128 v[168:171], v10 offset:26624
    v_mfma_f32_16x16x32_bf16 v[136:139], v[172:175], v[104:107], v[136:139]
    s_waitcnt lgkmcnt(4)
    v_mfma_f32_16x16x32_bf16 v[140:143], v[172:175], v[108:111], v[140:143]
    s_add_u32 s10, s17, 14875648
    ds_read_b128 v[172:175], v10 offset:27648
    v_mfma_f32_16x16x32_bf16 v[144:147], v[176:179], v[104:107], v[144:147]
    buffer_load_dwordx4 v[76:79], v10, s[28:31], s10 offen sc1
    s_waitcnt lgkmcnt(4)
    v_mfma_f32_16x16x32_bf16 v[148:151], v[176:179], v[108:111], v[148:151]
    ds_read_b128 v[176:179], v10 offset:28672
    v_mfma_f32_16x16x32_bf16 v[152:155], v[180:183], v[104:107], v[152:155]
    s_waitcnt vmcnt(17) lgkmcnt(4)
    v_mfma_f32_16x16x32_bf16 v[156:159], v[180:183], v[108:111], v[156:159]
    ds_read_b128 v[180:183], v10 offset:29696
    s_lshl_b32 s12, s4, 3
    s_add_u32 s12, s12, s3
    s_lshl_b32 s12, s12, 5
    s_add_u32 s12, s12, s5
    s_lshl_b32 s12, s12, 7
    s_add_u32 s12, s12, 851968
    v_mov_b32 v254, s100
    v_mov_b32 v255, s101
    s_waitcnt vmcnt(8)
    buffer_store_dwordx2 v[254:255], v252, s[44:47], s12 offen sc1
    v_mfma_f32_16x16x32_bf16 v[112:115], v[160:163], v[16:19], v[112:115]
    s_waitcnt lgkmcnt(4)
    v_mfma_f32_16x16x32_bf16 v[116:119], v[160:163], v[20:23], v[116:119]
    s_add_u32 s10, s17, 14856192
    ds_read_b128 v[160:163], v10 offset:30720
    v_mfma_f32_16x16x32_bf16 v[120:123], v[164:167], v[16:19], v[120:123]
    buffer_load_dwordx4 v[80:83], v10, s[28:31], s10 offen sc1
    s_waitcnt lgkmcnt(4)
    v_mfma_f32_16x16x32_bf16 v[124:127], v[164:167], v[20:23], v[124:127]
    ds_read_b128 v[164:167], v10 offset:31744
    v_mfma_f32_16x16x32_bf16 v[128:131], v[168:171], v[16:19], v[128:131]
    s_waitcnt lgkmcnt(4)
    v_mfma_f32_16x16x32_bf16 v[132:135], v[168:171], v[20:23], v[132:135]
    ds_read_b128 v[168:171], v10 offset:32768
    v_mfma_f32_16x16x32_bf16 v[136:139], v[172:175], v[16:19], v[136:139]
    s_waitcnt lgkmcnt(4)
    v_mfma_f32_16x16x32_bf16 v[140:143], v[172:175], v[20:23], v[140:143]
    s_add_u32 s10, s17, 14876672
    ds_read_b128 v[172:175], v10 offset:33792
    v_mfma_f32_16x16x32_bf16 v[144:147], v[176:179], v[16:19], v[144:147]
    buffer_load_dwordx4 v[84:87], v10, s[28:31], s10 offen sc1
    s_waitcnt lgkmcnt(4)
    v_mfma_f32_16x16x32_bf16 v[148:151], v[176:179], v[20:23], v[148:151]
    ds_read_b128 v[176:179], v10 offset:34816
    v_mfma_f32_16x16x32_bf16 v[152:155], v[180:183], v[16:19], v[152:155]
    s_waitcnt lgkmcnt(4)
    v_mfma_f32_16x16x32_bf16 v[156:159], v[180:183], v[20:23], v[156:159]
    ds_read_b128 v[180:183], v10 offset:35840
    v_mfma_f32_16x16x32_bf16 v[112:115], v[160:163], v[24:27], v[112:115]
    s_waitcnt lgkmcnt(4)
    v_mfma_f32_16x16x32_bf16 v[116:119], v[160:163], v[28:31], v[116:119]
    s_add_u32 s10, s17, 14857216
    ds_read_b128 v[160:163], v10 offset:36864
    v_mfma_f32_16x16x32_bf16 v[120:123], v[164:167], v[24:27], v[120:123]
    buffer_load_dwordx4 v[88:91], v10, s[28:31], s10 offen sc1
    s_waitcnt lgkmcnt(4)
    v_mfma_f32_16x16x32_bf16 v[124:127], v[164:167], v[28:31], v[124:127]
    ds_read_b128 v[164:167], v10 offset:37888
    v_mfma_f32_16x16x32_bf16 v[128:131], v[168:171], v[24:27], v[128:131]
    s_waitcnt lgkmcnt(4)
    v_mfma_f32_16x16x32_bf16 v[132:135], v[168:171], v[28:31], v[132:135]
    ds_read_b128 v[168:171], v10 offset:38912
    v_mfma_f32_16x16x32_bf16 v[136:139], v[172:175], v[24:27], v[136:139]
    s_waitcnt lgkmcnt(4)
    v_mfma_f32_16x16x32_bf16 v[140:143], v[172:175], v[28:31], v[140:143]
    s_add_u32 s10, s17, 14877696
    ds_read_b128 v[172:175], v10 offset:39936
    v_mfma_f32_16x16x32_bf16 v[144:147], v[176:179], v[24:27], v[144:147]
    buffer_load_dwordx4 v[92:95], v10, s[28:31], s10 offen sc1
    s_waitcnt lgkmcnt(4)
    v_mfma_f32_16x16x32_bf16 v[148:151], v[176:179], v[28:31], v[148:151]
    ds_read_b128 v[176:179], v10 offset:40960
    v_mfma_f32_16x16x32_bf16 v[152:155], v[180:183], v[24:27], v[152:155]
    s_waitcnt lgkmcnt(4)
    v_mfma_f32_16x16x32_bf16 v[156:159], v[180:183], v[28:31], v[156:159]
    ds_read_b128 v[180:183], v10 offset:41984
    v_mfma_f32_16x16x32_bf16 v[112:115], v[160:163], v[32:35], v[112:115]
    s_waitcnt lgkmcnt(4)
    v_mfma_f32_16x16x32_bf16 v[116:119], v[160:163], v[36:39], v[116:119]
    s_add_u32 s10, s17, 14858240
    ds_read_b128 v[160:163], v10 offset:43008
    v_mfma_f32_16x16x32_bf16 v[120:123], v[164:167], v[32:35], v[120:123]
    buffer_load_dwordx4 v[96:99], v10, s[28:31], s10 offen sc1
    s_waitcnt lgkmcnt(4)
    v_mfma_f32_16x16x32_bf16 v[124:127], v[164:167], v[36:39], v[124:127]
    ds_read_b128 v[164:167], v10 offset:44032
    v_mfma_f32_16x16x32_bf16 v[128:131], v[168:171], v[32:35], v[128:131]
    s_waitcnt lgkmcnt(4)
    v_mfma_f32_16x16x32_bf16 v[132:135], v[168:171], v[36:39], v[132:135]
    ds_read_b128 v[168:171], v10 offset:45056
    v_mfma_f32_16x16x32_bf16 v[136:139], v[172:175], v[32:35], v[136:139]
    s_waitcnt lgkmcnt(4)
    v_mfma_f32_16x16x32_bf16 v[140:143], v[172:175], v[36:39], v[140:143]
    s_add_u32 s10, s17, 14878720
    ds_read_b128 v[172:175], v10 offset:46080
    v_mfma_f32_16x16x32_bf16 v[144:147], v[176:179], v[32:35], v[144:147]
    buffer_load_dwordx4 v[100:103], v10, s[28:31], s10 offen sc1
    s_waitcnt lgkmcnt(4)
    v_mfma_f32_16x16x32_bf16 v[148:151], v[176:179], v[36:39], v[148:151]
    ds_read_b128 v[176:179], v10 offset:47104
    v_mfma_f32_16x16x32_bf16 v[152:155], v[180:183], v[32:35], v[152:155]
    s_waitcnt lgkmcnt(4)
    v_mfma_f32_16x16x32_bf16 v[156:159], v[180:183], v[36:39], v[156:159]
    ds_read_b128 v[180:183], v10 offset:48128
    v_mfma_f32_16x16x32_bf16 v[112:115], v[160:163], v[40:43], v[112:115]
    s_add_u32 s10, s17, 14859264
    buffer_load_dwordx4 v[104:107], v10, s[28:31], s10 offen sc1
    s_waitcnt lgkmcnt(4)
    v_mfma_f32_16x16x32_bf16 v[116:119], v[160:163], v[44:47], v[116:119]
    ds_read_b128 v[160:163], v10 offset:49152
    v_mfma_f32_16x16x32_bf16 v[120:123], v[164:167], v[40:43], v[120:123]
    s_waitcnt lgkmcnt(4)
    v_mfma_f32_16x16x32_bf16 v[124:127], v[164:167], v[44:47], v[124:127]
    s_add_u32 s10, s17, 14879744
    ds_read_b128 v[164:167], v10 offset:50176
    v_mfma_f32_16x16x32_bf16 v[128:131], v[168:171], v[40:43], v[128:131]
    buffer_load_dwordx4 v[108:111], v10, s[28:31], s10 offen sc1
    s_waitcnt lgkmcnt(4)
    v_mfma_f32_16x16x32_bf16 v[132:135], v[168:171], v[44:47], v[132:135]
    ds_read_b128 v[168:171], v10 offset:51200
    v_mfma_f32_16x16x32_bf16 v[136:139], v[172:175], v[40:43], v[136:139]
    s_waitcnt lgkmcnt(4)
    v_mfma_f32_16x16x32_bf16 v[140:143], v[172:175], v[44:47], v[140:143]
    ds_read_b128 v[172:175], v10 offset:52224
    v_mfma_f32_16x16x32_bf16 v[144:147], v[176:179], v[40:43], v[144:147]
    s_mov_b32 s13, 851968
    s_mov_b32 exec_lo, 0xff
    s_mov_b32 exec_hi, 0
    buffer_load_dwordx2 v[214:215], v253, s[44:47], s13 offen sc1
    s_mov_b64 exec, -1
    s_waitcnt lgkmcnt(4)
    v_mfma_f32_16x16x32_bf16 v[148:151], v[176:179], v[44:47], v[148:151]
    ds_read_b128 v[176:179], v10 offset:53248
    v_mfma_f32_16x16x32_bf16 v[152:155], v[180:183], v[40:43], v[152:155]
    s_waitcnt vmcnt(16) lgkmcnt(4)
    v_mfma_f32_16x16x32_bf16 v[156:159], v[180:183], v[44:47], v[156:159]
    ds_read_b128 v[180:183], v10 offset:54272
    v_mfma_f32_16x16x32_bf16 v[112:115], v[160:163], v[48:51], v[112:115]
    s_waitcnt lgkmcnt(4)
    v_mfma_f32_16x16x32_bf16 v[116:119], v[160:163], v[52:55], v[116:119]
    s_add_u32 s10, s17, 14860288
    ds_read_b128 v[160:163], v10 offset:55296
    v_mfma_f32_16x16x32_bf16 v[120:123], v[164:167], v[48:51], v[120:123]
    buffer_load_dwordx4 v[16:19], v10, s[28:31], s10 offen sc1
    s_waitcnt lgkmcnt(4)
    v_mfma_f32_16x16x32_bf16 v[124:127], v[164:167], v[52:55], v[124:127]
    ds_read_b128 v[164:167], v10 offset:56320
    v_mfma_f32_16x16x32_bf16 v[128:131], v[168:171], v[48:51], v[128:131]
    s_waitcnt lgkmcnt(4)
    v_mfma_f32_16x16x32_bf16 v[132:135], v[168:171], v[52:55], v[132:135]
    ds_read_b128 v[168:171], v10 offset:57344
    v_mfma_f32_16x16x32_bf16 v[136:139], v[172:175], v[48:51], v[136:139]
    s_waitcnt lgkmcnt(4)
    v_mfma_f32_16x16x32_bf16 v[140:143], v[172:175], v[52:55], v[140:143]
    s_add_u32 s10, s17, 14880768
    ds_read_b128 v[172:175], v10 offset:58368
    v_mfma_f32_16x16x32_bf16 v[144:147], v[176:179], v[48:51], v[144:147]
    buffer_load_dwordx4 v[20:23], v10, s[28:31], s10 offen sc1
    s_waitcnt lgkmcnt(4)
    v_mfma_f32_16x16x32_bf16 v[148:151], v[176:179], v[52:55], v[148:151]
    ds_read_b128 v[176:179], v10 offset:59392
    v_mfma_f32_16x16x32_bf16 v[152:155], v[180:183], v[48:51], v[152:155]
    s_waitcnt vmcnt(16) lgkmcnt(4)
    v_mfma_f32_16x16x32_bf16 v[156:159], v[180:183], v[52:55], v[156:159]
    ds_read_b128 v[180:183], v10 offset:60416
    v_mfma_f32_16x16x32_bf16 v[112:115], v[160:163], v[56:59], v[112:115]
    s_waitcnt lgkmcnt(4)
    v_mfma_f32_16x16x32_bf16 v[116:119], v[160:163], v[60:63], v[116:119]
    s_add_u32 s10, s17, 14861312
    ds_read_b128 v[160:163], v11 offset:0
    v_mfma_f32_16x16x32_bf16 v[120:123], v[164:167], v[56:59], v[120:123]
    buffer_load_dwordx4 v[24:27], v10, s[28:31], s10 offen sc1
    s_waitcnt lgkmcnt(4)
    v_mfma_f32_16x16x32_bf16 v[124:127], v[164:167], v[60:63], v[124:127]
    ds_read_b128 v[164:167], v11 offset:1024
    v_mfma_f32_16x16x32_bf16 v[128:131], v[168:171], v[56:59], v[128:131]
    s_waitcnt lgkmcnt(4)
    v_mfma_f32_16x16x32_bf16 v[132:135], v[168:171], v[60:63], v[132:135]
    ds_read_b128 v[168:171], v11 offset:2048
    v_mfma_f32_16x16x32_bf16 v[136:139], v[172:175], v[56:59], v[136:139]
    s_waitcnt lgkmcnt(4)
    v_mfma_f32_16x16x32_bf16 v[140:143], v[172:175], v[60:63], v[140:143]
    s_add_u32 s10, s17, 14881792
    ds_read_b128 v[172:175], v11 offset:3072
    v_mfma_f32_16x16x32_bf16 v[144:147], v[176:179], v[56:59], v[144:147]
    buffer_load_dwordx4 v[28:31], v10, s[28:31], s10 offen sc1
    s_waitcnt lgkmcnt(4)
    v_mfma_f32_16x16x32_bf16 v[148:151], v[176:179], v[60:63], v[148:151]
    ds_read_b128 v[176:179], v11 offset:4096
    v_mfma_f32_16x16x32_bf16 v[152:155], v[180:183], v[56:59], v[152:155]
    s_waitcnt vmcnt(16) lgkmcnt(4)
    v_mfma_f32_16x16x32_bf16 v[156:159], v[180:183], v[60:63], v[156:159]
    ds_read_b128 v[180:183], v11 offset:5120
    v_mfma_f32_16x16x32_bf16 v[112:115], v[160:163], v[64:67], v[112:115]
    s_waitcnt lgkmcnt(4)
    v_mfma_f32_16x16x32_bf16 v[116:119], v[160:163], v[68:71], v[116:119]
    s_add_u32 s10, s17, 14862336
    ds_read_b128 v[160:163], v11 offset:6144
    v_mfma_f32_16x16x32_bf16 v[120:123], v[164:167], v[64:67], v[120:123]
    buffer_load_dwordx4 v[32:35], v10, s[28:31], s10 offen sc1
    s_waitcnt lgkmcnt(4)
    v_mfma_f32_16x16x32_bf16 v[124:127], v[164:167], v[68:71], v[124:127]
    ds_read_b128 v[164:167], v11 offset:7168
    v_mfma_f32_16x16x32_bf16 v[128:131], v[168:171], v[64:67], v[128:131]
    s_waitcnt lgkmcnt(4)
    v_mfma_f32_16x16x32_bf16 v[132:135], v[168:171], v[68:71], v[132:135]
    ds_read_b128 v[168:171], v11 offset:8192
    v_mfma_f32_16x16x32_bf16 v[136:139], v[172:175], v[64:67], v[136:139]
    s_waitcnt lgkmcnt(4)
    v_mfma_f32_16x16x32_bf16 v[140:143], v[172:175], v[68:71], v[140:143]
    s_add_u32 s10, s17, 14882816
    ds_read_b128 v[172:175], v11 offset:9216
    v_mfma_f32_16x16x32_bf16 v[144:147], v[176:179], v[64:67], v[144:147]
    buffer_load_dwordx4 v[36:39], v10, s[28:31], s10 offen sc1
    s_waitcnt lgkmcnt(4)
    v_mfma_f32_16x16x32_bf16 v[148:151], v[176:179], v[68:71], v[148:151]
    ds_read_b128 v[176:179], v11 offset:10240
    v_mfma_f32_16x16x32_bf16 v[152:155], v[180:183], v[64:67], v[152:155]
    s_waitcnt vmcnt(16) lgkmcnt(4)
    v_mfma_f32_16x16x32_bf16 v[156:159], v[180:183], v[68:71], v[156:159]
    ds_read_b128 v[180:183], v11 offset:11264
    v_mfma_f32_16x16x32_bf16 v[112:115], v[160:163], v[72:75], v[112:115]
    s_waitcnt lgkmcnt(4)
    v_mfma_f32_16x16x32_bf16 v[116:119], v[160:163], v[76:79], v[116:119]
    s_add_u32 s10, s17, 14863360
    ds_read_b128 v[160:163], v11 offset:12288
    v_mfma_f32_16x16x32_bf16 v[120:123], v[164:167], v[72:75], v[120:123]
    buffer_load_dwordx4 v[40:43], v10, s[28:31], s10 offen sc1
    s_waitcnt lgkmcnt(4)
    v_mfma_f32_16x16x32_bf16 v[124:127], v[164:167], v[76:79], v[124:127]
    ds_read_b128 v[164:167], v11 offset:13312
    v_mfma_f32_16x16x32_bf16 v[128:131], v[168:171], v[72:75], v[128:131]
    s_waitcnt lgkmcnt(4)
    v_mfma_f32_16x16x32_bf16 v[132:135], v[168:171], v[76:79], v[132:135]
    ds_read_b128 v[168:171], v11 offset:14336
    v_mfma_f32_16x16x32_bf16 v[136:139], v[172:175], v[72:75], v[136:139]
    s_waitcnt lgkmcnt(4)
    v_mfma_f32_16x16x32_bf16 v[140:143], v[172:175], v[76:79], v[140:143]
    s_add_u32 s10, s17, 14883840
    ds_read_b128 v[172:175], v11 offset:15360
    v_mfma_f32_16x16x32_bf16 v[144:147], v[176:179], v[72:75], v[144:147]
    buffer_load_dwordx4 v[44:47], v10, s[28:31], s10 offen sc1
    s_waitcnt lgkmcnt(4)
    v_mfma_f32_16x16x32_bf16 v[148:151], v[176:179], v[76:79], v[148:151]
    ds_read_b128 v[176:179], v11 offset:16384
    v_mfma_f32_16x16x32_bf16 v[152:155], v[180:183], v[72:75], v[152:155]
    s_waitcnt vmcnt(15) lgkmcnt(4)
    v_mfma_f32_16x16x32_bf16 v[156:159], v[180:183], v[76:79], v[156:159]
    ds_read_b128 v[180:183], v11 offset:17408
    v_mfma_f32_16x16x32_bf16 v[112:115], v[160:163], v[80:83], v[112:115]
    s_waitcnt lgkmcnt(4)
    v_mfma_f32_16x16x32_bf16 v[116:119], v[160:163], v[84:87], v[116:119]
    ds_read_b128 v[160:163], v11 offset:18432
    v_mfma_f32_16x16x32_bf16 v[120:123], v[164:167], v[80:83], v[120:123]
    s_waitcnt lgkmcnt(4)
    v_mfma_f32_16x16x32_bf16 v[124:127], v[164:167], v[84:87], v[124:127]
    ds_read_b128 v[164:167], v11 offset:19456
    v_mfma_f32_16x16x32_bf16 v[128:131], v[168:171], v[80:83], v[128:131]
    s_waitcnt lgkmcnt(4)
    v_mfma_f32_16x16x32_bf16 v[132:135], v[168:171], v[84:87], v[132:135]
    ds_read_b128 v[168:171], v11 offset:20480
    v_mfma_f32_16x16x32_bf16 v[136:139], v[172:175], v[80:83], v[136:139]
    s_waitcnt lgkmcnt(4)
    v_mfma_f32_16x16x32_bf16 v[140:143], v[172:175], v[84:87], v[140:143]
    ds_read_b128 v[172:175], v11 offset:21504
    v_mfma_f32_16x16x32_bf16 v[144:147], v[176:179], v[80:83], v[144:147]
    s_waitcnt lgkmcnt(4)
    v_mfma_f32_16x16x32_bf16 v[148:151], v[176:179], v[84:87], v[148:151]
    ds_read_b128 v[176:179], v11 offset:22528
    v_mfma_f32_16x16x32_bf16 v[152:155], v[180:183], v[80:83], v[152:155]
    s_waitcnt vmcnt(13) lgkmcnt(4)
    v_mfma_f32_16x16x32_bf16 v[156:159], v[180:183], v[84:87], v[156:159]
    ds_read_b128 v[180:183], v11 offset:23552
    v_mfma_f32_16x16x32_bf16 v[112:115], v[160:163], v[88:91], v[112:115]
    s_waitcnt lgkmcnt(4)
    v_mfma_f32_16x16x32_bf16 v[116:119], v[160:163], v[92:95], v[116:119]
    ds_read_b128 v[160:163], v11 offset:24576
    v_mfma_f32_16x16x32_bf16 v[120:123], v[164:167], v[88:91], v[120:123]
    s_waitcnt lgkmcnt(4)
    v_mfma_f32_16x16x32_bf16 v[124:127], v[164:167], v[92:95], v[124:127]
    ds_read_b128 v[164:167], v11 offset:25600
    v_mfma_f32_16x16x32_bf16 v[128:131], v[168:171], v[88:91], v[128:131]
    s_waitcnt lgkmcnt(4)
    v_mfma_f32_16x16x32_bf16 v[132:135], v[168:171], v[92:95], v[132:135]
    ds_read_b128 v[168:171], v11 offset:26624
    v_mfma_f32_16x16x32_bf16 v[136:139], v[172:175], v[88:91], v[136:139]
    s_waitcnt lgkmcnt(4)
    v_mfma_f32_16x16x32_bf16 v[140:143], v[172:175], v[92:95], v[140:143]
    ds_read_b128 v[172:175], v11 offset:27648
    v_mfma_f32_16x16x32_bf16 v[144:147], v[176:179], v[88:91], v[144:147]
    s_waitcnt lgkmcnt(4)
    v_mfma_f32_16x16x32_bf16 v[148:151], v[176:179], v[92:95], v[148:151]
    ds_read_b128 v[176:179], v11 offset:28672
    v_mfma_f32_16x16x32_bf16 v[152:155], v[180:183], v[88:91], v[152:155]
    s_waitcnt vmcnt(11) lgkmcnt(4)
    v_mfma_f32_16x16x32_bf16 v[156:159], v[180:183], v[92:95], v[156:159]
    ds_read_b128 v[180:183], v11 offset:29696
    s_waitcnt vmcnt(8)
    v_mov_b32 v214, v214
    s_mov_b32 exec_lo, 0xff
    s_mov_b32 exec_hi, 0
    v_cmp_eq_u64 vcc, s[100:101], v[214:215]
    s_nop 0
    s_cmp_eq_u64 vcc, exec
    s_mov_b64 exec, -1
    s_cbranch_scc1 interleave_layers__ssm_conv_h3__swiglu_ffn__prompt_kernel_ok35
    s_mov_b32 s23, 0
interleave_layers__ssm_conv_h3__swiglu_ffn__prompt_kernel_spin36:
    s_sleep 1
    s_mov_b32 s13, 851968
    s_mov_b32 exec_lo, 0xff
    s_mov_b32 exec_hi, 0
    buffer_load_dwordx2 v[214:215], v253, s[44:47], s13 offen sc1
    s_mov_b64 exec, -1
    s_waitcnt vmcnt(0)
    s_add_u32 s23, s23, 1
    s_cmp_ge_u32 s23, 262144
    s_cbranch_scc1 interleave_layers__ssm_conv_h3__swiglu_ffn__prompt_kernel_ok35
    v_mov_b32 v214, v214
    s_mov_b32 exec_lo, 0xff
    s_mov_b32 exec_hi, 0
    v_cmp_eq_u64 vcc, s[100:101], v[214:215]
    s_nop 0
    s_cmp_eq_u64 vcc, exec
    s_mov_b64 exec, -1
    s_cbranch_scc0 interleave_layers__ssm_conv_h3__swiglu_ffn__prompt_kernel_spin36
    s_nop 0
interleave_layers__ssm_conv_h3__swiglu_ffn__prompt_kernel_ok35:
    v_mfma_f32_16x16x32_bf16 v[112:115], v[160:163], v[96:99], v[112:115]
    s_add_u32 s10, s57, 14680064
    buffer_load_dwordx4 v[48:51], v10, s[36:39], s10 offen sc1
    s_waitcnt lgkmcnt(4)
    v_mfma_f32_16x16x32_bf16 v[116:119], v[160:163], v[100:103], v[116:119]
    s_add_u32 s10, s58, 14680064
    ds_read_b128 v[160:163], v11 offset:30720
    v_mfma_f32_16x16x32_bf16 v[120:123], v[164:167], v[96:99], v[120:123]
    buffer_load_dwordx4 v[52:55], v10, s[36:39], s10 offen sc1
    s_waitcnt lgkmcnt(4)
    v_mfma_f32_16x16x32_bf16 v[124:127], v[164:167], v[100:103], v[124:127]
    s_add_u32 s10, s57, 14681088
    ds_read_b128 v[164:167], v11 offset:31744
    v_mfma_f32_16x16x32_bf16 v[128:131], v[168:171], v[96:99], v[128:131]
    buffer_load_dwordx4 v[56:59], v10, s[36:39], s10 offen sc1
    s_waitcnt lgkmcnt(4)
    v_mfma_f32_16x16x32_bf16 v[132:135], v[168:171], v[100:103], v[132:135]
    s_add_u32 s10, s58, 14681088
    ds_read_b128 v[168:171], v11 offset:32768
    v_mfma_f32_16x16x32_bf16 v[136:139], v[172:175], v[96:99], v[136:139]
    buffer_load_dwordx4 v[60:63], v10, s[36:39], s10 offen sc1
    s_waitcnt lgkmcnt(4)
    v_mfma_f32_16x16x32_bf16 v[140:143], v[172:175], v[100:103], v[140:143]
    s_add_u32 s10, s57, 14682112
    ds_read_b128 v[172:175], v11 offset:33792
    v_mfma_f32_16x16x32_bf16 v[144:147], v[176:179], v[96:99], v[144:147]
    buffer_load_dwordx4 v[64:67], v10, s[36:39], s10 offen sc1
    s_waitcnt lgkmcnt(4)
    v_mfma_f32_16x16x32_bf16 v[148:151], v[176:179], v[100:103], v[148:151]
    s_add_u32 s10, s58, 14682112
    ds_read_b128 v[176:179], v11 offset:34816
    v_mfma_f32_16x16x32_bf16 v[152:155], v[180:183], v[96:99], v[152:155]
    buffer_load_dwordx4 v[68:71], v10, s[36:39], s10 offen sc1
    s_waitcnt lgkmcnt(4)
    v_mfma_f32_16x16x32_bf16 v[156:159], v[180:183], v[100:103], v[156:159]
    ds_read_b128 v[180:183], v11 offset:35840
    v_mfma_f32_16x16x32_bf16 v[112:115], v[160:163], v[104:107], v[112:115]
    s_add_u32 s10, s57, 14683136
    buffer_load_dwordx4 v[72:75], v10, s[36:39], s10 offen sc1
    s_waitcnt lgkmcnt(4)
    v_mfma_f32_16x16x32_bf16 v[116:119], v[160:163], v[108:111], v[116:119]
    s_add_u32 s10, s58, 14683136
    ds_read_b128 v[160:163], v11 offset:36864
    v_mfma_f32_16x16x32_bf16 v[120:123], v[164:167], v[104:107], v[120:123]
    buffer_load_dwordx4 v[76:79], v10, s[36:39], s10 offen sc1
    s_waitcnt lgkmcnt(4)
    v_mfma_f32_16x16x32_bf16 v[124:127], v[164:167], v[108:111], v[124:127]
    s_add_u32 s10, s57, 14684160
    ds_read_b128 v[164:167], v11 offset:37888
    v_mfma_f32_16x16x32_bf16 v[128:131], v[168:171], v[104:107], v[128:131]
    buffer_load_dwordx4 v[80:83], v10, s[36:39], s10 offen sc1
    s_waitcnt lgkmcnt(4)
    v_mfma_f32_16x16x32_bf16 v[132:135], v[168:171], v[108:111], v[132:135]
    s_add_u32 s10, s58, 14684160
    ds_read_b128 v[168:171], v11 offset:38912
    v_mfma_f32_16x16x32_bf16 v[136:139], v[172:175], v[104:107], v[136:139]
    buffer_load_dwordx4 v[84:87], v10, s[36:39], s10 offen sc1
    s_waitcnt lgkmcnt(4)
    v_mfma_f32_16x16x32_bf16 v[140:143], v[172:175], v[108:111], v[140:143]
    s_add_u32 s10, s57, 14685184
    ds_read_b128 v[172:175], v11 offset:39936
    v_mfma_f32_16x16x32_bf16 v[144:147], v[176:179], v[104:107], v[144:147]
    buffer_load_dwordx4 v[88:91], v10, s[36:39], s10 offen sc1
    s_waitcnt lgkmcnt(4)
    v_mfma_f32_16x16x32_bf16 v[148:151], v[176:179], v[108:111], v[148:151]
    s_add_u32 s10, s58, 14685184
    ds_read_b128 v[176:179], v11 offset:40960
    v_mfma_f32_16x16x32_bf16 v[152:155], v[180:183], v[104:107], v[152:155]
    buffer_load_dwordx4 v[92:95], v10, s[36:39], s10 offen sc1
    s_waitcnt vmcnt(18) lgkmcnt(4)
    v_mfma_f32_16x16x32_bf16 v[156:159], v[180:183], v[108:111], v[156:159]
    ds_read_b128 v[180:183], v11 offset:41984
    v_mfma_f32_16x16x32_bf16 v[112:115], v[160:163], v[16:19], v[112:115]
    s_add_u32 s10, s57, 14686208
    buffer_load_dwordx4 v[96:99], v10, s[36:39], s10 offen sc1
    s_waitcnt lgkmcnt(4)
    v_mfma_f32_16x16x32_bf16 v[116:119], v[160:163], v[20:23], v[116:119]
    ds_read_b128 v[160:163], v11 offset:43008
    v_mfma_f32_16x16x32_bf16 v[120:123], v[164:167], v[16:19], v[120:123]
    s_waitcnt lgkmcnt(4)
    v_mfma_f32_16x16x32_bf16 v[124:127], v[164:167], v[20:23], v[124:127]
    s_add_u32 s10, s58, 14686208
    ds_read_b128 v[164:167], v11 offset:44032
    v_mfma_f32_16x16x32_bf16 v[128:131], v[168:171], v[16:19], v[128:131]
    buffer_load_dwordx4 v[100:103], v10, s[36:39], s10 offen sc1
    s_waitcnt lgkmcnt(4)
    v_mfma_f32_16x16x32_bf16 v[132:135], v[168:171], v[20:23], v[132:135]
    s_add_u32 s10, s57, 14687232
    ds_read_b128 v[168:171], v11 offset:45056
    v_mfma_f32_16x16x32_bf16 v[136:139], v[172:175], v[16:19], v[136:139]
    buffer_load_dwordx4 v[104:107], v10, s[36:39], s10 offen sc1
    s_waitcnt lgkmcnt(4)
    v_mfma_f32_16x16x32_bf16 v[140:143], v[172:175], v[20:23], v[140:143]
    ds_read_b128 v[172:175], v11 offset:46080
    v_mfma_f32_16x16x32_bf16 v[144:147], v[176:179], v[16:19], v[144:147]
    s_waitcnt lgkmcnt(4)
    v_mfma_f32_16x16x32_bf16 v[148:151], v[176:179], v[20:23], v[148:151]
    s_add_u32 s10, s58, 14687232
    ds_read_b128 v[176:179], v11 offset:47104
    v_mfma_f32_16x16x32_bf16 v[152:155], v[180:183], v[16:19], v[152:155]
    buffer_load_dwordx4 v[108:111], v10, s[36:39], s10 offen sc1
    s_waitcnt vmcnt(20) lgkmcnt(4)
    v_mfma_f32_16x16x32_bf16 v[156:159], v[180:183], v[20:23], v[156:159]
    ds_read_b128 v[180:183], v11 offset:48128
    v_mfma_f32_16x16x32_bf16 v[112:115], v[160:163], v[24:27], v[112:115]
    s_waitcnt lgkmcnt(4)
    v_mfma_f32_16x16x32_bf16 v[116:119], v[160:163], v[28:31], v[116:119]
    s_add_u32 s10, s57, 14688256
    ds_read_b128 v[160:163], v11 offset:49152
    v_mfma_f32_16x16x32_bf16 v[120:123], v[164:167], v[24:27], v[120:123]
    buffer_load_dwordx4 v[16:19], v10, s[36:39], s10 offen sc1
    s_waitcnt lgkmcnt(4)
    v_mfma_f32_16x16x32_bf16 v[124:127], v[164:167], v[28:31], v[124:127]
    ds_read_b128 v[164:167], v11 offset:50176
    v_mfma_f32_16x16x32_bf16 v[128:131], v[168:171], v[24:27], v[128:131]
    s_waitcnt lgkmcnt(4)
    v_mfma_f32_16x16x32_bf16 v[132:135], v[168:171], v[28:31], v[132:135]
    ds_read_b128 v[168:171], v11 offset:51200
    v_mfma_f32_16x16x32_bf16 v[136:139], v[172:175], v[24:27], v[136:139]
    s_waitcnt lgkmcnt(4)
    v_mfma_f32_16x16x32_bf16 v[140:143], v[172:175], v[28:31], v[140:143]
    s_add_u32 s10, s58, 14688256
    ds_read_b128 v[172:175], v11 offset:52224
    v_mfma_f32_16x16x32_bf16 v[144:147], v[176:179], v[24:27], v[144:147]
    buffer_load_dwordx4 v[20:23], v10, s[36:39], s10 offen sc1
    s_waitcnt lgkmcnt(4)
    v_mfma_f32_16x16x32_bf16 v[148:151], v[176:179], v[28:31], v[148:151]
    ds_read_b128 v[176:179], v11 offset:53248
    v_mfma_f32_16x16x32_bf16 v[152:155], v[180:183], v[24:27], v[152:155]
    s_waitcnt vmcnt(20) lgkmcnt(4)
    v_mfma_f32_16x16x32_bf16 v[156:159], v[180:183], v[28:31], v[156:159]
    ds_read_b128 v[180:183], v11 offset:54272
    v_mfma_f32_16x16x32_bf16 v[112:115], v[160:163], v[32:35], v[112:115]
    s_waitcnt lgkmcnt(4)
    v_mfma_f32_16x16x32_bf16 v[116:119], v[160:163], v[36:39], v[116:119]
    s_add_u32 s10, s57, 14689280
    ds_read_b128 v[160:163], v11 offset:55296
    v_mfma_f32_16x16x32_bf16 v[120:123], v[164:167], v[32:35], v[120:123]
    buffer_load_dwordx4 v[24:27], v10, s[36:39], s10 offen sc1
    s_waitcnt lgkmcnt(4)
    v_mfma_f32_16x16x32_bf16 v[124:127], v[164:167], v[36:39], v[124:127]
    ds_read_b128 v[164:167], v11 offset:56320
    v_mfma_f32_16x16x32_bf16 v[128:131], v[168:171], v[32:35], v[128:131]
    s_waitcnt lgkmcnt(4)
    v_mfma_f32_16x16x32_bf16 v[132:135], v[168:171], v[36:39], v[132:135]
    ds_read_b128 v[168:171], v11 offset:57344
    v_mfma_f32_16x16x32_bf16 v[136:139], v[172:175], v[32:35], v[136:139]
    s_waitcnt lgkmcnt(4)
    v_mfma_f32_16x16x32_bf16 v[140:143], v[172:175], v[36:39], v[140:143]
    s_add_u32 s10, s58, 14689280
    ds_read_b128 v[172:175], v11 offset:58368
    v_mfma_f32_16x16x32_bf16 v[144:147], v[176:179], v[32:35], v[144:147]
    buffer_load_dwordx4 v[28:31], v10, s[36:39], s10 offen sc1
    s_waitcnt lgkmcnt(4)
    v_mfma_f32_16x16x32_bf16 v[148:151], v[176:179], v[36:39], v[148:151]
    ds_read_b128 v[176:179], v11 offset:59392
    v_mfma_f32_16x16x32_bf16 v[152:155], v[180:183], v[32:35], v[152:155]
    s_waitcnt vmcnt(20) lgkmcnt(4)
    v_mfma_f32_16x16x32_bf16 v[156:159], v[180:183], v[36:39], v[156:159]
    ds_read_b128 v[180:183], v11 offset:60416
    v_mfma_f32_16x16x32_bf16 v[112:115], v[160:163], v[40:43], v[112:115]
    s_waitcnt lgkmcnt(4)
    v_mfma_f32_16x16x32_bf16 v[116:119], v[160:163], v[44:47], v[116:119]
    s_add_u32 s10, s57, 14690304
    v_lshlrev_b32 v255, 4, v3
    v_add_u32 v255, 122880, v255
    ds_read_b128 v[160:163], v255 offset:0
    v_mfma_f32_16x16x32_bf16 v[120:123], v[164:167], v[40:43], v[120:123]
    buffer_load_dwordx4 v[32:35], v10, s[36:39], s10 offen sc1
    s_waitcnt lgkmcnt(4)
    v_mfma_f32_16x16x32_bf16 v[124:127], v[164:167], v[44:47], v[124:127]
    ds_read_b128 v[164:167], v255 offset:64
    v_mfma_f32_16x16x32_bf16 v[128:131], v[168:171], v[40:43], v[128:131]
    s_waitcnt lgkmcnt(4)
    v_mfma_f32_16x16x32_bf16 v[132:135], v[168:171], v[44:47], v[132:135]
    ds_read_b128 v[168:171], v255 offset:128
    v_mfma_f32_16x16x32_bf16 v[136:139], v[172:175], v[40:43], v[136:139]
    s_waitcnt lgkmcnt(4)
    v_mfma_f32_16x16x32_bf16 v[140:143], v[172:175], v[44:47], v[140:143]
    s_add_u32 s10, s58, 14690304
    ds_read_b128 v[172:175], v255 offset:192
    v_mfma_f32_16x16x32_bf16 v[144:147], v[176:179], v[40:43], v[144:147]
    buffer_load_dwordx4 v[36:39], v10, s[36:39], s10 offen sc1
    s_waitcnt lgkmcnt(4)
    v_mfma_f32_16x16x32_bf16 v[148:151], v[176:179], v[44:47], v[148:151]
    ds_read_b128 v[176:179], v255 offset:256
    v_mfma_f32_16x16x32_bf16 v[152:155], v[180:183], v[40:43], v[152:155]
    v_mfma_f32_16x16x32_bf16 v[156:159], v[180:183], v[44:47], v[156:159]
    ds_read_b128 v[180:183], v255 offset:320
    s_add_u32 s10, s57, 14691328
    buffer_load_dwordx4 v[40:43], v10, s[36:39], s10 offen sc1
    s_add_u32 s10, s58, 14691328
    buffer_load_dwordx4 v[44:47], v10, s[36:39], s10 offen sc1
    s_add_u32 s12, s56, 15073280
    v_mul_f32 v212, 0xbfb8aa3b, v241
    v_mul_f32 v213, v241, v241
    v_rcp_f32 v213, v213
    s_waitcnt lgkmcnt(5)
    v_pk_fma_f32 v[112:113], v[160:161], v[240:241], v[112:113] op_sel:[0,0,0] op_sel_hi:[1,0,1]
    v_pk_fma_f32 v[114:115], v[162:163], v[240:241], v[114:115] op_sel:[0,0,0] op_sel_hi:[1,0,1]
    s_waitcnt lgkmcnt(4)
    v_pk_fma_f32 v[120:121], v[164:165], v[240:241], v[120:121] op_sel:[0,0,0] op_sel_hi:[1,0,1]
    v_pk_fma_f32 v[122:123], v[166:167], v[240:241], v[122:123] op_sel:[0,0,0] op_sel_hi:[1,0,1]
    s_waitcnt lgkmcnt(3)
    v_pk_fma_f32 v[128:129], v[168:169], v[240:241], v[128:129] op_sel:[0,0,0] op_sel_hi:[1,0,1]
    v_pk_fma_f32 v[130:131], v[170:171], v[240:241], v[130:131] op_sel:[0,0,0] op_sel_hi:[1,0,1]
    s_waitcnt lgkmcnt(2)
    v_pk_fma_f32 v[136:137], v[172:173], v[240:241], v[136:137] op_sel:[0,0,0] op_sel_hi:[1,0,1]
    v_pk_fma_f32 v[138:139], v[174:175], v[240:241], v[138:139] op_sel:[0,0,0] op_sel_hi:[1,0,1]
    s_waitcnt lgkmcnt(1)
    v_pk_fma_f32 v[144:145], v[176:177], v[240:241], v[144:145] op_sel:[0,0,0] op_sel_hi:[1,0,1]
    v_pk_fma_f32 v[146:147], v[178:179], v[240:241], v[146:147] op_sel:[0,0,0] op_sel_hi:[1,0,1]
    s_waitcnt lgkmcnt(0)
    v_pk_fma_f32 v[152:153], v[180:181], v[240:241], v[152:153] op_sel:[0,0,0] op_sel_hi:[1,0,1]
    v_pk_fma_f32 v[154:155], v[182:183], v[240:241], v[154:155] op_sel:[0,0,0] op_sel_hi:[1,0,1]
    v_pk_mul_f32 v[184:185], v[112:113], v[212:213] op_sel:[0,0] op_sel_hi:[1,0]
    v_pk_mul_f32 v[186:187], v[114:115], v[212:213] op_sel:[0,0] op_sel_hi:[1,0]
    v_pk_mul_f32 v[188:189], v[120:121], v[212:213] op_sel:[0,0] op_sel_hi:[1,0]
    v_pk_mul_f32 v[190:191], v[122:123], v[212:213] op_sel:[0,0] op_sel_hi:[1,0]
    v_pk_mul_f32 v[192:193], v[128:129], v[212:213] op_sel:[0,0] op_sel_hi:[1,0]
    v_pk_mul_f32 v[194:195], v[130:131], v[212:213] op_sel:[0,0] op_sel_hi:[1,0]
    v_exp_f32 v184, v184
    v_exp_f32 v185, v185
    v_exp_f32 v186, v186
    v_exp_f32 v187, v187
    v_exp_f32 v188, v188
    v_exp_f32 v189, v189
    v_exp_f32 v190, v190
    v_exp_f32 v191, v191
    v_exp_f32 v192, v192
    v_exp_f32 v193, v193
    v_exp_f32 v194, v194
    v_exp_f32 v195, v195
    v_pk_mul_f32 v[112:113], v[112:113], v[136:137]
    v_pk_mul_f32 v[114:115], v[114:115], v[138:139]
    v_pk_mul_f32 v[120:121], v[120:121], v[144:145]
    v_pk_mul_f32 v[122:123], v[122:123], v[146:147]
    v_pk_mul_f32 v[128:129], v[128:129], v[152:153]
    v_pk_mul_f32 v[130:131], v[130:131], v[154:155]
    v_pk_fma_f32 v[184:185], v[184:185], v[212:213], v[212:213] op_sel:[0,1,1] op_sel_hi:[1,1,1]
    v_pk_fma_f32 v[186:187], v[186:187], v[212:213], v[212:213] op_sel:[0,1,1] op_sel_hi:[1,1,1]
    v_pk_fma_f32 v[188:189], v[188:189], v[212:213], v[212:213] op_sel:[0,1,1] op_sel_hi:[1,1,1]
    v_pk_fma_f32 v[190:191], v[190:191], v[212:213], v[212:213] op_sel:[0,1,1] op_sel_hi:[1,1,1]
    v_pk_fma_f32 v[192:193], v[192:193], v[212:213], v[212:213] op_sel:[0,1,1] op_sel_hi:[1,1,1]
    v_pk_fma_f32 v[194:195], v[194:195], v[212:213], v[212:213] op_sel:[0,1,1] op_sel_hi:[1,1,1]
    v_rcp_f32 v184, v184
    v_rcp_f32 v185, v185
    v_rcp_f32 v186, v186
    v_rcp_f32 v187, v187
    v_rcp_f32 v188, v188
    v_rcp_f32 v189, v189
    v_rcp_f32 v190, v190
    v_rcp_f32 v191, v191
    v_rcp_f32 v192, v192
    v_rcp_f32 v193, v193
    v_rcp_f32 v194, v194
    v_rcp_f32 v195, v195
    v_pk_mul_f32 v[184:185], v[184:185], v[112:113]
    v_pk_mul_f32 v[186:187], v[186:187], v[114:115]
    v_pk_mul_f32 v[188:189], v[188:189], v[120:121]
    v_pk_mul_f32 v[190:191], v[190:191], v[122:123]
    v_pk_mul_f32 v[192:193], v[192:193], v[128:129]
    v_pk_mul_f32 v[194:195], v[194:195], v[130:131]
    v_cvt_pk_bf16_f32 v196, v184, v185
    v_cvt_pk_bf16_f32 v197, v186, v187
    v_cvt_pk_bf16_f32 v198, v188, v189
    v_cvt_pk_bf16_f32 v199, v190, v191
    v_cvt_pk_bf16_f32 v204, v192, v193
    v_cvt_pk_bf16_f32 v205, v194, v195
    buffer_store_dwordx4 v[196:199], v10, s[36:39], s12 offen sc1
    v_mul_f32 v212, 0xbfb8aa3b, v243
    v_mul_f32 v213, v243, v243
    v_rcp_f32 v213, v213
    v_pk_fma_f32 v[116:117], v[160:161], v[242:243], v[116:117] op_sel:[0,0,0] op_sel_hi:[1,0,1]
    v_pk_fma_f32 v[118:119], v[162:163], v[242:243], v[118:119] op_sel:[0,0,0] op_sel_hi:[1,0,1]
    v_pk_fma_f32 v[124:125], v[164:165], v[242:243], v[124:125] op_sel:[0,0,0] op_sel_hi:[1,0,1]
    v_pk_fma_f32 v[126:127], v[166:167], v[242:243], v[126:127] op_sel:[0,0,0] op_sel_hi:[1,0,1]
    v_pk_fma_f32 v[132:133], v[168:169], v[242:243], v[132:133] op_sel:[0,0,0] op_sel_hi:[1,0,1]
    v_pk_fma_f32 v[134:135], v[170:171], v[242:243], v[134:135] op_sel:[0,0,0] op_sel_hi:[1,0,1]
    v_pk_fma_f32 v[140:141], v[172:173], v[242:243], v[140:141] op_sel:[0,0,0] op_sel_hi:[1,0,1]
    v_pk_fma_f32 v[142:143], v[174:175], v[242:243], v[142:143] op_sel:[0,0,0] op_sel_hi:[1,0,1]
    v_pk_fma_f32 v[148:149], v[176:177], v[242:243], v[148:149] op_sel:[0,0,0] op_sel_hi:[1,0,1]
    v_pk_fma_f32 v[150:151], v[178:179], v[242:243], v[150:151] op_sel:[0,0,0] op_sel_hi:[1,0,1]
    v_pk_fma_f32 v[156:157], v[180:181], v[242:243], v[156:157] op_sel:[0,0,0] op_sel_hi:[1,0,1]
    v_pk_fma_f32 v[158:159], v[182:183], v[242:243], v[158:159] op_sel:[0,0,0] op_sel_hi:[1,0,1]
    v_pk_mul_f32 v[184:185], v[116:117], v[212:213] op_sel:[0,0] op_sel_hi:[1,0]
    v_pk_mul_f32 v[186:187], v[118:119], v[212:213] op_sel:[0,0] op_sel_hi:[1,0]
    v_pk_mul_f32 v[188:189], v[124:125], v[212:213] op_sel:[0,0] op_sel_hi:[1,0]
    v_pk_mul_f32 v[190:191], v[126:127], v[212:213] op_sel:[0,0] op_sel_hi:[1,0]
    v_pk_mul_f32 v[192:193], v[132:133], v[212:213] op_sel:[0,0] op_sel_hi:[1,0]
    v_pk_mul_f32 v[194:195], v[134:135], v[212:213] op_sel:[0,0] op_sel_hi:[1,0]
    v_exp_f32 v184, v184
    v_exp_f32 v185, v185
    v_exp_f32 v186, v186
    v_exp_f32 v187, v187
    v_exp_f32 v188, v188
    v_exp_f32 v189, v189
    v_exp_f32 v190, v190
    v_exp_f32 v191, v191
    v_exp_f32 v192, v192
    v_exp_f32 v193, v193
    v_exp_f32 v194, v194
    v_exp_f32 v195, v195
    v_pk_mul_f32 v[116:117], v[116:117], v[140:141]
    v_pk_mul_f32 v[118:119], v[118:119], v[142:143]
    v_pk_mul_f32 v[124:125], v[124:125], v[148:149]
    v_pk_mul_f32 v[126:127], v[126:127], v[150:151]
    v_pk_mul_f32 v[132:133], v[132:133], v[156:157]
    v_pk_mul_f32 v[134:135], v[134:135], v[158:159]
    v_pk_fma_f32 v[184:185], v[184:185], v[212:213], v[212:213] op_sel:[0,1,1] op_sel_hi:[1,1,1]
    v_pk_fma_f32 v[186:187], v[186:187], v[212:213], v[212:213] op_sel:[0,1,1] op_sel_hi:[1,1,1]
    v_pk_fma_f32 v[188:189], v[188:189], v[212:213], v[212:213] op_sel:[0,1,1] op_sel_hi:[1,1,1]
    v_pk_fma_f32 v[190:191], v[190:191], v[212:213], v[212:213] op_sel:[0,1,1] op_sel_hi:[1,1,1]
    v_pk_fma_f32 v[192:193], v[192:193], v[212:213], v[212:213] op_sel:[0,1,1] op_sel_hi:[1,1,1]
    v_pk_fma_f32 v[194:195], v[194:195], v[212:213], v[212:213] op_sel:[0,1,1] op_sel_hi:[1,1,1]
    v_rcp_f32 v184, v184
    v_rcp_f32 v185, v185
    v_rcp_f32 v186, v186
    v_rcp_f32 v187, v187
    v_rcp_f32 v188, v188
    v_rcp_f32 v189, v189
    v_rcp_f32 v190, v190
    v_rcp_f32 v191, v191
    v_rcp_f32 v192, v192
    v_rcp_f32 v193, v193
    v_rcp_f32 v194, v194
    v_rcp_f32 v195, v195
    v_pk_mul_f32 v[184:185], v[184:185], v[116:117]
    v_pk_mul_f32 v[186:187], v[186:187], v[118:119]
    v_pk_mul_f32 v[188:189], v[188:189], v[124:125]
    v_pk_mul_f32 v[190:191], v[190:191], v[126:127]
    v_pk_mul_f32 v[192:193], v[192:193], v[132:133]
    v_pk_mul_f32 v[194:195], v[194:195], v[134:135]
    v_cvt_pk_bf16_f32 v200, v184, v185
    v_cvt_pk_bf16_f32 v201, v186, v187
    v_cvt_pk_bf16_f32 v202, v188, v189
    v_cvt_pk_bf16_f32 v203, v190, v191
    v_cvt_pk_bf16_f32 v206, v192, v193
    v_cvt_pk_bf16_f32 v207, v194, v195
    s_add_u32 s13, s12, 49152
    buffer_store_dwordx4 v[200:203], v10, s[36:39], s13 offen sc1
    v_permlane16_swap_b32 v204, v206
    v_permlane16_swap_b32 v205, v207
    buffer_store_dwordx4 v[204:207], v8, s[36:39], s12 offen offset:1024 sc1
    s_waitcnt vmcnt(26)
    v_mfma_f32_16x16x32_bf16 v[160:163], a[0:3], v[48:51], 0
    v_mfma_f32_16x16x32_bf16 v[164:167], a[4:7], v[48:51], 0
    v_mfma_f32_16x16x32_bf16 v[128:131], a[8:11], v[48:51], 0
    v_mfma_f32_16x16x32_bf16 v[136:139], a[12:15], v[48:51], 0
    v_mfma_f32_16x16x32_bf16 v[168:171], a[16:19], v[48:51], 0
    s_waitcnt vmcnt(25)
    v_mfma_f32_16x16x32_bf16 v[116:119], a[0:3], v[52:55], 0
    v_mfma_f32_16x16x32_bf16 v[124:127], a[4:7], v[52:55], 0
    v_mfma_f32_16x16x32_bf16 v[132:135], a[8:11], v[52:55], 0
    v_mfma_f32_16x16x32_bf16 v[140:143], a[12:15], v[52:55], 0
    v_mfma_f32_16x16x32_bf16 v[148:151], a[16:19], v[52:55], 0
    s_waitcnt vmcnt(24)
    v_mfma_f32_16x16x32_bf16 v[160:163], a[20:23], v[56:59], v[160:163]
    v_mfma_f32_16x16x32_bf16 v[164:167], a[24:27], v[56:59], v[164:167]
    v_mfma_f32_16x16x32_bf16 v[128:131], a[28:31], v[56:59], v[128:131]
    v_mfma_f32_16x16x32_bf16 v[136:139], a[32:35], v[56:59], v[136:139]
    v_mfma_f32_16x16x32_bf16 v[168:171], a[36:39], v[56:59], v[168:171]
    s_waitcnt vmcnt(23)
    v_mfma_f32_16x16x32_bf16 v[116:119], a[20:23], v[60:63], v[116:119]
    v_mfma_f32_16x16x32_bf16 v[124:127], a[24:27], v[60:63], v[124:127]
    v_mfma_f32_16x16x32_bf16 v[132:135], a[28:31], v[60:63], v[132:135]
    v_mfma_f32_16x16x32_bf16 v[140:143], a[32:35], v[60:63], v[140:143]
    v_mfma_f32_16x16x32_bf16 v[148:151], a[36:39], v[60:63], v[148:151]
    s_waitcnt vmcnt(22)
    v_mfma_f32_16x16x32_bf16 v[160:163], a[40:43], v[64:67], v[160:163]
    v_mfma_f32_16x16x32_bf16 v[164:167], a[44:47], v[64:67], v[164:167]
    v_mfma_f32_16x16x32_bf16 v[128:131], a[48:51], v[64:67], v[128:131]
    v_mfma_f32_16x16x32_bf16 v[136:139], a[52:55], v[64:67], v[136:139]
    v_mfma_f32_16x16x32_bf16 v[168:171], a[56:59], v[64:67], v[168:171]
    s_waitcnt vmcnt(21)
    v_mfma_f32_16x16x32_bf16 v[116:119], a[40:43], v[68:71], v[116:119]
    v_mfma_f32_16x16x32_bf16 v[124:127], a[44:47], v[68:71], v[124:127]
    v_mfma_f32_16x16x32_bf16 v[132:135], a[48:51], v[68:71], v[132:135]
    v_mfma_f32_16x16x32_bf16 v[140:143], a[52:55], v[68:71], v[140:143]
    v_mfma_f32_16x16x32_bf16 v[148:151], a[56:59], v[68:71], v[148:151]
    s_waitcnt vmcnt(20)
    v_mfma_f32_16x16x32_bf16 v[160:163], a[60:63], v[72:75], v[160:163]
    v_mfma_f32_16x16x32_bf16 v[164:167], a[64:67], v[72:75], v[164:167]
    v_mfma_f32_16x16x32_bf16 v[128:131], a[68:71], v[72:75], v[128:131]
    v_mfma_f32_16x16x32_bf16 v[136:139], a[72:75], v[72:75], v[136:139]
    v_mfma_f32_16x16x32_bf16 v[168:171], a[76:79], v[72:75], v[168:171]
    s_waitcnt vmcnt(19)
    v_mfma_f32_16x16x32_bf16 v[116:119], a[60:63], v[76:79], v[116:119]
    v_mfma_f32_16x16x32_bf16 v[124:127], a[64:67], v[76:79], v[124:127]
    v_mfma_f32_16x16x32_bf16 v[132:135], a[68:71], v[76:79], v[132:135]
    v_mfma_f32_16x16x32_bf16 v[140:143], a[72:75], v[76:79], v[140:143]
    v_mfma_f32_16x16x32_bf16 v[148:151], a[76:79], v[76:79], v[148:151]
    s_waitcnt vmcnt(18)
    v_mfma_f32_16x16x32_bf16 v[160:163], a[80:83], v[80:83], v[160:163]
    v_mfma_f32_16x16x32_bf16 v[164:167], a[84:87], v[80:83], v[164:167]
    v_mfma_f32_16x16x32_bf16 v[128:131], a[88:91], v[80:83], v[128:131]
    v_mfma_f32_16x16x32_bf16 v[136:139], a[92:95], v[80:83], v[136:139]
    v_mfma_f32_16x16x32_bf16 v[168:171], a[96:99], v[80:83], v[168:171]
    s_waitcnt vmcnt(17)
    v_mfma_f32_16x16x32_bf16 v[116:119], a[80:83], v[84:87], v[116:119]
    v_mfma_f32_16x16x32_bf16 v[124:127], a[84:87], v[84:87], v[124:127]
    v_mfma_f32_16x16x32_bf16 v[132:135], a[88:91], v[84:87], v[132:135]
    v_mfma_f32_16x16x32_bf16 v[140:143], a[92:95], v[84:87], v[140:143]
    v_mfma_f32_16x16x32_bf16 v[148:151], a[96:99], v[84:87], v[148:151]
    s_lshl_b32 s12, s4, 3
    s_add_u32 s12, s12, s3
    s_lshl_b32 s12, s12, 5
    s_add_u32 s12, s12, s5
    s_lshl_b32 s12, s12, 7
    s_add_u32 s12, s12, 868352
    v_mov_b32 v254, s100
    v_mov_b32 v255, s101
    s_waitcnt vmcnt(0)
    buffer_store_dwordx2 v[254:255], v252, s[44:47], s12 offen sc1
    s_barrier
    v_mfma_f32_16x16x32_bf16 v[160:163], a[100:103], v[88:91], v[160:163]
    v_mfma_f32_16x16x32_bf16 v[164:167], a[104:107], v[88:91], v[164:167]
    v_mfma_f32_16x16x32_bf16 v[128:131], a[108:111], v[88:91], v[128:131]
    v_mfma_f32_16x16x32_bf16 v[136:139], a[112:115], v[88:91], v[136:139]
    v_mfma_f32_16x16x32_bf16 v[168:171], a[116:119], v[88:91], v[168:171]
    v_mfma_f32_16x16x32_bf16 v[116:119], a[100:103], v[92:95], v[116:119]
    v_mfma_f32_16x16x32_bf16 v[124:127], a[104:107], v[92:95], v[124:127]
    v_mfma_f32_16x16x32_bf16 v[132:135], a[108:111], v[92:95], v[132:135]
    v_mfma_f32_16x16x32_bf16 v[140:143], a[112:115], v[92:95], v[140:143]
    v_mfma_f32_16x16x32_bf16 v[148:151], a[116:119], v[92:95], v[148:151]
    v_mfma_f32_16x16x32_bf16 v[160:163], a[120:123], v[96:99], v[160:163]
    v_mfma_f32_16x16x32_bf16 v[164:167], a[124:127], v[96:99], v[164:167]
    v_mfma_f32_16x16x32_bf16 v[128:131], a[128:131], v[96:99], v[128:131]
    v_mfma_f32_16x16x32_bf16 v[136:139], a[132:135], v[96:99], v[136:139]
    v_mfma_f32_16x16x32_bf16 v[168:171], a[136:139], v[96:99], v[168:171]
    v_mfma_f32_16x16x32_bf16 v[116:119], a[120:123], v[100:103], v[116:119]
    v_mfma_f32_16x16x32_bf16 v[124:127], a[124:127], v[100:103], v[124:127]
    v_mfma_f32_16x16x32_bf16 v[132:135], a[128:131], v[100:103], v[132:135]
    v_mfma_f32_16x16x32_bf16 v[140:143], a[132:135], v[100:103], v[140:143]
    v_mfma_f32_16x16x32_bf16 v[148:151], a[136:139], v[100:103], v[148:151]
    v_mfma_f32_16x16x32_bf16 v[160:163], a[140:143], v[104:107], v[160:163]
    v_mfma_f32_16x16x32_bf16 v[164:167], a[144:147], v[104:107], v[164:167]
    v_mfma_f32_16x16x32_bf16 v[128:131], a[148:151], v[104:107], v[128:131]
    v_mfma_f32_16x16x32_bf16 v[136:139], a[152:155], v[104:107], v[136:139]
    v_mfma_f32_16x16x32_bf16 v[168:171], a[156:159], v[104:107], v[168:171]
    v_mfma_f32_16x16x32_bf16 v[116:119], a[140:143], v[108:111], v[116:119]
    v_mfma_f32_16x16x32_bf16 v[124:127], a[144:147], v[108:111], v[124:127]
    v_mfma_f32_16x16x32_bf16 v[132:135], a[148:151], v[108:111], v[132:135]
    v_mfma_f32_16x16x32_bf16 v[140:143], a[152:155], v[108:111], v[140:143]
    v_mfma_f32_16x16x32_bf16 v[148:151], a[156:159], v[108:111], v[148:151]
    v_mfma_f32_16x16x32_bf16 v[160:163], a[160:163], v[16:19], v[160:163]
    v_mfma_f32_16x16x32_bf16 v[164:167], a[164:167], v[16:19], v[164:167]
    v_mfma_f32_16x16x32_bf16 v[128:131], a[168:171], v[16:19], v[128:131]
    v_mfma_f32_16x16x32_bf16 v[136:139], a[172:175], v[16:19], v[136:139]
    v_mfma_f32_16x16x32_bf16 v[168:171], a[176:179], v[16:19], v[168:171]
    v_mfma_f32_16x16x32_bf16 v[116:119], a[160:163], v[20:23], v[116:119]
    v_mfma_f32_16x16x32_bf16 v[124:127], a[164:167], v[20:23], v[124:127]
    v_mfma_f32_16x16x32_bf16 v[132:135], a[168:171], v[20:23], v[132:135]
    v_mfma_f32_16x16x32_bf16 v[140:143], a[172:175], v[20:23], v[140:143]
    v_mfma_f32_16x16x32_bf16 v[148:151], a[176:179], v[20:23], v[148:151]
    v_mfma_f32_16x16x32_bf16 v[116:119], a[180:183], v[28:31], v[116:119]
    v_mfma_f32_16x16x32_bf16 v[116:119], a[200:203], v[36:39], v[116:119]
    v_mfma_f32_16x16x32_bf16 v[116:119], a[220:223], v[44:47], v[116:119]
    s_mov_b32 s13, 868352
    s_mov_b32 exec_lo, 0xff
    s_mov_b32 exec_hi, 0
    buffer_load_dwordx2 v[214:215], v253, s[44:47], s13 offen sc1
    s_mov_b64 exec, -1
    v_mfma_f32_16x16x32_bf16 v[124:127], a[184:187], v[28:31], v[124:127]
    v_mfma_f32_16x16x32_bf16 v[124:127], a[204:207], v[36:39], v[124:127]
    v_mfma_f32_16x16x32_bf16 v[124:127], a[224:227], v[44:47], v[124:127]
    v_mfma_f32_16x16x32_bf16 v[128:131], a[188:191], v[24:27], v[128:131]
    v_mfma_f32_16x16x32_bf16 v[128:131], a[208:211], v[32:35], v[128:131]
    v_mfma_f32_16x16x32_bf16 v[128:131], a[228:231], v[40:43], v[128:131]
    ds_write_b128 v249, v[116:119] offset:0
    v_mfma_f32_16x16x32_bf16 v[136:139], a[192:195], v[24:27], v[136:139]
    v_mfma_f32_16x16x32_bf16 v[136:139], a[212:215], v[32:35], v[136:139]
    v_mfma_f32_16x16x32_bf16 v[136:139], a[232:235], v[40:43], v[136:139]
    s_nop 0
    ds_write_b128 v249, v[124:127] offset:1024
    v_mfma_f32_16x16x32_bf16 v[132:135], a[188:191], v[28:31], v[132:135]
    v_mfma_f32_16x16x32_bf16 v[132:135], a[208:211], v[36:39], v[132:135]
    v_mfma_f32_16x16x32_bf16 v[132:135], a[228:231], v[44:47], v[132:135]
    ds_write_b128 v249, v[128:131] offset:2048
    v_mfma_f32_16x16x32_bf16 v[140:143], a[192:195], v[28:31], v[140:143]
    v_lshlrev_b32 v184, 16, v216
    v_mfma_f32_16x16x32_bf16 v[140:143], a[212:215], v[36:39], v[140:143]
    v_and_b32 v185, 0xffff0000, v216
    v_mfma_f32_16x16x32_bf16 v[140:143], a[232:235], v[44:47], v[140:143]
    v_lshlrev_b32 v186, 16, v217
    ds_write_b128 v249, v[136:139] offset:3072
    v_mfma_f32_16x16x32_bf16 v[148:151], a[196:199], v[28:31], v[148:151]
    v_and_b32 v187, 0xffff0000, v217
    v_mfma_f32_16x16x32_bf16 v[148:151], a[216:219], v[36:39], v[148:151]
    v_lshlrev_b32 v188, 16, v218
    v_mfma_f32_16x16x32_bf16 v[148:151], a[236:239], v[44:47], v[148:151]
    v_and_b32 v189, 0xffff0000, v218
    ds_write_b128 v249, v[132:135] offset:4096
    v_mfma_f32_16x16x32_bf16 v[168:171], a[196:199], v[24:27], v[168:171]
    v_lshlrev_b32 v190, 16, v219
    v_mfma_f32_16x16x32_bf16 v[168:171], a[216:219], v[32:35], v[168:171]
    v_and_b32 v191, 0xffff0000, v219
    v_mfma_f32_16x16x32_bf16 v[168:171], a[236:239], v[40:43], v[168:171]
    v_lshlrev_b32 v192, 16, v220
    ds_write_b128 v249, v[140:143] offset:5120
    v_mfma_f32_16x16x32_bf16 v[160:163], a[180:183], v[24:27], v[160:163]
    v_and_b32 v193, 0xffff0000, v220
    v_mfma_f32_16x16x32_bf16 v[160:163], a[200:203], v[32:35], v[160:163]
    v_lshlrev_b32 v194, 16, v221
    v_mfma_f32_16x16x32_bf16 v[160:163], a[220:223], v[40:43], v[160:163]
    v_and_b32 v195, 0xffff0000, v221
    ds_write_b128 v249, v[148:151] offset:7168
    v_mfma_f32_16x16x32_bf16 v[164:167], a[184:187], v[24:27], v[164:167]
    v_xor_b32 v197, 8192, v249
    v_mfma_f32_16x16x32_bf16 v[164:167], a[204:207], v[32:35], v[164:167]
    v_xor_b32 v198, 16384, v249
    v_mfma_f32_16x16x32_bf16 v[164:167], a[224:227], v[40:43], v[164:167]
    v_xor_b32 v199, 24576, v249
    ds_write_b128 v249, v[168:171] offset:6144
    s_waitcnt vmcnt(0)
    v_mov_b32 v214, v214
    s_mov_b32 exec_lo, 0xff
    s_mov_b32 exec_hi, 0
    v_cmp_eq_u64 vcc, s[100:101], v[214:215]
    s_nop 0
    s_cmp_eq_u64 vcc, exec
    s_mov_b64 exec, -1
    s_cbranch_scc1 interleave_layers__ssm_conv_h3__swiglu_ffn__prompt_kernel_ok37
    s_mov_b32 s23, 0
interleave_layers__ssm_conv_h3__swiglu_ffn__prompt_kernel_spin38:
    s_sleep 1
    s_mov_b32 s13, 868352
    s_mov_b32 exec_lo, 0xff
    s_mov_b32 exec_hi, 0
    buffer_load_dwordx2 v[214:215], v253, s[44:47], s13 offen sc1
    s_mov_b64 exec, -1
    s_waitcnt vmcnt(0)
    s_add_u32 s23, s23, 1
    s_cmp_ge_u32 s23, 262144
    s_cbranch_scc1 interleave_layers__ssm_conv_h3__swiglu_ffn__prompt_kernel_ok37
    v_mov_b32 v214, v214
    s_mov_b32 exec_lo, 0xff
    s_mov_b32 exec_hi, 0
    v_cmp_eq_u64 vcc, s[100:101], v[214:215]
    s_nop 0
    s_cmp_eq_u64 vcc, exec
    s_mov_b64 exec, -1
    s_cbranch_scc0 interleave_layers__ssm_conv_h3__swiglu_ffn__prompt_kernel_spin38
    s_nop 0
interleave_layers__ssm_conv_h3__swiglu_ffn__prompt_kernel_ok37:
    s_add_u32 s10, s57, 15073280
    buffer_load_dwordx4 v[16:19], v10, s[36:39], s10 offen sc1
    s_add_u32 s10, s58, 15073280
    buffer_load_dwordx4 v[20:23], v10, s[36:39], s10 offen sc1
    s_add_u32 s10, s57, 15074304
    buffer_load_dwordx4 v[24:27], v10, s[36:39], s10 offen sc1
    s_add_u32 s10, s58, 15074304
    buffer_load_dwordx4 v[28:31], v10, s[36:39], s10 offen sc1
    s_add_u32 s10, s57, 15075328
    buffer_load_dwordx4 v[32:35], v10, s[36:39], s10 offen sc1
    s_add_u32 s10, s58, 15075328
    buffer_load_dwordx4 v[36:39], v10, s[36:39], s10 offen sc1
    s_add_u32 s10, s57, 15076352
    buffer_load_dwordx4 v[40:43], v10, s[36:39], s10 offen sc1
    s_add_u32 s10, s58, 15076352
    buffer_load_dwordx4 v[44:47], v10, s[36:39], s10 offen sc1
    s_add_u32 s10, s57, 15077376
    buffer_load_dwordx4 v[48:51], v10, s[36:39], s10 offen sc1
    s_add_u32 s10, s58, 15077376
    buffer_load_dwordx4 v[52:55], v10, s[36:39], s10 offen sc1
    s_waitcnt lgkmcnt(0)
    s_barrier
    ds_read_b128 v[112:115], v197 offset:0
    ds_read_b128 v[116:119], v197 offset:1024
    ds_read_b128 v[120:123], v197 offset:7168
    ds_read_b128 v[124:127], v198 offset:2048
    ds_read_b128 v[128:131], v198 offset:3072
    ds_read_b128 v[132:135], v198 offset:6144
    ds_read_b128 v[136:139], v199 offset:4096
    ds_read_b128 v[140:143], v199 offset:5120
    ds_read_b128 v[144:147], v199 offset:7168
    v_pk_add_f32 v[160:161], v[160:161], v[184:185]
    v_pk_add_f32 v[162:163], v[162:163], v[186:187]
    v_pk_add_f32 v[164:165], v[164:165], v[188:189]
    v_pk_add_f32 v[166:167], v[166:167], v[190:191]
    v_pk_add_f32 v[168:169], v[168:169], v[192:193]
    v_pk_add_f32 v[170:171], v[170:171], v[194:195]
    s_waitcnt lgkmcnt(8)
    v_pk_add_f32 v[160:161], v[160:161], v[112:113]
    v_pk_add_f32 v[162:163], v[162:163], v[114:115]
    s_waitcnt lgkmcnt(7)
    v_pk_add_f32 v[164:165], v[164:165], v[116:117]
    v_pk_add_f32 v[166:167], v[166:167], v[118:119]
    s_waitcnt lgkmcnt(6)
    v_pk_add_f32 v[168:169], v[168:169], v[120:121]
    v_pk_add_f32 v[170:171], v[170:171], v[122:123]
    s_waitcnt lgkmcnt(5)
    v_pk_add_f32 v[160:161], v[160:161], v[124:125]
    v_pk_add_f32 v[162:163], v[162:163], v[126:127]
    s_waitcnt lgkmcnt(4)
    v_pk_add_f32 v[164:165], v[164:165], v[128:129]
    v_pk_add_f32 v[166:167], v[166:167], v[130:131]
    s_waitcnt lgkmcnt(3)
    v_pk_add_f32 v[168:169], v[168:169], v[132:133]
    v_pk_add_f32 v[170:171], v[170:171], v[134:135]
    s_waitcnt lgkmcnt(2)
    v_pk_add_f32 v[160:161], v[160:161], v[136:137]
    v_pk_add_f32 v[162:163], v[162:163], v[138:139]
    s_waitcnt lgkmcnt(1)
    v_pk_add_f32 v[164:165], v[164:165], v[140:141]
    v_pk_add_f32 v[166:167], v[166:167], v[142:143]
    s_waitcnt lgkmcnt(0)
    v_pk_add_f32 v[168:169], v[168:169], v[144:145]
    v_pk_add_f32 v[170:171], v[170:171], v[146:147]
    v_cvt_pk_bf16_f32 v184, v160, v161
    v_cvt_pk_bf16_f32 v185, v162, v163
    v_cvt_pk_bf16_f32 v186, v164, v165
    v_cvt_pk_bf16_f32 v187, v166, v167
    v_cvt_pk_bf16_f32 v188, v168, v169
    v_cvt_pk_bf16_f32 v189, v170, v171
    v_mul_u32_u24 v192, 1280, v13
    s_mul_i32 s12, s8, 160
    s_add_u32 s12, s12, 0
    s_lshl_b32 s13, s14, 6
    s_add_u32 s13, s13, s12
    v_lshl_add_u32 v193, v3, 4, v192
    v_lshl_add_u32 v194, v3, 3, v192
    s_lshl_b32 s10, s14, 31
    v_or_b32 v194, s10, v194
    buffer_store_dwordx4 v[184:187], v193, s[48:51], s13 offen
    buffer_store_dwordx2 v[188:189], v194, s[48:51], s12 offen offset:128
    s_waitcnt vmcnt(11)
    v_mfma_f32_16x16x32_bf16 v[172:175], a[0:3], v[16:19], 0
    v_mfma_f32_16x16x32_bf16 v[176:179], a[4:7], v[16:19], 0
    v_mfma_f32_16x16x32_bf16 v[128:131], a[8:11], v[16:19], 0
    s_add_u32 s10, s57, 15078400
    buffer_load_dwordx4 v[56:59], v10, s[36:39], s10 offen sc1
    v_mfma_f32_16x16x32_bf16 v[136:139], a[12:15], v[16:19], 0
    v_mfma_f32_16x16x32_bf16 v[180:183], a[16:19], v[16:19], 0
    s_waitcnt vmcnt(11)
    v_mfma_f32_16x16x32_bf16 v[116:119], a[0:3], v[20:23], 0
    v_mfma_f32_16x16x32_bf16 v[124:127], a[4:7], v[20:23], 0
    v_mfma_f32_16x16x32_bf16 v[132:135], a[8:11], v[20:23], 0
    s_add_u32 s10, s58, 15078400
    buffer_load_dwordx4 v[60:63], v10, s[36:39], s10 offen sc1
    v_mfma_f32_16x16x32_bf16 v[140:143], a[12:15], v[20:23], 0
    v_mfma_f32_16x16x32_bf16 v[148:151], a[16:19], v[20:23], 0
    s_waitcnt vmcnt(11)
    v_mfma_f32_16x16x32_bf16 v[172:175], a[20:23], v[24:27], v[172:175]
    v_mfma_f32_16x16x32_bf16 v[176:179], a[24:27], v[24:27], v[176:179]
    v_mfma_f32_16x16x32_bf16 v[128:131], a[28:31], v[24:27], v[128:131]
    s_add_u32 s10, s57, 15079424
    buffer_load_dwordx4 v[64:67], v10, s[36:39], s10 offen sc1
    v_mfma_f32_16x16x32_bf16 v[136:139], a[32:35], v[24:27], v[136:139]
    v_mfma_f32_16x16x32_bf16 v[180:183], a[36:39], v[24:27], v[180:183]
    s_waitcnt vmcnt(11)
    v_mfma_f32_16x16x32_bf16 v[116:119], a[20:23], v[28:31], v[116:119]
    v_mfma_f32_16x16x32_bf16 v[124:127], a[24:27], v[28:31], v[124:127]
    v_mfma_f32_16x16x32_bf16 v[132:135], a[28:31], v[28:31], v[132:135]
    s_add_u32 s10, s58, 15079424
    buffer_load_dwordx4 v[68:71], v10, s[36:39], s10 offen sc1
    v_mfma_f32_16x16x32_bf16 v[140:143], a[32:35], v[28:31], v[140:143]
    v_mfma_f32_16x16x32_bf16 v[148:151], a[36:39], v[28:31], v[148:151]
    s_waitcnt vmcnt(11)
    v_mfma_f32_16x16x32_bf16 v[172:175], a[40:43], v[32:35], v[172:175]
    v_mfma_f32_16x16x32_bf16 v[176:179], a[44:47], v[32:35], v[176:179]
    v_mfma_f32_16x16x32_bf16 v[128:131], a[48:51], v[32:35], v[128:131]
    s_add_u32 s10, s57, 15080448
    buffer_load_dwordx4 v[72:75], v10, s[36:39], s10 offen sc1
    v_mfma_f32_16x16x32_bf16 v[136:139], a[52:55], v[32:35], v[136:139]
    v_mfma_f32_16x16x32_bf16 v[180:183], a[56:59], v[32:35], v[180:183]
    s_waitcnt vmcnt(11)
    v_mfma_f32_16x16x32_bf16 v[116:119], a[40:43], v[36:39], v[116:119]
    v_mfma_f32_16x16x32_bf16 v[124:127], a[44:47], v[36:39], v[124:127]
    v_mfma_f32_16x16x32_bf16 v[132:135], a[48:51], v[36:39], v[132:135]
    s_add_u32 s10, s58, 15080448
    buffer_load_dwordx4 v[76:79], v10, s[36:39], s10 offen sc1
    v_mfma_f32_16x16x32_bf16 v[140:143], a[52:55], v[36:39], v[140:143]
    v_mfma_f32_16x16x32_bf16 v[148:151], a[56:59], v[36:39], v[148:151]
    s_waitcnt vmcnt(11)
    v_mfma_f32_16x16x32_bf16 v[172:175], a[60:63], v[40:43], v[172:175]
    v_mfma_f32_16x16x32_bf16 v[176:179], a[64:67], v[40:43], v[176:179]
    v_mfma_f32_16x16x32_bf16 v[128:131], a[68:71], v[40:43], v[128:131]
    s_add_u32 s10, s57, 15081472
    buffer_load_dwordx4 v[80:83], v10, s[36:39], s10 offen sc1
    v_mfma_f32_16x16x32_bf16 v[136:139], a[72:75], v[40:43], v[136:139]
    v_mfma_f32_16x16x32_bf16 v[180:183], a[76:79], v[40:43], v[180:183]
    s_waitcnt vmcnt(11)
    v_mfma_f32_16x16x32_bf16 v[116:119], a[60:63], v[44:47], v[116:119]
    v_mfma_f32_16x16x32_bf16 v[124:127], a[64:67], v[44:47], v[124:127]
    v_mfma_f32_16x16x32_bf16 v[132:135], a[68:71], v[44:47], v[132:135]
    s_add_u32 s10, s58, 15081472
    buffer_load_dwordx4 v[84:87], v10, s[36:39], s10 offen sc1
    v_mfma_f32_16x16x32_bf16 v[140:143], a[72:75], v[44:47], v[140:143]
    v_mfma_f32_16x16x32_bf16 v[148:151], a[76:79], v[44:47], v[148:151]
    s_waitcnt vmcnt(11)
    v_mfma_f32_16x16x32_bf16 v[172:175], a[80:83], v[48:51], v[172:175]
    v_mfma_f32_16x16x32_bf16 v[176:179], a[84:87], v[48:51], v[176:179]
    v_mfma_f32_16x16x32_bf16 v[128:131], a[88:91], v[48:51], v[128:131]
    s_add_u32 s10, s57, 15082496
    buffer_load_dwordx4 v[88:91], v10, s[36:39], s10 offen sc1
    v_mfma_f32_16x16x32_bf16 v[136:139], a[92:95], v[48:51], v[136:139]
    v_mfma_f32_16x16x32_bf16 v[180:183], a[96:99], v[48:51], v[180:183]
    s_waitcnt vmcnt(11)
    v_mfma_f32_16x16x32_bf16 v[116:119], a[80:83], v[52:55], v[116:119]
    v_mfma_f32_16x16x32_bf16 v[124:127], a[84:87], v[52:55], v[124:127]
    v_mfma_f32_16x16x32_bf16 v[132:135], a[88:91], v[52:55], v[132:135]
    s_add_u32 s10, s58, 15082496
    buffer_load_dwordx4 v[92:95], v10, s[36:39], s10 offen sc1
    v_mfma_f32_16x16x32_bf16 v[140:143], a[92:95], v[52:55], v[140:143]
    v_mfma_f32_16x16x32_bf16 v[148:151], a[96:99], v[52:55], v[148:151]
    s_barrier
    s_waitcnt vmcnt(9)
    v_mfma_f32_16x16x32_bf16 v[172:175], a[100:103], v[56:59], v[172:175]
    v_mfma_f32_16x16x32_bf16 v[176:179], a[104:107], v[56:59], v[176:179]
    v_mfma_f32_16x16x32_bf16 v[128:131], a[108:111], v[56:59], v[128:131]
    s_add_u32 s10, s57, 15083520
    buffer_load_dwordx4 v[96:99], v10, s[36:39], s10 offen sc1
    v_mfma_f32_16x16x32_bf16 v[136:139], a[112:115], v[56:59], v[136:139]
    v_mfma_f32_16x16x32_bf16 v[180:183], a[116:119], v[56:59], v[180:183]
    s_waitcnt vmcnt(9)
    v_mfma_f32_16x16x32_bf16 v[116:119], a[100:103], v[60:63], v[116:119]
    v_mfma_f32_16x16x32_bf16 v[124:127], a[104:107], v[60:63], v[124:127]
    v_mfma_f32_16x16x32_bf16 v[132:135], a[108:111], v[60:63], v[132:135]
    s_add_u32 s10, s58, 15083520
    buffer_load_dwordx4 v[100:103], v10, s[36:39], s10 offen sc1
    v_mfma_f32_16x16x32_bf16 v[140:143], a[112:115], v[60:63], v[140:143]
    v_mfma_f32_16x16x32_bf16 v[148:151], a[116:119], v[60:63], v[148:151]
    s_waitcnt vmcnt(9)
    v_mfma_f32_16x16x32_bf16 v[172:175], a[120:123], v[64:67], v[172:175]
    v_mfma_f32_16x16x32_bf16 v[176:179], a[124:127], v[64:67], v[176:179]
    v_mfma_f32_16x16x32_bf16 v[128:131], a[128:131], v[64:67], v[128:131]
    s_add_u32 s10, s57, 15084544
    buffer_load_dwordx4 v[104:107], v10, s[36:39], s10 offen sc1
    v_mfma_f32_16x16x32_bf16 v[136:139], a[132:135], v[64:67], v[136:139]
    v_mfma_f32_16x16x32_bf16 v[180:183], a[136:139], v[64:67], v[180:183]
    s_waitcnt vmcnt(9)
    v_mfma_f32_16x16x32_bf16 v[116:119], a[120:123], v[68:71], v[116:119]
    v_mfma_f32_16x16x32_bf16 v[124:127], a[124:127], v[68:71], v[124:127]
    v_mfma_f32_16x16x32_bf16 v[132:135], a[128:131], v[68:71], v[132:135]
    s_add_u32 s10, s58, 15084544
    buffer_load_dwordx4 v[108:111], v10, s[36:39], s10 offen sc1
    v_mfma_f32_16x16x32_bf16 v[140:143], a[132:135], v[68:71], v[140:143]
    v_mfma_f32_16x16x32_bf16 v[148:151], a[136:139], v[68:71], v[148:151]
    s_waitcnt vmcnt(9)
    v_mfma_f32_16x16x32_bf16 v[172:175], a[140:143], v[72:75], v[172:175]
    v_mfma_f32_16x16x32_bf16 v[176:179], a[144:147], v[72:75], v[176:179]
    v_mfma_f32_16x16x32_bf16 v[128:131], a[148:151], v[72:75], v[128:131]
    v_mfma_f32_16x16x32_bf16 v[136:139], a[152:155], v[72:75], v[136:139]
    v_mfma_f32_16x16x32_bf16 v[180:183], a[156:159], v[72:75], v[180:183]
    s_waitcnt vmcnt(8)
    v_mfma_f32_16x16x32_bf16 v[116:119], a[140:143], v[76:79], v[116:119]
    v_mfma_f32_16x16x32_bf16 v[124:127], a[144:147], v[76:79], v[124:127]
    v_mfma_f32_16x16x32_bf16 v[132:135], a[148:151], v[76:79], v[132:135]
    v_mfma_f32_16x16x32_bf16 v[140:143], a[152:155], v[76:79], v[140:143]
    v_mfma_f32_16x16x32_bf16 v[148:151], a[156:159], v[76:79], v[148:151]
    s_waitcnt vmcnt(7)
    v_mfma_f32_16x16x32_bf16 v[172:175], a[160:163], v[80:83], v[172:175]
    v_mfma_f32_16x16x32_bf16 v[176:179], a[164:167], v[80:83], v[176:179]
    v_mfma_f32_16x16x32_bf16 v[128:131], a[168:171], v[80:83], v[128:131]
    v_mfma_f32_16x16x32_bf16 v[136:139], a[172:175], v[80:83], v[136:139]
    v_mfma_f32_16x16x32_bf16 v[180:183], a[176:179], v[80:83], v[180:183]
    s_waitcnt vmcnt(6)
    v_mfma_f32_16x16x32_bf16 v[116:119], a[160:163], v[84:87], v[116:119]
    v_mfma_f32_16x16x32_bf16 v[124:127], a[164:167], v[84:87], v[124:127]
    v_mfma_f32_16x16x32_bf16 v[132:135], a[168:171], v[84:87], v[132:135]
    v_mfma_f32_16x16x32_bf16 v[140:143], a[172:175], v[84:87], v[140:143]
    v_mfma_f32_16x16x32_bf16 v[148:151], a[176:179], v[84:87], v[148:151]
    s_waitcnt vmcnt(4)
    v_mfma_f32_16x16x32_bf16 v[116:119], a[180:183], v[92:95], v[116:119]
    s_waitcnt vmcnt(2)
    v_mfma_f32_16x16x32_bf16 v[116:119], a[200:203], v[100:103], v[116:119]
    s_waitcnt vmcnt(0)
    v_mfma_f32_16x16x32_bf16 v[116:119], a[220:223], v[108:111], v[116:119]
    v_mfma_f32_16x16x32_bf16 v[124:127], a[184:187], v[92:95], v[124:127]
    v_mfma_f32_16x16x32_bf16 v[124:127], a[204:207], v[100:103], v[124:127]
    v_mfma_f32_16x16x32_bf16 v[124:127], a[224:227], v[108:111], v[124:127]
    v_mfma_f32_16x16x32_bf16 v[128:131], a[188:191], v[88:91], v[128:131]
    v_mfma_f32_16x16x32_bf16 v[128:131], a[208:211], v[96:99], v[128:131]
    v_mfma_f32_16x16x32_bf16 v[128:131], a[228:231], v[104:107], v[128:131]
    s_nop 1
    ds_write_b128 v249, v[116:119] offset:0
    v_mfma_f32_16x16x32_bf16 v[136:139], a[192:195], v[88:91], v[136:139]
    v_mfma_f32_16x16x32_bf16 v[136:139], a[212:215], v[96:99], v[136:139]
    v_mfma_f32_16x16x32_bf16 v[136:139], a[232:235], v[104:107], v[136:139]
    ds_write_b128 v249, v[124:127] offset:1024
    v_mfma_f32_16x16x32_bf16 v[132:135], a[188:191], v[92:95], v[132:135]
    v_mfma_f32_16x16x32_bf16 v[132:135], a[208:211], v[100:103], v[132:135]
    v_mfma_f32_16x16x32_bf16 v[132:135], a[228:231], v[108:111], v[132:135]
    ds_write_b128 v249, v[128:131] offset:2048
    v_mfma_f32_16x16x32_bf16 v[140:143], a[192:195], v[92:95], v[140:143]
    v_lshlrev_b32 v184, 16, v222
    v_mfma_f32_16x16x32_bf16 v[140:143], a[212:215], v[100:103], v[140:143]
    v_and_b32 v185, 0xffff0000, v222
    v_mfma_f32_16x16x32_bf16 v[140:143], a[232:235], v[108:111], v[140:143]
    v_lshlrev_b32 v186, 16, v223
    ds_write_b128 v249, v[136:139] offset:3072
    v_mfma_f32_16x16x32_bf16 v[148:151], a[196:199], v[92:95], v[148:151]
    v_and_b32 v187, 0xffff0000, v223
    v_mfma_f32_16x16x32_bf16 v[148:151], a[216:219], v[100:103], v[148:151]
    v_lshlrev_b32 v188, 16, v224
    v_mfma_f32_16x16x32_bf16 v[148:151], a[236:239], v[108:111], v[148:151]
    v_and_b32 v189, 0xffff0000, v224
    ds_write_b128 v249, v[132:135] offset:4096
    v_mfma_f32_16x16x32_bf16 v[180:183], a[196:199], v[88:91], v[180:183]
    v_lshlrev_b32 v190, 16, v225
    v_mfma_f32_16x16x32_bf16 v[180:183], a[216:219], v[96:99], v[180:183]
    v_and_b32 v191, 0xffff0000, v225
    v_mfma_f32_16x16x32_bf16 v[180:183], a[236:239], v[104:107], v[180:183]
    v_lshlrev_b32 v192, 16, v226
    ds_write_b128 v249, v[140:143] offset:5120
    v_mfma_f32_16x16x32_bf16 v[172:175], a[180:183], v[88:91], v[172:175]
    v_and_b32 v193, 0xffff0000, v226
    v_mfma_f32_16x16x32_bf16 v[172:175], a[200:203], v[96:99], v[172:175]
    v_lshlrev_b32 v194, 16, v227
    v_mfma_f32_16x16x32_bf16 v[172:175], a[220:223], v[104:107], v[172:175]
    v_and_b32 v195, 0xffff0000, v227
    ds_write_b128 v249, v[148:151] offset:7168
    v_mfma_f32_16x16x32_bf16 v[176:179], a[184:187], v[88:91], v[176:179]
    v_xor_b32 v197, 8192, v249
    v_mfma_f32_16x16x32_bf16 v[176:179], a[204:207], v[96:99], v[176:179]
    v_xor_b32 v198, 16384, v249
    v_mfma_f32_16x16x32_bf16 v[176:179], a[224:227], v[104:107], v[176:179]
    v_xor_b32 v199, 24576, v249
    ds_write_b128 v249, v[180:183] offset:6144
    s_waitcnt lgkmcnt(0)
    s_barrier
    ds_read_b128 v[112:115], v197 offset:0
    ds_read_b128 v[116:119], v197 offset:1024
    ds_read_b128 v[120:123], v197 offset:7168
    ds_read_b128 v[124:127], v198 offset:2048
    ds_read_b128 v[128:131], v198 offset:3072
    ds_read_b128 v[132:135], v198 offset:6144
    ds_read_b128 v[136:139], v199 offset:4096
    ds_read_b128 v[140:143], v199 offset:5120
    ds_read_b128 v[144:147], v199 offset:7168
    v_pk_add_f32 v[172:173], v[172:173], v[184:185]
    v_pk_add_f32 v[174:175], v[174:175], v[186:187]
    v_pk_add_f32 v[176:177], v[176:177], v[188:189]
    v_pk_add_f32 v[178:179], v[178:179], v[190:191]
    v_pk_add_f32 v[180:181], v[180:181], v[192:193]
    v_pk_add_f32 v[182:183], v[182:183], v[194:195]
    s_waitcnt lgkmcnt(8)
    v_pk_add_f32 v[172:173], v[172:173], v[112:113]
    v_pk_add_f32 v[174:175], v[174:175], v[114:115]
    s_waitcnt lgkmcnt(7)
    v_pk_add_f32 v[176:177], v[176:177], v[116:117]
    v_pk_add_f32 v[178:179], v[178:179], v[118:119]
    s_waitcnt lgkmcnt(6)
    v_pk_add_f32 v[180:181], v[180:181], v[120:121]
    v_pk_add_f32 v[182:183], v[182:183], v[122:123]
    s_waitcnt lgkmcnt(5)
    v_pk_add_f32 v[172:173], v[172:173], v[124:125]
    v_pk_add_f32 v[174:175], v[174:175], v[126:127]
    s_waitcnt lgkmcnt(4)
    v_pk_add_f32 v[176:177], v[176:177], v[128:129]
    v_pk_add_f32 v[178:179], v[178:179], v[130:131]
    s_waitcnt lgkmcnt(3)
    v_pk_add_f32 v[180:181], v[180:181], v[132:133]
    v_pk_add_f32 v[182:183], v[182:183], v[134:135]
    s_waitcnt lgkmcnt(2)
    v_pk_add_f32 v[172:173], v[172:173], v[136:137]
    v_pk_add_f32 v[174:175], v[174:175], v[138:139]
    s_waitcnt lgkmcnt(1)
    v_pk_add_f32 v[176:177], v[176:177], v[140:141]
    v_pk_add_f32 v[178:179], v[178:179], v[142:143]
    s_waitcnt lgkmcnt(0)
    v_pk_add_f32 v[180:181], v[180:181], v[144:145]
    v_pk_add_f32 v[182:183], v[182:183], v[146:147]
    v_cvt_pk_bf16_f32 v184, v172, v173
    v_cvt_pk_bf16_f32 v185, v174, v175
    v_cvt_pk_bf16_f32 v186, v176, v177
    v_cvt_pk_bf16_f32 v187, v178, v179
    v_cvt_pk_bf16_f32 v188, v180, v181
    v_cvt_pk_bf16_f32 v189, v182, v183
    v_mul_u32_u24 v192, 1280, v13
    s_mul_i32 s12, s8, 160
    s_add_u32 s12, s12, 163840
    s_lshl_b32 s13, s14, 6
    s_add_u32 s13, s13, s12
    v_lshl_add_u32 v193, v3, 4, v192
    v_lshl_add_u32 v194, v3, 3, v192
    s_lshl_b32 s10, s14, 31
    v_or_b32 v194, s10, v194
    buffer_store_dwordx4 v[184:187], v193, s[48:51], s13 offen
    buffer_store_dwordx2 v[188:189], v194, s[48:51], s12 offen offset:128
main_end:
    s_endpgm
main_code_end:

.section .rodata,"a"
.p2align 6
.amdhsa_kernel interleave_layers__ssm_conv_h3__swiglu_ffn__prompt_kernel
  .amdhsa_next_free_vgpr 500
  .amdhsa_next_free_sgpr 102
  .amdhsa_accum_offset 256
  .amdhsa_group_segment_fixed_size 0
  .amdhsa_kernarg_size 104
  .amdhsa_user_sgpr_count 2
  .amdhsa_user_sgpr_kernarg_segment_ptr 1
  .amdhsa_system_sgpr_workgroup_id_x 1
  .amdhsa_float_denorm_mode_32 3
.end_amdhsa_kernel
```
